```python
import torch

def _softmax(x, axis=-1):
    return torch.softmax(x, dim=axis)
def _gelu(x):
    return torch.nn.functional.gelu(x, approximate="tanh")
def _silu(x):
    return torch.nn.functional.silu(x)
def _sigmoid(x):
    return torch.sigmoid(x)
def _layernorm(x, axis=-1, eps=1e-5):
    m = x.mean(dim=axis, keepdim=True)
    v = x.var(dim=axis, keepdim=True, unbiased=False)
    return (x - m) / torch.sqrt(v + eps)
def _scatter_add(tgt, idx, src, axis=0):
    return tgt.clone().index_add_(axis, idx, src)
def _segment_sum(src, seg, n):
    out = torch.zeros((n,) + src.shape[1:], dtype=src.dtype)
    return out.index_add_(0, seg, src)
def _pad(x, pw):
    flat = tuple(v for pair in reversed(pw) for v in pair)
    return torch.nn.functional.pad(x, flat)

kernel_name = 'interleave_layers__ssm_conv_h3__softmax_full_mha__prompt'

def setup_inputs():

    _w = (lambda a: (lambda t: t.to(torch.bfloat16) if t.is_floating_point() else t)(torch.as_tensor(a)))
    def _A_setup():
        B, S, D = 1, 2048, 576
        ks = 4
        return {
            "q": _w((lambda *s: torch.randn(*s, dtype=torch.bfloat16) * 0.05)(B, S, D)),
            "k": _w((lambda *s: torch.randn(*s, dtype=torch.bfloat16) * 0.4)(B, S, D)),
            "v": _w((lambda *s: torch.randn(*s, dtype=torch.bfloat16) * 0.4)(B, S, D)),
            "shift_k": _w((lambda *s: torch.randn(*s, dtype=torch.bfloat16) * 0.4)(D, ks) * 0.5),
            "ssm_k": _w((lambda *s: torch.randn(*s, dtype=torch.bfloat16) * 0.4)(D, S) * (1.0 / S ** 0.5)),
            "ssm_D": _w((lambda *s: torch.randn(*s, dtype=torch.bfloat16) * 0.4)(D)),
        }
    _A_in = _A_setup()

    def _B_setup():
        B, S, D = 1, 2048, 576
        return {
            "x": _w((lambda *s: torch.randn(*s, dtype=torch.bfloat16) * 0.05)(B, S, D)),
            "wqkv": _w((lambda *s: torch.randn(*s, dtype=torch.bfloat16) * 0.05)(D, 3 * D)),
            "wo": _w((lambda *s: torch.randn(*s, dtype=torch.bfloat16) * 0.05)(D, D)),
        }
    _B_in = _B_setup()

    return {
        "A_q": _A_in["q"],
        "A_k": _A_in["k"],
        "A_v": _A_in["v"],
        "A_shift_k": _A_in["shift_k"],
        "A_ssm_k": _A_in["ssm_k"],
        "A_ssm_D": _A_in["ssm_D"],
        "B_x": _B_in["x"],
        "B_wqkv": _B_in["wqkv"],
        "B_wo": _B_in["wo"],
    }

def reference(A_q, A_k, A_v, A_shift_k, A_ssm_k, A_ssm_D, B_x, B_wqkv, B_wo):
    def _A_ref(q, k, v, shift_k, ssm_k, ssm_D):
        B, S, D = q.shape
        ks = shift_k.shape[-1]
        k_pad = _pad(k, ((0, 0), (ks - 1, 0), (0, 0)))
        k_shift = torch.zeros_like(k)
        for t in range(ks):
            k_shift = k_shift + k_pad[:, t:t + S, :] * shift_k[:, ks - 1 - t][None, None, :]
        kv = k_shift * v
        L = 2 * S
        kv_pad = _pad(kv, ((0, 0), (0, S), (0, 0)))
        kf_pad = _pad(ssm_k, ((0, 0), (0, S)))
        kv_f = (lambda x, axes=(-2,-1): torch.fft.rfft2(x.float(), dim=axes))(kv_pad[:, None, :, :], axes=(1, 2))
        kf_f = (lambda x, axes=(-2,-1): torch.fft.rfft2(x.float(), dim=axes))(kf_pad[:, None, :], axes=(1, 2))
        kf_f = (lambda x, *d: x.permute(*d))(kf_f, 1, 2, 0)
        y_f = kv_f * kf_f[None, :, :, :]
        y = (lambda x, s, axes=(-2,-1): torch.fft.irfft2(x, s=s, dim=axes).to(torch.bfloat16))(y_f, (1, L), axes=(1, 2))[:, 0, :S, :]
        y = y + kv * ssm_D[None, None, :]
        return q * y

    def _B_ref(x, wqkv, wo):
        B, S, D = x.shape
        H = 32; Dh = D // H
        qkv = (lambda x, *d: x.permute(*d))((x @ wqkv).reshape(B, S, 3, H, Dh), 2, 0, 3, 1, 4)
        q, k, v = qkv[0], qkv[1], qkv[2]
        scale = Dh ** -0.5
        scores = torch.einsum("bhqd,bhkd->bhqk", q, k) * scale
        p = _softmax(scores, axis=-1)
        o = torch.einsum("bhqk,bhkd->bhqd", p, v)
        return (lambda x, *d: x.permute(*d))(o, 0, 2, 1, 3).reshape(B, S, D) @ wo

    x = A_q
    x = x + _A_ref(_layernorm(x, axis=-1), A_k, A_v, A_shift_k, A_ssm_k, A_ssm_D)
    x = x + _B_ref(_layernorm(x, axis=-1), B_wqkv, B_wo)
    x = x + _A_ref(_layernorm(x, axis=-1), A_k, A_v, A_shift_k, A_ssm_k, A_ssm_D)
    x = x + _B_ref(_layernorm(x, axis=-1), B_wqkv, B_wo)
    return x
```

```asm
; @launch grid=(256,1,1) block=(512,1,1) lds=163840
.amdgcn_target "amdgcn-amd-amdhsa--gfx950"
.text
.p2align 8
.globl interleave_layers__ssm_conv_h3__softmax_full_mha__prompt_kernel
.type interleave_layers__ssm_conv_h3__softmax_full_mha__prompt_kernel,@function
interleave_layers__ssm_conv_h3__softmax_full_mha__prompt_kernel:
    s_cmp_ge_u32 s2, 256
    s_cbranch_scc1 Lend0_2
    s_load_dwordx8 s[8:15], s[0:1], 0
    s_load_dwordx4 s[16:19], s[0:1], 32
    s_load_dwordx4 s[24:27], s[0:1], 56
    s_load_dwordx4 s[28:31], s[0:1], 80
    v_lshrrev_b32 v2, 6, v0
    v_and_b32 v1, 63, v0
    v_readfirstlane_b32 s3, v2
    v_lshlrev_b32 v2, 4, v1
    s_and_b32 s4, s2, 7
    s_lshr_b32 s5, s2, 3
    s_mov_b32 s7, 0
    s_waitcnt lgkmcnt(0)
    s_load_dword s6, s[30:31], 0
    s_mov_b32 s20, s30
    s_mov_b32 s21, s31
    s_mov_b32 s22, 268435456
    s_mov_b32 s23, 0x20000
    s_mul_i32 s56, s2, 9216
    s_cmp_gt_u32 s3, 4
    s_cbranch_scc1 LnoT_9
    v_min_u32 v9, 287, v0
    v_lshl_add_u32 v3, v9, 2, s56
    v_lshlrev_b32 v9, 4, v9
    v_add_u32 v4, 4608, v3
    v_subrev_u32 v5, 3456, v3
    v_mov_b32 v7, 2147483648
    v_mov_b32 v20, 0
    v_mov_b32 v21, 0
    v_mov_b32 v22, 0
    s_cmp_eq_u32 s2, 0
    s_cbranch_scc1 LnoT_9h
    global_load_dword v20, v5, s[10:11] offset:0
    global_load_dword v21, v5, s[10:11] offset:1152
    global_load_dword v22, v5, s[10:11] offset:2304
LnoT_9h:
    global_load_dword v23, v3, s[10:11] offset:0
    global_load_dword v24, v3, s[10:11] offset:1152
    global_load_dword v25, v3, s[10:11] offset:2304
    global_load_dword v26, v3, s[10:11] offset:3456
    global_load_dword v27, v4, s[10:11] offset:0
    global_load_dword v28, v4, s[10:11] offset:1152
    global_load_dword v29, v4, s[10:11] offset:2304
    global_load_dword v30, v4, s[10:11] offset:3456
    global_load_dwordx4 v[48:51], v9, s[14:15]
    global_load_dword v32, v3, s[12:13] offset:0
    global_load_dword v33, v3, s[12:13] offset:1152
    global_load_dword v34, v3, s[12:13] offset:2304
    global_load_dword v35, v3, s[12:13] offset:3456
    global_load_dword v36, v4, s[12:13] offset:0
    global_load_dword v37, v4, s[12:13] offset:1152
    global_load_dword v38, v4, s[12:13] offset:2304
    global_load_dword v39, v4, s[12:13] offset:3456
    global_load_dword v40, v3, s[8:9] offset:0
    global_load_dword v41, v3, s[8:9] offset:1152
    global_load_dword v42, v3, s[8:9] offset:2304
    global_load_dword v43, v3, s[8:9] offset:3456
    global_load_dword v44, v4, s[8:9] offset:0
    global_load_dword v45, v4, s[8:9] offset:1152
    global_load_dword v46, v4, s[8:9] offset:2304
    global_load_dword v47, v4, s[8:9] offset:3456
LnoT_9:
    s_mov_b32 s36, s8
    s_mov_b32 s37, s9
    s_mov_b32 s38, 2359296
    s_mov_b32 s39, 0x20000
    s_mov_b32 s44, s12
    s_mov_b32 s45, s13
    s_mov_b32 s46, 2359296
    s_mov_b32 s47, 0x20000
    s_cmp_eq_u32 s3, 5
    s_cbranch_scc0 Lw5_11
    v_lshrrev_b32 v10, 3, v1
    v_and_b32 v11, 7, v1
    v_mul_u32_u24 v12, 1152, v10
    v_mul_u32_u24 v13, 144, v11
    v_add3_u32 v12, v12, v13, s56
    buffer_load_dwordx4 v[20:23], v12, s[36:39], 0 offen offset:0
    buffer_load_dwordx4 v[24:27], v12, s[36:39], 0 offen offset:16
    buffer_load_dwordx4 v[28:31], v12, s[36:39], 0 offen offset:32
    buffer_load_dwordx4 v[32:35], v12, s[36:39], 0 offen offset:48
    buffer_load_dwordx4 v[36:39], v12, s[36:39], 0 offen offset:64
    buffer_load_dwordx4 v[40:43], v12, s[36:39], 0 offen offset:80
    buffer_load_dwordx4 v[44:47], v12, s[36:39], 0 offen offset:96
    buffer_load_dwordx4 v[48:51], v12, s[36:39], 0 offen offset:112
    buffer_load_dwordx4 v[52:55], v12, s[36:39], 0 offen offset:128
Lw5_11:
    s_mov_b32 s52, s16
    s_mov_b32 s53, s17
    s_mov_b32 s54, 2359296
    s_mov_b32 s55, 0x20000
    s_and_b32 s60, s2, 7
    s_lshr_b32 s61, s2, 4
    s_lshl_b32 s61, s61, 3
    s_add_u32 s61, s61, s60
    s_lshl_b32 s61, s61, 1
    s_bfe_u32 s60, s2, 0x10003
    s_add_u32 s61, s61, s60
    s_and_b32 s62, s3, 3
    s_lshl_b32 s63, s61, 2
    s_add_u32 s63, s63, s62
    s_cmp_eq_u32 s3, 5
    s_cbranch_scc1 Lw5_11b
    s_cmp_eq_u32 s3, 6
    s_cbranch_scc1 Lw6_12
    s_cmp_eq_u32 s3, 7
    s_cbranch_scc1 Lw7_13
    v_and_b32 v16, 31, v1
    v_lshlrev_b32 v16, 5, v16
    v_lshrrev_b32 v17, 5, v1
    v_lshl_add_u32 v16, v17, 4, v16
    s_lshl_b32 s57, s3, 11
    s_add_u32 s57, s57, s56
    v_add_u32 v16, s57, v16
    v_add_u32 v17, 1024, v16
    s_cmp_eq_u32 s3, 4
    s_cselect_b64 s[58:59], -1, 0
    v_cndmask_b32 v17, v17, v7, s[58:59]
    s_waitcnt vmcnt(16)
    v_and_b32 v64, 0xffff, v48
    v_lshrrev_b32 v65, 16, v48
    v_and_b32 v66, 0xffff, v49
    v_lshrrev_b32 v67, 16, v49
    v_lshlrev_b32 v68, 16, v50
    v_and_b32 v69, 0xffff0000, v50
    v_lshlrev_b32 v70, 16, v51
    v_and_b32 v71, 0xffff0000, v51
    v_dot2_f32_bf16 v72, v20, v67, 0
    v_dot2_f32_bf16 v80, v20, v71, 0
    v_dot2_f32_bf16 v73, v21, v67, 0
    v_dot2_f32_bf16 v81, v21, v71, 0
    v_dot2_f32_bf16 v74, v22, v67, 0
    v_dot2_f32_bf16 v82, v22, v71, 0
    v_dot2_f32_bf16 v75, v23, v67, 0
    v_dot2_f32_bf16 v83, v23, v71, 0
    v_dot2_f32_bf16 v76, v24, v67, 0
    v_dot2_f32_bf16 v84, v24, v71, 0
    v_dot2_f32_bf16 v77, v25, v67, 0
    v_dot2_f32_bf16 v85, v25, v71, 0
    v_dot2_f32_bf16 v78, v26, v67, 0
    v_dot2_f32_bf16 v86, v26, v71, 0
    v_dot2_f32_bf16 v79, v27, v67, 0
    v_dot2_f32_bf16 v87, v27, v71, 0
    v_dot2_f32_bf16 v72, v21, v66, v72
    v_dot2_f32_bf16 v80, v21, v70, v80
    v_dot2_f32_bf16 v73, v22, v66, v73
    v_dot2_f32_bf16 v81, v22, v70, v81
    v_dot2_f32_bf16 v74, v23, v66, v74
    v_dot2_f32_bf16 v82, v23, v70, v82
    v_dot2_f32_bf16 v75, v24, v66, v75
    v_dot2_f32_bf16 v83, v24, v70, v83
    v_dot2_f32_bf16 v76, v25, v66, v76
    v_dot2_f32_bf16 v84, v25, v70, v84
    v_dot2_f32_bf16 v77, v26, v66, v77
    v_dot2_f32_bf16 v85, v26, v70, v85
    v_dot2_f32_bf16 v78, v27, v66, v78
    v_dot2_f32_bf16 v86, v27, v70, v86
    v_dot2_f32_bf16 v79, v28, v66, v79
    v_dot2_f32_bf16 v87, v28, v70, v87
    v_dot2_f32_bf16 v72, v22, v65, v72
    v_dot2_f32_bf16 v80, v22, v69, v80
    v_dot2_f32_bf16 v73, v23, v65, v73
    v_dot2_f32_bf16 v81, v23, v69, v81
    v_dot2_f32_bf16 v74, v24, v65, v74
    v_dot2_f32_bf16 v82, v24, v69, v82
    v_dot2_f32_bf16 v75, v25, v65, v75
    v_dot2_f32_bf16 v83, v25, v69, v83
    v_dot2_f32_bf16 v76, v26, v65, v76
    v_dot2_f32_bf16 v84, v26, v69, v84
    v_dot2_f32_bf16 v77, v27, v65, v77
    v_dot2_f32_bf16 v85, v27, v69, v85
    v_dot2_f32_bf16 v78, v28, v65, v78
    v_dot2_f32_bf16 v86, v28, v69, v86
    v_dot2_f32_bf16 v79, v29, v65, v79
    v_dot2_f32_bf16 v87, v29, v69, v87
    v_dot2_f32_bf16 v72, v23, v64, v72
    v_dot2_f32_bf16 v80, v23, v68, v80
    v_dot2_f32_bf16 v73, v24, v64, v73
    v_dot2_f32_bf16 v81, v24, v68, v81
    v_dot2_f32_bf16 v74, v25, v64, v74
    v_dot2_f32_bf16 v82, v25, v68, v82
    v_dot2_f32_bf16 v75, v26, v64, v75
    v_dot2_f32_bf16 v83, v26, v68, v83
    v_dot2_f32_bf16 v76, v27, v64, v76
    v_dot2_f32_bf16 v84, v27, v68, v84
    v_dot2_f32_bf16 v77, v28, v64, v77
    v_dot2_f32_bf16 v85, v28, v68, v85
    v_dot2_f32_bf16 v78, v29, v64, v78
    v_dot2_f32_bf16 v86, v29, v68, v86
    v_dot2_f32_bf16 v79, v30, v64, v79
    v_dot2_f32_bf16 v87, v30, v68, v87
    s_waitcnt vmcnt(8)
    v_lshlrev_b32 v88, 16, v32
    v_and_b32 v32, 0xffff0000, v32
    v_lshlrev_b32 v89, 16, v33
    v_and_b32 v33, 0xffff0000, v33
    v_lshlrev_b32 v90, 16, v34
    v_and_b32 v34, 0xffff0000, v34
    v_lshlrev_b32 v91, 16, v35
    v_and_b32 v35, 0xffff0000, v35
    v_lshlrev_b32 v92, 16, v36
    v_and_b32 v36, 0xffff0000, v36
    v_lshlrev_b32 v93, 16, v37
    v_and_b32 v37, 0xffff0000, v37
    v_lshlrev_b32 v94, 16, v38
    v_and_b32 v38, 0xffff0000, v38
    v_lshlrev_b32 v95, 16, v39
    v_and_b32 v39, 0xffff0000, v39
    v_mul_f32 v72, v72, v88
    v_mul_f32 v80, v80, v32
    v_mul_f32 v73, v73, v89
    v_mul_f32 v81, v81, v33
    v_mul_f32 v74, v74, v90
    v_mul_f32 v82, v82, v34
    v_mul_f32 v75, v75, v91
    v_mul_f32 v83, v83, v35
    v_mul_f32 v76, v76, v92
    v_mul_f32 v84, v84, v36
    v_mul_f32 v77, v77, v93
    v_mul_f32 v85, v85, v37
    v_mul_f32 v78, v78, v94
    v_mul_f32 v86, v86, v38
    v_mul_f32 v79, v79, v95
    v_mul_f32 v87, v87, v39
    v_cvt_pk_bf16_f32 v88, v79, v78
    v_cvt_pk_bf16_f32 v89, v77, v76
    v_cvt_pk_bf16_f32 v90, v75, v74
    v_cvt_pk_bf16_f32 v91, v73, v72
    v_cvt_pk_bf16_f32 v92, v87, v86
    v_cvt_pk_bf16_f32 v93, v85, v84
    v_cvt_pk_bf16_f32 v94, v83, v82
    v_cvt_pk_bf16_f32 v95, v81, v80
    s_mov_b32 s57, 1495040
    s_mov_b32 s67, 3854336
    v_permlane32_swap_b32 v88, v92
    v_permlane32_swap_b32 v89, v93
    v_permlane32_swap_b32 v90, v94
    v_permlane32_swap_b32 v91, v95
    buffer_store_dwordx4 v[88:91], v16, s[20:23], s57 offen sc1
    buffer_store_dwordx4 v[92:95], v17, s[20:23], s57 offen sc1
    s_waitcnt vmcnt(2)
    v_permlane32_swap_b32 v40, v44
    v_permlane32_swap_b32 v41, v45
    v_permlane32_swap_b32 v42, v46
    v_permlane32_swap_b32 v43, v47
    buffer_store_dwordx4 v[40:43], v16, s[20:23], s67 offen sc1
    buffer_store_dwordx4 v[44:47], v17, s[20:23], s67 offen sc1
    s_branch LTbar_14
Lw5_11b:
    s_mov_b32 s57, 0x3f803f80
    s_waitcnt vmcnt(0)
    v_dot2_f32_bf16 v17, v20, s57, 0
    v_dot2_f32_bf16 v18, v20, v20, 0
    v_dot2_f32_bf16 v17, v21, s57, v17
    v_dot2_f32_bf16 v18, v21, v21, v18
    v_dot2_f32_bf16 v17, v22, s57, v17
    v_dot2_f32_bf16 v18, v22, v22, v18
    v_dot2_f32_bf16 v17, v23, s57, v17
    v_dot2_f32_bf16 v18, v23, v23, v18
    v_dot2_f32_bf16 v17, v24, s57, v17
    v_dot2_f32_bf16 v18, v24, v24, v18
    v_dot2_f32_bf16 v17, v25, s57, v17
    v_dot2_f32_bf16 v18, v25, v25, v18
    v_dot2_f32_bf16 v17, v26, s57, v17
    v_dot2_f32_bf16 v18, v26, v26, v18
    v_dot2_f32_bf16 v17, v27, s57, v17
    v_dot2_f32_bf16 v18, v27, v27, v18
    v_dot2_f32_bf16 v17, v28, s57, v17
    v_dot2_f32_bf16 v18, v28, v28, v18
    v_dot2_f32_bf16 v17, v29, s57, v17
    v_dot2_f32_bf16 v18, v29, v29, v18
    v_dot2_f32_bf16 v17, v30, s57, v17
    v_dot2_f32_bf16 v18, v30, v30, v18
    v_dot2_f32_bf16 v17, v31, s57, v17
    v_dot2_f32_bf16 v18, v31, v31, v18
    v_dot2_f32_bf16 v17, v32, s57, v17
    v_dot2_f32_bf16 v18, v32, v32, v18
    v_dot2_f32_bf16 v17, v33, s57, v17
    v_dot2_f32_bf16 v18, v33, v33, v18
    v_dot2_f32_bf16 v17, v34, s57, v17
    v_dot2_f32_bf16 v18, v34, v34, v18
    v_dot2_f32_bf16 v17, v35, s57, v17
    v_dot2_f32_bf16 v18, v35, v35, v18
    v_dot2_f32_bf16 v17, v36, s57, v17
    v_dot2_f32_bf16 v18, v36, v36, v18
    v_dot2_f32_bf16 v17, v37, s57, v17
    v_dot2_f32_bf16 v18, v37, v37, v18
    v_dot2_f32_bf16 v17, v38, s57, v17
    v_dot2_f32_bf16 v18, v38, v38, v18
    v_dot2_f32_bf16 v17, v39, s57, v17
    v_dot2_f32_bf16 v18, v39, v39, v18
    v_dot2_f32_bf16 v17, v40, s57, v17
    v_dot2_f32_bf16 v18, v40, v40, v18
    v_dot2_f32_bf16 v17, v41, s57, v17
    v_dot2_f32_bf16 v18, v41, v41, v18
    v_dot2_f32_bf16 v17, v42, s57, v17
    v_dot2_f32_bf16 v18, v42, v42, v18
    v_dot2_f32_bf16 v17, v43, s57, v17
    v_dot2_f32_bf16 v18, v43, v43, v18
    v_dot2_f32_bf16 v17, v44, s57, v17
    v_dot2_f32_bf16 v18, v44, v44, v18
    v_dot2_f32_bf16 v17, v45, s57, v17
    v_dot2_f32_bf16 v18, v45, v45, v18
    v_dot2_f32_bf16 v17, v46, s57, v17
    v_dot2_f32_bf16 v18, v46, v46, v18
    v_dot2_f32_bf16 v17, v47, s57, v17
    v_dot2_f32_bf16 v18, v47, v47, v18
    v_dot2_f32_bf16 v17, v48, s57, v17
    v_dot2_f32_bf16 v18, v48, v48, v18
    v_dot2_f32_bf16 v17, v49, s57, v17
    v_dot2_f32_bf16 v18, v49, v49, v18
    v_dot2_f32_bf16 v17, v50, s57, v17
    v_dot2_f32_bf16 v18, v50, v50, v18
    v_dot2_f32_bf16 v17, v51, s57, v17
    v_dot2_f32_bf16 v18, v51, v51, v18
    v_dot2_f32_bf16 v17, v52, s57, v17
    v_dot2_f32_bf16 v18, v52, v52, v18
    v_dot2_f32_bf16 v17, v53, s57, v17
    v_dot2_f32_bf16 v18, v53, v53, v18
    v_dot2_f32_bf16 v17, v54, s57, v17
    v_dot2_f32_bf16 v18, v54, v54, v18
    v_dot2_f32_bf16 v17, v55, s57, v17
    v_dot2_f32_bf16 v18, v55, v55, v18
    s_nop 1
    v_add_f32_dpp v17, v17, v17 quad_perm:[1,0,3,2] row_mask:0xf bank_mask:0xf
    v_add_f32_dpp v18, v18, v18 quad_perm:[1,0,3,2] row_mask:0xf bank_mask:0xf
    s_nop 0
    v_add_f32_dpp v17, v17, v17 quad_perm:[2,3,0,1] row_mask:0xf bank_mask:0xf
    v_add_f32_dpp v18, v18, v18 quad_perm:[2,3,0,1] row_mask:0xf bank_mask:0xf
    s_nop 0
    v_add_f32_dpp v17, v17, v17 row_half_mirror row_mask:0xf bank_mask:0xf
    v_add_f32_dpp v18, v18, v18 row_half_mirror row_mask:0xf bank_mask:0xf
    v_mul_f32 v17, 0x3ae38e39, v17
    v_mul_f32 v18, 0x3ae38e39, v18
    v_fma_f32 v18, -v17, v17, v18
    v_max_f32 v18, 0, v18
    v_add_f32 v18, 0x3727c5ac, v18
    v_rsq_f32 v18, v18
    v_lshlrev_b32 v19, 2, v10
    v_lshl_add_u32 v19, v11, 5, v19
    v_mul_f32 v17, -v17, v18
    v_cmp_eq_u32 vcc, 0, v11
    s_lshl_b32 s57, s2, 6
    s_add_u32 s57, s57, 1298432
    v_cndmask_b32 v17, v17, v18, vcc
    s_mov_b32 exec_lo, 0x03030303
    s_mov_b32 exec_hi, 0x03030303
    buffer_store_dword v17, v19, s[20:23], s57 offen sc1
    s_mov_b64 exec, -1
    s_branch LTbar_14
Lw7_13:
    v_mov_b32 v12, -1
    v_mov_b32 v13, -1
    s_lshl_b32 s57, s2, 9
    s_add_u32 s57, s57, 1363968
    v_lshlrev_b32 v11, 3, v1
    buffer_store_dwordx2 v[12:13], v11, s[20:23], s57 offen sc1
    s_getreg_b32 s57, hwreg(HW_REG_XCC_ID, 0, 4)
    v_mov_b32 v14, s57
    s_lshl_b32 s57, s2, 6
    s_add_u32 s57, s57, 200704
    s_mov_b64 exec, 1
    buffer_store_dword v14, v11, s[20:23], s57 offen sc1
    s_mov_b64 exec, -1
Lw6_12:
    v_lshlrev_b32 v11, 2, v1
    v_add_u32 v11, 85248, v11
    v_mov_b32 v12, 0
    ds_write2st64_b32 v11, v12, v12 offset1:1
    s_sub_u32 s57, s2, 144
    s_cmp_ge_u32 s57, 72
    s_cbranch_scc1 Lnsl_15
    s_mov_b32 s48, s24
    s_mov_b32 s49, s25
    s_mov_b32 s50, 1990656
    s_mov_b32 s51, 0x20000
    s_mul_i32 s57, s57, 27648
    s_and_b32 s58, s3, 1
    s_lshl_b32 s58, s58, 10
    s_add_u32 s57, s57, s58
    s_mov_b32 m0, s58
    s_add_u32 s58, s58, 2048
    buffer_load_dwordx4 v2, s[48:51], s57 offen lds
    s_add_u32 s57, s57, 2048
    s_mov_b32 m0, s58
    s_add_u32 s58, s58, 2048
    buffer_load_dwordx4 v2, s[48:51], s57 offen lds
    s_add_u32 s57, s57, 2048
    s_mov_b32 m0, s58
    s_add_u32 s58, s58, 2048
    buffer_load_dwordx4 v2, s[48:51], s57 offen lds
    s_add_u32 s57, s57, 2048
    s_mov_b32 m0, s58
    s_add_u32 s58, s58, 2048
    buffer_load_dwordx4 v2, s[48:51], s57 offen lds
    s_add_u32 s57, s57, 2048
    s_mov_b32 m0, s58
    s_add_u32 s58, s58, 2048
    buffer_load_dwordx4 v2, s[48:51], s57 offen lds
    s_add_u32 s57, s57, 2048
    s_mov_b32 m0, s58
    s_add_u32 s58, s58, 2048
    buffer_load_dwordx4 v2, s[48:51], s57 offen lds
    s_add_u32 s57, s57, 2048
    s_mov_b32 m0, s58
    s_add_u32 s58, s58, 2048
    buffer_load_dwordx4 v2, s[48:51], s57 offen lds
    s_add_u32 s57, s57, 2048
    s_mov_b32 m0, s58
    s_add_u32 s58, s58, 2048
    buffer_load_dwordx4 v2, s[48:51], s57 offen lds
    s_add_u32 s57, s57, 2048
    s_mov_b32 m0, s58
    s_add_u32 s58, s58, 2048
    buffer_load_dwordx4 v2, s[48:51], s57 offen lds
    s_add_u32 s57, s57, 2048
    s_mov_b32 m0, s58
    s_add_u32 s58, s58, 2048
    buffer_load_dwordx4 v2, s[48:51], s57 offen lds
    s_add_u32 s57, s57, 2048
    s_mov_b32 m0, s58
    s_add_u32 s58, s58, 2048
    buffer_load_dwordx4 v2, s[48:51], s57 offen lds
    s_add_u32 s57, s57, 2048
    s_mov_b32 m0, s58
    s_add_u32 s58, s58, 2048
    buffer_load_dwordx4 v2, s[48:51], s57 offen lds
    s_add_u32 s57, s57, 2048
    s_mov_b32 m0, s58
    s_add_u32 s58, s58, 2048
    buffer_load_dwordx4 v2, s[48:51], s57 offen lds
    s_add_u32 s57, s57, 2048
    s_cmp_eq_u32 s3, 7
    s_cbranch_scc1 Lnsl_15
    s_mov_b32 m0, s58
    s_add_u32 s58, s58, 2048
    buffer_load_dwordx4 v2, s[48:51], s57 offen lds
    s_add_u32 s57, s57, 2048
Lnsl_15:
    v_mov_b32 v11, s56
    buffer_load_dword v12, v11, s[44:47], 0 offen offset:3456
    s_waitcnt vmcnt(0)
LTbar_14:
    s_cmp_lt_u32 s3, 4
    s_cbranch_scc1 LnoH_10
    s_cmp_ge_u32 s2, 144
    s_cbranch_scc1 LnoH_10
    s_lshl_b32 s64, s63, 12
    v_add_u32 v99, s64, v2
    buffer_load_dwordx4 v[100:103], v99, s[52:55], 0 offen offset:0
    buffer_load_dwordx2 v[104:105], v99, s[52:55], 0 offen offset:16
    buffer_load_dwordx4 v[106:109], v99, s[52:55], 0 offen offset:1024
    buffer_load_dwordx2 v[110:111], v99, s[52:55], 0 offen offset:1040
    buffer_load_dwordx4 v[112:115], v99, s[52:55], 0 offen offset:2048
    buffer_load_dwordx2 v[116:117], v99, s[52:55], 0 offen offset:2064
    buffer_load_dwordx4 v[118:121], v99, s[52:55], 0 offen offset:3072
    buffer_load_dwordx2 v[122:123], v99, s[52:55], 0 offen offset:3088
    s_lshr_b32 s64, s63, 1
    s_lshl_b32 s64, s64, 2
    s_load_dword s65, s[18:19], s64
    s_waitcnt vmcnt(8) lgkmcnt(0)
    s_branch LnoH_10b
LnoH_10:
    s_waitcnt vmcnt(0) lgkmcnt(0)
LnoH_10b:
    s_add_u32 s6, s6, 0x9e3779b9
    s_barrier
    s_cmp_eq_u32 s3, 6
    s_cbranch_scc0 Lnf_16
    s_lshl_b32 s57, s2, 4
    s_add_u32 s57, s57, 4096
    v_mov_b32 v10, s6
    v_lshlrev_b32 v11, 12, v1
    s_mov_b64 exec, 0xff
    buffer_store_dword v10, v11, s[20:23], s57 offen sc1
    s_mov_b64 exec, -1
Lnf_16:
    s_cmp_ge_u32 s2, 144
    s_cbranch_scc1 Lprep_6
    s_cmp_lt_u32 s3, 4
    s_cbranch_scc1 LClo_17
    s_mul_i32 s36, s62, 16640
    v_add_u32 v4, s36, v2
    s_waitcnt vmcnt(0)
    v_readlane_b32 s38, v100, 0
    v_readlane_b32 s39, v101, 0
    ds_write_b128 v4, v[100:103] offset:32
    v_alignbit_b32 v124, v101, v100, 16
    v_alignbit_b32 v125, v102, v101, 16
    v_alignbit_b32 v126, v103, v102, 16
    v_alignbit_b32 v127, v104, v103, 16
    ds_write_b128 v4, v[124:127] offset:4192
    v_mov_b32 v128, v101
    v_mov_b32 v129, v102
    v_mov_b32 v130, v103
    v_mov_b32 v131, v104
    ds_write_b128 v4, v[128:131] offset:8352
    v_alignbit_b32 v132, v102, v101, 16
    v_alignbit_b32 v133, v103, v102, 16
    v_alignbit_b32 v134, v104, v103, 16
    v_alignbit_b32 v135, v105, v104, 16
    ds_write_b128 v4, v[132:135] offset:12512
    ds_write_b128 v4, v[106:109] offset:1056
    v_alignbit_b32 v124, v107, v106, 16
    v_alignbit_b32 v125, v108, v107, 16
    v_alignbit_b32 v126, v109, v108, 16
    v_alignbit_b32 v127, v110, v109, 16
    ds_write_b128 v4, v[124:127] offset:5216
    v_mov_b32 v128, v107
    v_mov_b32 v129, v108
    v_mov_b32 v130, v109
    v_mov_b32 v131, v110
    ds_write_b128 v4, v[128:131] offset:9376
    v_alignbit_b32 v132, v108, v107, 16
    v_alignbit_b32 v133, v109, v108, 16
    v_alignbit_b32 v134, v110, v109, 16
    v_alignbit_b32 v135, v111, v110, 16
    ds_write_b128 v4, v[132:135] offset:13536
    ds_write_b128 v4, v[112:115] offset:2080
    v_alignbit_b32 v124, v113, v112, 16
    v_alignbit_b32 v125, v114, v113, 16
    v_alignbit_b32 v126, v115, v114, 16
    v_alignbit_b32 v127, v116, v115, 16
    ds_write_b128 v4, v[124:127] offset:6240
    v_mov_b32 v128, v113
    v_mov_b32 v129, v114
    v_mov_b32 v130, v115
    v_mov_b32 v131, v116
    ds_write_b128 v4, v[128:131] offset:10400
    v_alignbit_b32 v132, v114, v113, 16
    v_alignbit_b32 v133, v115, v114, 16
    v_alignbit_b32 v134, v116, v115, 16
    v_alignbit_b32 v135, v117, v116, 16
    ds_write_b128 v4, v[132:135] offset:14560
    ds_write_b128 v4, v[118:121] offset:3104
    v_alignbit_b32 v124, v119, v118, 16
    v_alignbit_b32 v125, v120, v119, 16
    v_alignbit_b32 v126, v121, v120, 16
    v_alignbit_b32 v127, v122, v121, 16
    ds_write_b128 v4, v[124:127] offset:7264
    v_mov_b32 v128, v119
    v_mov_b32 v129, v120
    v_mov_b32 v130, v121
    v_mov_b32 v131, v122
    ds_write_b128 v4, v[128:131] offset:11424
    v_alignbit_b32 v132, v120, v119, 16
    v_alignbit_b32 v133, v121, v120, 16
    v_alignbit_b32 v134, v122, v121, 16
    v_alignbit_b32 v135, v123, v122, 16
    ds_write_b128 v4, v[132:135] offset:15584
    v_mov_b32 v12, 0
    v_mov_b32 v13, 0
    v_mov_b32 v14, 0
    v_mov_b32 v15, 0
    v_lshlrev_b32 v11, 3, v0
    v_add_u32 v11, 64512, v11
    ds_write_b64 v11, v[12:13]
    v_mov_b32 v11, 84992
    ds_write_b128 v11, v[12:15]
    ds_write_b128 v11, v[12:15] offset:32
    v_mul_u32_u24 v11, 4160, v1
    v_add_u32 v11, s36, v11
    v_lshlrev_b32 v16, 4, v1
    v_sub_u32 v16, 48, v16
    v_mov_b32 v6, s38
    v_mov_b32 v7, s39
    v_lshlrev_b64 v[18:19], v16, v[6:7]
    v_lshlrev_b64 v[18:19], 16, v[18:19]
    v_mov_b32 v16, 0
    v_mov_b32 v17, 0
    s_mov_b64 exec, 15
    ds_write_b128 v11, v[12:15]
    ds_write_b128 v11, v[16:19] offset:16
    s_mov_b64 exec, -1
    v_and_b32 v8, 15, v1
    v_lshrrev_b32 v9, 4, v1
    v_add_u32 v11, 1, v8
    v_and_b32 v12, 3, v11
    v_sub_u32 v11, v11, v12
    v_lshl_add_u32 v11, v9, 3, v11
    v_lshlrev_b32 v11, 1, v11
    v_mov_b32 v13, 4160
    v_mad_u32_u24 v11, v12, v13, v11
    v_add_u32 v20, s36, v11
    v_lshlrev_b32 v11, 1, v8
    v_sub_u32 v11, v11, v9
    v_add_u32 v12, 33, v11
    v_lshrrev_b32 v13, 2, v12
    v_add_u32 v13, s62, v13
    v_and_b32 v13, 3, v13
    v_lshlrev_b32 v13, 4, v13
    v_lshl_add_u32 v12, v12, 6, v13
    v_add_u32 v21, 66560, v12
    v_add_u32 v12, 29, v11
    v_lshrrev_b32 v13, 2, v12
    v_add_u32 v13, s62, v13
    v_and_b32 v13, 3, v13
    v_lshlrev_b32 v13, 4, v13
    v_lshl_add_u32 v12, v12, 6, v13
    v_add_u32 v22, 66560, v12
    v_add_u32 v12, 25, v11
    v_lshrrev_b32 v13, 2, v12
    v_add_u32 v13, s62, v13
    v_and_b32 v13, 3, v13
    v_lshlrev_b32 v13, 4, v13
    v_lshl_add_u32 v12, v12, 6, v13
    v_add_u32 v23, 66560, v12
    v_add_u32 v12, 21, v11
    v_lshrrev_b32 v13, 2, v12
    v_add_u32 v13, s62, v13
    v_and_b32 v13, 3, v13
    v_lshlrev_b32 v13, 4, v13
    v_lshl_add_u32 v12, v12, 6, v13
    v_add_u32 v24, 66560, v12
    v_add_u32 v12, 17, v11
    v_lshrrev_b32 v13, 2, v12
    v_add_u32 v13, s62, v13
    v_and_b32 v13, 3, v13
    v_lshlrev_b32 v13, 4, v13
    v_lshl_add_u32 v12, v12, 6, v13
    v_add_u32 v25, 66560, v12
    v_add_u32 v12, 13, v11
    v_lshrrev_b32 v13, 2, v12
    v_add_u32 v13, s62, v13
    v_and_b32 v13, 3, v13
    v_lshlrev_b32 v13, 4, v13
    v_lshl_add_u32 v12, v12, 6, v13
    v_add_u32 v26, 66560, v12
    v_add_u32 v12, 9, v11
    v_lshrrev_b32 v13, 2, v12
    v_add_u32 v13, s62, v13
    v_and_b32 v13, 3, v13
    v_lshlrev_b32 v13, 4, v13
    v_lshl_add_u32 v12, v12, 6, v13
    v_add_u32 v27, 66560, v12
    v_add_u32 v12, 5, v11
    v_lshrrev_b32 v13, 2, v12
    v_add_u32 v13, s62, v13
    v_and_b32 v13, 3, v13
    v_lshlrev_b32 v13, 4, v13
    v_lshl_add_u32 v12, v12, 6, v13
    v_add_u32 v28, 66560, v12
    s_lshr_b32 s38, s65, 16
    s_and_b32 s39, s65, 0xffff
    s_bitcmp1_b32 s63, 0
    s_cselect_b32 s38, s38, s39
    v_lshlrev_b32 v11, 3, v9
    v_add_u32 v11, v11, v8
    v_sub_u32 v11, 15, v11
    v_and_b32 v12, 1, v11
    v_lshlrev_b32 v12, 4, v12
    v_lshlrev_b32 v12, v12, s38
    v_ashrrev_i32 v11, 1, v11
    v_cmp_eq_u32 vcc, 0, v11
    s_nop 1
    v_cndmask_b32 v30, 0, v12, vcc
    v_cmp_eq_u32 vcc, 1, v11
    s_nop 1
    v_cndmask_b32 v31, 0, v12, vcc
    v_cmp_eq_u32 vcc, 2, v11
    s_nop 1
    v_cndmask_b32 v32, 0, v12, vcc
    v_cmp_eq_u32 vcc, 3, v11
    s_nop 1
    v_cndmask_b32 v33, 0, v12, vcc
    s_lshr_b32 s40, s63, 1
    s_and_b32 s41, s3, 1
    v_lshrrev_b32 v11, 1, v9
    v_lshl_add_u32 v11, v8, 1, v11
    v_and_b32 v12, 1, v9
    v_lshlrev_b32 v12, 4, v12
    v_lshrrev_b32 v13, 2, v11
    v_and_b32 v14, 1, v9
    v_add_u32 v13, v13, v14
    s_lshl_b32 s42, s41, 13
    s_add_u32 s42, s42, 86016
    v_lshl_add_u32 v11, v11, 6, s42
    v_and_b32 v14, 3, v13
    v_lshl_add_u32 v35, v14, 4, v11
    v_add_u32 v13, 2, v13
    v_and_b32 v14, 3, v13
    v_lshl_add_u32 v36, v14, 4, v11
    s_bitcmp1_b32 s62, 1
    s_cselect_b64 vcc, -1, 0
    v_cndmask_b32 v34, v35, v36, vcc
    s_mul_i32 s42, s41, 1179648
    v_lshrrev_b32 v11, 1, v8
    v_mul_u32_u24 v11, 36864, v11
    v_and_b32 v12, 1, v8
    v_lshl_add_u32 v11, v12, 6, v11
    v_lshl_add_u32 v11, v9, 4, v11
    s_and_b32 s46, s40, 3
    s_lshl_b32 s46, s46, 1
    s_bfe_u32 s47, s40, 0x10002
    s_or_b32 s46, s46, s47
    s_andn2_b32 s47, s40, 7
    s_or_b32 s46, s46, s47
    s_lshl_b32 s46, s46, 7
    v_add_u32 v29, s46, v11
    ds_read_b64 v[116:117], v20 offset:0
    ds_read_b64 v[118:119], v20 offset:8
    ds_read_b64 v[120:121], v20 offset:512
    ds_read_b64 v[122:123], v20 offset:520
    ds_read_b64 v[124:125], v20 offset:1024
    ds_read_b64 v[126:127], v20 offset:1032
    ds_read_b64 v[128:129], v20 offset:1536
    ds_read_b64 v[130:131], v20 offset:1544
    ds_read_b64 v[132:133], v20 offset:2048
    ds_read_b64 v[134:135], v20 offset:2056
    ds_read_b64 v[136:137], v20 offset:2560
    ds_read_b64 v[138:139], v20 offset:2568
    ds_read_b64 v[140:141], v20 offset:3072
    ds_read_b64 v[142:143], v20 offset:3080
    ds_read_b64 v[144:145], v20 offset:3584
    ds_read_b64 v[146:147], v20 offset:3592
    s_waitcnt lgkmcnt(0)
    s_barrier
    s_setprio 2
    ds_read_b128 v[148:151], v21 offset:0
    ds_read_b128 v[152:155], v21 offset:2048
    ds_read_b128 v[156:159], v21 offset:4096
    ds_read_b128 v[160:163], v21 offset:6144
    ds_read_b128 v[164:167], v21 offset:8192
    ds_read_b128 v[168:171], v21 offset:10240
    ds_read_b128 v[172:175], v21 offset:12288
    ds_read_b128 v[176:179], v21 offset:14336
    v_mov_b32 v13, 85024
    v_mov_b32 v15, 1
    s_waitcnt lgkmcnt(0)
    v_mfma_f32_16x16x32_bf16 v[84:87], v[30:33], v[148:151], 0
    ds_read_b128 v[212:215], v22 offset:0
    v_mfma_f32_16x16x32_bf16 v[88:91], v[30:33], v[152:155], 0
    ds_read_b64 v[180:181], v20 offset:64
    v_mfma_f32_16x16x32_bf16 v[92:95], v[30:33], v[156:159], 0
    ds_read_b64 v[182:183], v20 offset:72
    v_mfma_f32_16x16x32_bf16 v[96:99], v[30:33], v[160:163], 0
    ds_read_b128 v[216:219], v22 offset:2048
    v_mfma_f32_16x16x32_bf16 v[100:103], v[30:33], v[164:167], 0
    ds_read_b64 v[184:185], v20 offset:576
    v_mfma_f32_16x16x32_bf16 v[104:107], v[30:33], v[168:171], 0
    ds_read_b64 v[186:187], v20 offset:584
    v_mfma_f32_16x16x32_bf16 v[108:111], v[30:33], v[172:175], 0
    ds_read_b128 v[220:223], v22 offset:4096
    v_mfma_f32_16x16x32_bf16 v[112:115], v[30:33], v[176:179], 0
    ds_read_b64 v[188:189], v20 offset:1088
    v_mfma_f32_16x16x32_bf16 v[84:87], v[116:119], v[148:151], v[84:87]
    ds_read_b64 v[190:191], v20 offset:1096
    v_mfma_f32_16x16x32_bf16 v[88:91], v[116:119], v[152:155], v[88:91]
    ds_read_b128 v[224:227], v22 offset:6144
    v_mfma_f32_16x16x32_bf16 v[92:95], v[116:119], v[156:159], v[92:95]
    ds_read_b64 v[192:193], v20 offset:1600
    v_mfma_f32_16x16x32_bf16 v[96:99], v[116:119], v[160:163], v[96:99]
    ds_read_b64 v[194:195], v20 offset:1608
    v_mfma_f32_16x16x32_bf16 v[100:103], v[116:119], v[164:167], v[100:103]
    ds_read_b128 v[228:231], v22 offset:8192
    v_mfma_f32_16x16x32_bf16 v[104:107], v[116:119], v[168:171], v[104:107]
    ds_read_b64 v[196:197], v20 offset:2112
    v_mfma_f32_16x16x32_bf16 v[108:111], v[116:119], v[172:175], v[108:111]
    ds_read_b64 v[198:199], v20 offset:2120
    v_mfma_f32_16x16x32_bf16 v[112:115], v[116:119], v[176:179], v[112:115]
    ds_read_b128 v[232:235], v22 offset:10240
    v_mfma_f32_16x16x32_bf16 v[88:91], v[120:123], v[148:151], v[88:91]
    ds_read_b64 v[200:201], v20 offset:2624
    v_mfma_f32_16x16x32_bf16 v[92:95], v[120:123], v[152:155], v[92:95]
    ds_read_b64 v[202:203], v20 offset:2632
    v_mfma_f32_16x16x32_bf16 v[96:99], v[120:123], v[156:159], v[96:99]
    ds_read_b128 v[236:239], v22 offset:12288
    v_mfma_f32_16x16x32_bf16 v[100:103], v[120:123], v[160:163], v[100:103]
    ds_read_b64 v[204:205], v20 offset:3136
    v_mfma_f32_16x16x32_bf16 v[104:107], v[120:123], v[164:167], v[104:107]
    ds_read_b64 v[206:207], v20 offset:3144
    v_mfma_f32_16x16x32_bf16 v[108:111], v[120:123], v[168:171], v[108:111]
    ds_read_b128 v[240:243], v22 offset:14336
    v_mfma_f32_16x16x32_bf16 v[112:115], v[120:123], v[172:175], v[112:115]
    ds_read_b64 v[208:209], v20 offset:3648
    v_mfma_f32_16x16x32_bf16 v[92:95], v[124:127], v[148:151], v[92:95]
    ds_read_b64 v[210:211], v20 offset:3656
    v_mfma_f32_16x16x32_bf16 v[96:99], v[124:127], v[152:155], v[96:99]
    v_mfma_f32_16x16x32_bf16 v[100:103], v[124:127], v[156:159], v[100:103]
    v_mfma_f32_16x16x32_bf16 v[104:107], v[124:127], v[160:163], v[104:107]
    v_mfma_f32_16x16x32_bf16 v[108:111], v[124:127], v[164:167], v[108:111]
    v_mfma_f32_16x16x32_bf16 v[112:115], v[124:127], v[168:171], v[112:115]
    v_mfma_f32_16x16x32_bf16 v[96:99], v[128:131], v[148:151], v[96:99]
    v_mfma_f32_16x16x32_bf16 v[100:103], v[128:131], v[152:155], v[100:103]
    v_mfma_f32_16x16x32_bf16 v[104:107], v[128:131], v[156:159], v[104:107]
    v_mfma_f32_16x16x32_bf16 v[108:111], v[128:131], v[160:163], v[108:111]
    v_mfma_f32_16x16x32_bf16 v[112:115], v[128:131], v[164:167], v[112:115]
    v_mfma_f32_16x16x32_bf16 v[100:103], v[132:135], v[148:151], v[100:103]
    v_mfma_f32_16x16x32_bf16 v[104:107], v[132:135], v[152:155], v[104:107]
    v_mfma_f32_16x16x32_bf16 v[108:111], v[132:135], v[156:159], v[108:111]
    v_mfma_f32_16x16x32_bf16 v[112:115], v[132:135], v[160:163], v[112:115]
    v_mfma_f32_16x16x32_bf16 v[104:107], v[136:139], v[148:151], v[104:107]
    v_mfma_f32_16x16x32_bf16 v[108:111], v[136:139], v[152:155], v[108:111]
    v_mfma_f32_16x16x32_bf16 v[112:115], v[136:139], v[156:159], v[112:115]
    v_mfma_f32_16x16x32_bf16 v[108:111], v[140:143], v[148:151], v[108:111]
    v_mfma_f32_16x16x32_bf16 v[112:115], v[140:143], v[152:155], v[112:115]
    v_mfma_f32_16x16x32_bf16 v[112:115], v[144:147], v[148:151], v[112:115]
    s_waitcnt lgkmcnt(0)
    v_mfma_f32_16x16x32_bf16 v[84:87], v[180:183], v[212:215], v[84:87]
    ds_read_b128 v[148:151], v23 offset:0
    v_mfma_f32_16x16x32_bf16 v[88:91], v[180:183], v[216:219], v[88:91]
    ds_read_b64 v[116:117], v20 offset:128
    v_mfma_f32_16x16x32_bf16 v[92:95], v[180:183], v[220:223], v[92:95]
    ds_read_b64 v[118:119], v20 offset:136
    v_mfma_f32_16x16x32_bf16 v[96:99], v[180:183], v[224:227], v[96:99]
    ds_read_b128 v[152:155], v23 offset:2048
    v_mfma_f32_16x16x32_bf16 v[100:103], v[180:183], v[228:231], v[100:103]
    ds_read_b64 v[120:121], v20 offset:640
    v_mfma_f32_16x16x32_bf16 v[104:107], v[180:183], v[232:235], v[104:107]
    ds_read_b64 v[122:123], v20 offset:648
    v_mfma_f32_16x16x32_bf16 v[108:111], v[180:183], v[236:239], v[108:111]
    ds_read_b128 v[156:159], v23 offset:4096
    v_mfma_f32_16x16x32_bf16 v[112:115], v[180:183], v[240:243], v[112:115]
    ds_read_b64 v[124:125], v20 offset:1152
    v_mfma_f32_16x16x32_bf16 v[88:91], v[184:187], v[212:215], v[88:91]
    ds_read_b64 v[126:127], v20 offset:1160
    v_mfma_f32_16x16x32_bf16 v[92:95], v[184:187], v[216:219], v[92:95]
    ds_read_b128 v[160:163], v23 offset:6144
    v_mfma_f32_16x16x32_bf16 v[96:99], v[184:187], v[220:223], v[96:99]
    ds_read_b64 v[128:129], v20 offset:1664
    v_mfma_f32_16x16x32_bf16 v[100:103], v[184:187], v[224:227], v[100:103]
    ds_read_b64 v[130:131], v20 offset:1672
    v_mfma_f32_16x16x32_bf16 v[104:107], v[184:187], v[228:231], v[104:107]
    ds_read_b128 v[164:167], v23 offset:8192
    v_mfma_f32_16x16x32_bf16 v[108:111], v[184:187], v[232:235], v[108:111]
    ds_read_b64 v[132:133], v20 offset:2176
    v_mfma_f32_16x16x32_bf16 v[112:115], v[184:187], v[236:239], v[112:115]
    ds_read_b64 v[134:135], v20 offset:2184
    v_mfma_f32_16x16x32_bf16 v[92:95], v[188:191], v[212:215], v[92:95]
    ds_read_b128 v[168:171], v23 offset:10240
    v_mfma_f32_16x16x32_bf16 v[96:99], v[188:191], v[216:219], v[96:99]
    ds_read_b64 v[136:137], v20 offset:2688
    v_mfma_f32_16x16x32_bf16 v[100:103], v[188:191], v[220:223], v[100:103]
    ds_read_b64 v[138:139], v20 offset:2696
    v_mfma_f32_16x16x32_bf16 v[104:107], v[188:191], v[224:227], v[104:107]
    ds_read_b128 v[172:175], v23 offset:12288
    v_mfma_f32_16x16x32_bf16 v[108:111], v[188:191], v[228:231], v[108:111]
    ds_read_b64 v[140:141], v20 offset:3200
    v_mfma_f32_16x16x32_bf16 v[112:115], v[188:191], v[232:235], v[112:115]
    ds_read_b64 v[142:143], v20 offset:3208
    v_mfma_f32_16x16x32_bf16 v[96:99], v[192:195], v[212:215], v[96:99]
    ds_read_b128 v[176:179], v23 offset:14336
    v_mfma_f32_16x16x32_bf16 v[100:103], v[192:195], v[216:219], v[100:103]
    ds_read_b64 v[144:145], v20 offset:3712
    v_mfma_f32_16x16x32_bf16 v[104:107], v[192:195], v[220:223], v[104:107]
    ds_read_b64 v[146:147], v20 offset:3720
    v_mfma_f32_16x16x32_bf16 v[108:111], v[192:195], v[224:227], v[108:111]
    v_mfma_f32_16x16x32_bf16 v[112:115], v[192:195], v[228:231], v[112:115]
    v_mfma_f32_16x16x32_bf16 v[100:103], v[196:199], v[212:215], v[100:103]
    v_mfma_f32_16x16x32_bf16 v[104:107], v[196:199], v[216:219], v[104:107]
    v_mfma_f32_16x16x32_bf16 v[108:111], v[196:199], v[220:223], v[108:111]
    v_mfma_f32_16x16x32_bf16 v[112:115], v[196:199], v[224:227], v[112:115]
    v_mfma_f32_16x16x32_bf16 v[104:107], v[200:203], v[212:215], v[104:107]
    v_mfma_f32_16x16x32_bf16 v[108:111], v[200:203], v[216:219], v[108:111]
    v_mfma_f32_16x16x32_bf16 v[112:115], v[200:203], v[220:223], v[112:115]
    v_mfma_f32_16x16x32_bf16 v[108:111], v[204:207], v[212:215], v[108:111]
    v_mfma_f32_16x16x32_bf16 v[112:115], v[204:207], v[216:219], v[112:115]
    v_mfma_f32_16x16x32_bf16 v[112:115], v[208:211], v[212:215], v[112:115]
    s_waitcnt lgkmcnt(0)
    v_mfma_f32_16x16x32_bf16 v[84:87], v[116:119], v[148:151], v[84:87]
    ds_read_b128 v[212:215], v24 offset:0
    v_mfma_f32_16x16x32_bf16 v[88:91], v[116:119], v[152:155], v[88:91]
    ds_read_b64 v[180:181], v20 offset:192
    v_mfma_f32_16x16x32_bf16 v[92:95], v[116:119], v[156:159], v[92:95]
    ds_read_b64 v[182:183], v20 offset:200
    v_mfma_f32_16x16x32_bf16 v[96:99], v[116:119], v[160:163], v[96:99]
    ds_read_b128 v[216:219], v24 offset:2048
    v_mfma_f32_16x16x32_bf16 v[100:103], v[116:119], v[164:167], v[100:103]
    ds_read_b64 v[184:185], v20 offset:704
    v_mfma_f32_16x16x32_bf16 v[104:107], v[116:119], v[168:171], v[104:107]
    ds_read_b64 v[186:187], v20 offset:712
    v_mfma_f32_16x16x32_bf16 v[108:111], v[116:119], v[172:175], v[108:111]
    ds_read_b128 v[220:223], v24 offset:4096
    v_mfma_f32_16x16x32_bf16 v[112:115], v[116:119], v[176:179], v[112:115]
    ds_read_b64 v[188:189], v20 offset:1216
    v_mfma_f32_16x16x32_bf16 v[88:91], v[120:123], v[148:151], v[88:91]
    ds_read_b64 v[190:191], v20 offset:1224
    v_mfma_f32_16x16x32_bf16 v[92:95], v[120:123], v[152:155], v[92:95]
    ds_read_b128 v[224:227], v24 offset:6144
    v_mfma_f32_16x16x32_bf16 v[96:99], v[120:123], v[156:159], v[96:99]
    ds_read_b64 v[192:193], v20 offset:1728
    v_mfma_f32_16x16x32_bf16 v[100:103], v[120:123], v[160:163], v[100:103]
    ds_read_b64 v[194:195], v20 offset:1736
    v_mfma_f32_16x16x32_bf16 v[104:107], v[120:123], v[164:167], v[104:107]
    ds_read_b128 v[228:231], v24 offset:8192
    v_mfma_f32_16x16x32_bf16 v[108:111], v[120:123], v[168:171], v[108:111]
    ds_read_b64 v[196:197], v20 offset:2240
    v_mfma_f32_16x16x32_bf16 v[112:115], v[120:123], v[172:175], v[112:115]
    ds_read_b64 v[198:199], v20 offset:2248
    v_mfma_f32_16x16x32_bf16 v[92:95], v[124:127], v[148:151], v[92:95]
    ds_read_b128 v[232:235], v24 offset:10240
    v_mfma_f32_16x16x32_bf16 v[96:99], v[124:127], v[152:155], v[96:99]
    ds_read_b64 v[200:201], v20 offset:2752
    v_mfma_f32_16x16x32_bf16 v[100:103], v[124:127], v[156:159], v[100:103]
    ds_read_b64 v[202:203], v20 offset:2760
    v_mfma_f32_16x16x32_bf16 v[104:107], v[124:127], v[160:163], v[104:107]
    ds_read_b128 v[236:239], v24 offset:12288
    v_mfma_f32_16x16x32_bf16 v[108:111], v[124:127], v[164:167], v[108:111]
    ds_read_b64 v[204:205], v20 offset:3264
    v_mfma_f32_16x16x32_bf16 v[112:115], v[124:127], v[168:171], v[112:115]
    ds_read_b64 v[206:207], v20 offset:3272
    v_mfma_f32_16x16x32_bf16 v[96:99], v[128:131], v[148:151], v[96:99]
    ds_read_b128 v[240:243], v24 offset:14336
    v_mfma_f32_16x16x32_bf16 v[100:103], v[128:131], v[152:155], v[100:103]
    ds_read_b64 v[208:209], v20 offset:3776
    v_mfma_f32_16x16x32_bf16 v[104:107], v[128:131], v[156:159], v[104:107]
    ds_read_b64 v[210:211], v20 offset:3784
    v_mfma_f32_16x16x32_bf16 v[108:111], v[128:131], v[160:163], v[108:111]
    v_mfma_f32_16x16x32_bf16 v[112:115], v[128:131], v[164:167], v[112:115]
    v_mfma_f32_16x16x32_bf16 v[100:103], v[132:135], v[148:151], v[100:103]
    v_mfma_f32_16x16x32_bf16 v[104:107], v[132:135], v[152:155], v[104:107]
    v_mfma_f32_16x16x32_bf16 v[108:111], v[132:135], v[156:159], v[108:111]
    v_mfma_f32_16x16x32_bf16 v[112:115], v[132:135], v[160:163], v[112:115]
    v_mfma_f32_16x16x32_bf16 v[104:107], v[136:139], v[148:151], v[104:107]
    v_mfma_f32_16x16x32_bf16 v[108:111], v[136:139], v[152:155], v[108:111]
    v_mfma_f32_16x16x32_bf16 v[112:115], v[136:139], v[156:159], v[112:115]
    v_mfma_f32_16x16x32_bf16 v[108:111], v[140:143], v[148:151], v[108:111]
    v_mfma_f32_16x16x32_bf16 v[112:115], v[140:143], v[152:155], v[112:115]
    v_mfma_f32_16x16x32_bf16 v[112:115], v[144:147], v[148:151], v[112:115]
    s_waitcnt lgkmcnt(0)
    v_mfma_f32_16x16x32_bf16 v[84:87], v[180:183], v[212:215], v[84:87]
    ds_read_b128 v[148:151], v25 offset:0
    v_mfma_f32_16x16x32_bf16 v[88:91], v[180:183], v[216:219], v[88:91]
    ds_read_b64 v[116:117], v20 offset:256
    v_mfma_f32_16x16x32_bf16 v[92:95], v[180:183], v[220:223], v[92:95]
    ds_read_b64 v[118:119], v20 offset:264
    v_mfma_f32_16x16x32_bf16 v[96:99], v[180:183], v[224:227], v[96:99]
    ds_read_b128 v[152:155], v25 offset:2048
    v_mfma_f32_16x16x32_bf16 v[100:103], v[180:183], v[228:231], v[100:103]
    ds_read_b64 v[120:121], v20 offset:768
    v_mfma_f32_16x16x32_bf16 v[104:107], v[180:183], v[232:235], v[104:107]
    ds_read_b64 v[122:123], v20 offset:776
    v_mfma_f32_16x16x32_bf16 v[108:111], v[180:183], v[236:239], v[108:111]
    ds_read_b128 v[156:159], v25 offset:4096
    v_mfma_f32_16x16x32_bf16 v[112:115], v[180:183], v[240:243], v[112:115]
    ds_read_b64 v[124:125], v20 offset:1280
    v_mfma_f32_16x16x32_bf16 v[88:91], v[184:187], v[212:215], v[88:91]
    ds_read_b64 v[126:127], v20 offset:1288
    v_mfma_f32_16x16x32_bf16 v[92:95], v[184:187], v[216:219], v[92:95]
    ds_read_b128 v[160:163], v25 offset:6144
    v_mfma_f32_16x16x32_bf16 v[96:99], v[184:187], v[220:223], v[96:99]
    ds_read_b64 v[128:129], v20 offset:1792
    v_mfma_f32_16x16x32_bf16 v[100:103], v[184:187], v[224:227], v[100:103]
    ds_read_b64 v[130:131], v20 offset:1800
    v_mfma_f32_16x16x32_bf16 v[104:107], v[184:187], v[228:231], v[104:107]
    ds_read_b128 v[164:167], v25 offset:8192
    v_mfma_f32_16x16x32_bf16 v[108:111], v[184:187], v[232:235], v[108:111]
    ds_read_b64 v[132:133], v20 offset:2304
    v_mfma_f32_16x16x32_bf16 v[112:115], v[184:187], v[236:239], v[112:115]
    ds_read_b64 v[134:135], v20 offset:2312
    v_mfma_f32_16x16x32_bf16 v[92:95], v[188:191], v[212:215], v[92:95]
    ds_read_b128 v[168:171], v25 offset:10240
    v_mfma_f32_16x16x32_bf16 v[96:99], v[188:191], v[216:219], v[96:99]
    ds_read_b64 v[136:137], v20 offset:2816
    v_mfma_f32_16x16x32_bf16 v[100:103], v[188:191], v[220:223], v[100:103]
    ds_read_b64 v[138:139], v20 offset:2824
    v_mfma_f32_16x16x32_bf16 v[104:107], v[188:191], v[224:227], v[104:107]
    ds_read_b128 v[172:175], v25 offset:12288
    v_mfma_f32_16x16x32_bf16 v[108:111], v[188:191], v[228:231], v[108:111]
    ds_read_b64 v[140:141], v20 offset:3328
    v_mfma_f32_16x16x32_bf16 v[112:115], v[188:191], v[232:235], v[112:115]
    ds_read_b64 v[142:143], v20 offset:3336
    v_mfma_f32_16x16x32_bf16 v[96:99], v[192:195], v[212:215], v[96:99]
    ds_read_b128 v[176:179], v25 offset:14336
    v_mfma_f32_16x16x32_bf16 v[100:103], v[192:195], v[216:219], v[100:103]
    ds_read_b64 v[144:145], v20 offset:3840
    v_mfma_f32_16x16x32_bf16 v[104:107], v[192:195], v[220:223], v[104:107]
    ds_read_b64 v[146:147], v20 offset:3848
    v_mfma_f32_16x16x32_bf16 v[108:111], v[192:195], v[224:227], v[108:111]
    v_mfma_f32_16x16x32_bf16 v[112:115], v[192:195], v[228:231], v[112:115]
    v_mfma_f32_16x16x32_bf16 v[100:103], v[196:199], v[212:215], v[100:103]
    v_mfma_f32_16x16x32_bf16 v[104:107], v[196:199], v[216:219], v[104:107]
    v_mfma_f32_16x16x32_bf16 v[108:111], v[196:199], v[220:223], v[108:111]
    v_mfma_f32_16x16x32_bf16 v[112:115], v[196:199], v[224:227], v[112:115]
    v_mfma_f32_16x16x32_bf16 v[104:107], v[200:203], v[212:215], v[104:107]
    v_mfma_f32_16x16x32_bf16 v[108:111], v[200:203], v[216:219], v[108:111]
    v_mfma_f32_16x16x32_bf16 v[112:115], v[200:203], v[220:223], v[112:115]
    v_mfma_f32_16x16x32_bf16 v[108:111], v[204:207], v[212:215], v[108:111]
    v_mfma_f32_16x16x32_bf16 v[112:115], v[204:207], v[216:219], v[112:115]
    v_mfma_f32_16x16x32_bf16 v[112:115], v[208:211], v[212:215], v[112:115]
    s_waitcnt lgkmcnt(0)
    v_mfma_f32_16x16x32_bf16 v[84:87], v[116:119], v[148:151], v[84:87]
    ds_read_b128 v[212:215], v26 offset:0
    v_mfma_f32_16x16x32_bf16 v[88:91], v[116:119], v[152:155], v[88:91]
    ds_read_b64 v[180:181], v20 offset:320
    v_mfma_f32_16x16x32_bf16 v[92:95], v[116:119], v[156:159], v[92:95]
    ds_read_b64 v[182:183], v20 offset:328
    v_mfma_f32_16x16x32_bf16 v[96:99], v[116:119], v[160:163], v[96:99]
    ds_read_b128 v[216:219], v26 offset:2048
    v_mfma_f32_16x16x32_bf16 v[100:103], v[116:119], v[164:167], v[100:103]
    ds_read_b64 v[184:185], v20 offset:832
    v_mfma_f32_16x16x32_bf16 v[104:107], v[116:119], v[168:171], v[104:107]
    ds_read_b64 v[186:187], v20 offset:840
    v_mfma_f32_16x16x32_bf16 v[108:111], v[116:119], v[172:175], v[108:111]
    ds_read_b128 v[220:223], v26 offset:4096
    v_mfma_f32_16x16x32_bf16 v[112:115], v[116:119], v[176:179], v[112:115]
    ds_read_b64 v[188:189], v20 offset:1344
    v_mfma_f32_16x16x32_bf16 v[88:91], v[120:123], v[148:151], v[88:91]
    ds_read_b64 v[190:191], v20 offset:1352
    v_mfma_f32_16x16x32_bf16 v[92:95], v[120:123], v[152:155], v[92:95]
    ds_read_b128 v[224:227], v26 offset:6144
    v_mfma_f32_16x16x32_bf16 v[96:99], v[120:123], v[156:159], v[96:99]
    ds_read_b64 v[192:193], v20 offset:1856
    v_mfma_f32_16x16x32_bf16 v[100:103], v[120:123], v[160:163], v[100:103]
    ds_read_b64 v[194:195], v20 offset:1864
    v_mfma_f32_16x16x32_bf16 v[104:107], v[120:123], v[164:167], v[104:107]
    ds_read_b128 v[228:231], v26 offset:8192
    v_mfma_f32_16x16x32_bf16 v[108:111], v[120:123], v[168:171], v[108:111]
    ds_read_b64 v[196:197], v20 offset:2368
    v_mfma_f32_16x16x32_bf16 v[112:115], v[120:123], v[172:175], v[112:115]
    ds_read_b64 v[198:199], v20 offset:2376
    v_mfma_f32_16x16x32_bf16 v[92:95], v[124:127], v[148:151], v[92:95]
    ds_read_b128 v[232:235], v26 offset:10240
    v_mfma_f32_16x16x32_bf16 v[96:99], v[124:127], v[152:155], v[96:99]
    ds_read_b64 v[200:201], v20 offset:2880
    v_mfma_f32_16x16x32_bf16 v[100:103], v[124:127], v[156:159], v[100:103]
    ds_read_b64 v[202:203], v20 offset:2888
    v_mfma_f32_16x16x32_bf16 v[104:107], v[124:127], v[160:163], v[104:107]
    ds_read_b128 v[236:239], v26 offset:12288
    v_mfma_f32_16x16x32_bf16 v[108:111], v[124:127], v[164:167], v[108:111]
    ds_read_b64 v[204:205], v20 offset:3392
    v_mfma_f32_16x16x32_bf16 v[112:115], v[124:127], v[168:171], v[112:115]
    ds_read_b64 v[206:207], v20 offset:3400
    v_mfma_f32_16x16x32_bf16 v[96:99], v[128:131], v[148:151], v[96:99]
    ds_read_b128 v[240:243], v26 offset:14336
    v_mfma_f32_16x16x32_bf16 v[100:103], v[128:131], v[152:155], v[100:103]
    ds_read_b64 v[208:209], v20 offset:3904
    v_mfma_f32_16x16x32_bf16 v[104:107], v[128:131], v[156:159], v[104:107]
    ds_read_b64 v[210:211], v20 offset:3912
    v_mfma_f32_16x16x32_bf16 v[108:111], v[128:131], v[160:163], v[108:111]
    v_mfma_f32_16x16x32_bf16 v[112:115], v[128:131], v[164:167], v[112:115]
    v_mfma_f32_16x16x32_bf16 v[100:103], v[132:135], v[148:151], v[100:103]
    v_mfma_f32_16x16x32_bf16 v[104:107], v[132:135], v[152:155], v[104:107]
    v_mfma_f32_16x16x32_bf16 v[108:111], v[132:135], v[156:159], v[108:111]
    v_mfma_f32_16x16x32_bf16 v[112:115], v[132:135], v[160:163], v[112:115]
    v_mfma_f32_16x16x32_bf16 v[104:107], v[136:139], v[148:151], v[104:107]
    v_mfma_f32_16x16x32_bf16 v[108:111], v[136:139], v[152:155], v[108:111]
    v_mfma_f32_16x16x32_bf16 v[112:115], v[136:139], v[156:159], v[112:115]
    v_mfma_f32_16x16x32_bf16 v[108:111], v[140:143], v[148:151], v[108:111]
    v_mfma_f32_16x16x32_bf16 v[112:115], v[140:143], v[152:155], v[112:115]
    v_mfma_f32_16x16x32_bf16 v[112:115], v[144:147], v[148:151], v[112:115]
    s_waitcnt lgkmcnt(0)
    v_mfma_f32_16x16x32_bf16 v[84:87], v[180:183], v[212:215], v[84:87]
    ds_read_b128 v[148:151], v27 offset:0
    v_mfma_f32_16x16x32_bf16 v[88:91], v[180:183], v[216:219], v[88:91]
    ds_read_b64 v[116:117], v20 offset:384
    v_mfma_f32_16x16x32_bf16 v[92:95], v[180:183], v[220:223], v[92:95]
    ds_read_b64 v[118:119], v20 offset:392
    v_mfma_f32_16x16x32_bf16 v[96:99], v[180:183], v[224:227], v[96:99]
    ds_read_b128 v[152:155], v27 offset:2048
    v_mfma_f32_16x16x32_bf16 v[100:103], v[180:183], v[228:231], v[100:103]
    ds_read_b64 v[120:121], v20 offset:896
    v_mfma_f32_16x16x32_bf16 v[104:107], v[180:183], v[232:235], v[104:107]
    ds_read_b64 v[122:123], v20 offset:904
    v_mfma_f32_16x16x32_bf16 v[108:111], v[180:183], v[236:239], v[108:111]
    ds_read_b128 v[156:159], v27 offset:4096
    v_mfma_f32_16x16x32_bf16 v[112:115], v[180:183], v[240:243], v[112:115]
    ds_read_b64 v[124:125], v20 offset:1408
    v_mfma_f32_16x16x32_bf16 v[88:91], v[184:187], v[212:215], v[88:91]
    ds_read_b64 v[126:127], v20 offset:1416
    v_mfma_f32_16x16x32_bf16 v[92:95], v[184:187], v[216:219], v[92:95]
    ds_read_b128 v[160:163], v27 offset:6144
    v_mfma_f32_16x16x32_bf16 v[96:99], v[184:187], v[220:223], v[96:99]
    ds_read_b64 v[128:129], v20 offset:1920
    v_mfma_f32_16x16x32_bf16 v[100:103], v[184:187], v[224:227], v[100:103]
    ds_read_b64 v[130:131], v20 offset:1928
    v_mfma_f32_16x16x32_bf16 v[104:107], v[184:187], v[228:231], v[104:107]
    ds_read_b128 v[164:167], v27 offset:8192
    v_mfma_f32_16x16x32_bf16 v[108:111], v[184:187], v[232:235], v[108:111]
    ds_read_b64 v[132:133], v20 offset:2432
    v_mfma_f32_16x16x32_bf16 v[112:115], v[184:187], v[236:239], v[112:115]
    ds_read_b64 v[134:135], v20 offset:2440
    v_mfma_f32_16x16x32_bf16 v[92:95], v[188:191], v[212:215], v[92:95]
    ds_read_b128 v[168:171], v27 offset:10240
    v_mfma_f32_16x16x32_bf16 v[96:99], v[188:191], v[216:219], v[96:99]
    ds_read_b64 v[136:137], v20 offset:2944
    v_mfma_f32_16x16x32_bf16 v[100:103], v[188:191], v[220:223], v[100:103]
    ds_read_b64 v[138:139], v20 offset:2952
    v_mfma_f32_16x16x32_bf16 v[104:107], v[188:191], v[224:227], v[104:107]
    ds_read_b128 v[172:175], v27 offset:12288
    v_mfma_f32_16x16x32_bf16 v[108:111], v[188:191], v[228:231], v[108:111]
    ds_read_b64 v[140:141], v20 offset:3456
    v_mfma_f32_16x16x32_bf16 v[112:115], v[188:191], v[232:235], v[112:115]
    ds_read_b64 v[142:143], v20 offset:3464
    v_mfma_f32_16x16x32_bf16 v[96:99], v[192:195], v[212:215], v[96:99]
    ds_read_b128 v[176:179], v27 offset:14336
    v_mfma_f32_16x16x32_bf16 v[100:103], v[192:195], v[216:219], v[100:103]
    ds_read_b64 v[144:145], v20 offset:3968
    v_mfma_f32_16x16x32_bf16 v[104:107], v[192:195], v[220:223], v[104:107]
    ds_read_b64 v[146:147], v20 offset:3976
    v_mfma_f32_16x16x32_bf16 v[108:111], v[192:195], v[224:227], v[108:111]
    v_mfma_f32_16x16x32_bf16 v[112:115], v[192:195], v[228:231], v[112:115]
    v_mfma_f32_16x16x32_bf16 v[100:103], v[196:199], v[212:215], v[100:103]
    v_mfma_f32_16x16x32_bf16 v[104:107], v[196:199], v[216:219], v[104:107]
    v_mfma_f32_16x16x32_bf16 v[108:111], v[196:199], v[220:223], v[108:111]
    v_mfma_f32_16x16x32_bf16 v[112:115], v[196:199], v[224:227], v[112:115]
    v_mfma_f32_16x16x32_bf16 v[104:107], v[200:203], v[212:215], v[104:107]
    v_mfma_f32_16x16x32_bf16 v[108:111], v[200:203], v[216:219], v[108:111]
    v_mfma_f32_16x16x32_bf16 v[112:115], v[200:203], v[220:223], v[112:115]
    v_mfma_f32_16x16x32_bf16 v[108:111], v[204:207], v[212:215], v[108:111]
    v_mfma_f32_16x16x32_bf16 v[112:115], v[204:207], v[216:219], v[112:115]
    v_mfma_f32_16x16x32_bf16 v[112:115], v[208:211], v[212:215], v[112:115]
    s_waitcnt lgkmcnt(0)
    v_mfma_f32_16x16x32_bf16 v[84:87], v[116:119], v[148:151], v[84:87]
    ds_read_b128 v[212:215], v28 offset:0
    v_mfma_f32_16x16x32_bf16 v[88:91], v[116:119], v[152:155], v[88:91]
    ds_read_b64 v[180:181], v20 offset:448
    v_mfma_f32_16x16x32_bf16 v[92:95], v[116:119], v[156:159], v[92:95]
    ds_read_b64 v[182:183], v20 offset:456
    v_mfma_f32_16x16x32_bf16 v[96:99], v[116:119], v[160:163], v[96:99]
    ds_read_b128 v[216:219], v28 offset:2048
    v_mfma_f32_16x16x32_bf16 v[100:103], v[116:119], v[164:167], v[100:103]
    ds_read_b64 v[184:185], v20 offset:960
    v_mfma_f32_16x16x32_bf16 v[104:107], v[116:119], v[168:171], v[104:107]
    ds_read_b64 v[186:187], v20 offset:968
    v_mfma_f32_16x16x32_bf16 v[108:111], v[116:119], v[172:175], v[108:111]
    ds_read_b128 v[220:223], v28 offset:4096
    v_mfma_f32_16x16x32_bf16 v[112:115], v[116:119], v[176:179], v[112:115]
    ds_read_b64 v[188:189], v20 offset:1472
    v_mfma_f32_16x16x32_bf16 v[88:91], v[120:123], v[148:151], v[88:91]
    ds_read_b64 v[190:191], v20 offset:1480
    v_mfma_f32_16x16x32_bf16 v[92:95], v[120:123], v[152:155], v[92:95]
    ds_read_b128 v[224:227], v28 offset:6144
    v_mfma_f32_16x16x32_bf16 v[96:99], v[120:123], v[156:159], v[96:99]
    ds_read_b64 v[192:193], v20 offset:1984
    v_mfma_f32_16x16x32_bf16 v[100:103], v[120:123], v[160:163], v[100:103]
    ds_read_b64 v[194:195], v20 offset:1992
    v_mfma_f32_16x16x32_bf16 v[104:107], v[120:123], v[164:167], v[104:107]
    ds_read_b128 v[228:231], v28 offset:8192
    v_mfma_f32_16x16x32_bf16 v[108:111], v[120:123], v[168:171], v[108:111]
    ds_read_b64 v[196:197], v20 offset:2496
    v_mfma_f32_16x16x32_bf16 v[112:115], v[120:123], v[172:175], v[112:115]
    ds_read_b64 v[198:199], v20 offset:2504
    v_mfma_f32_16x16x32_bf16 v[92:95], v[124:127], v[148:151], v[92:95]
    ds_read_b128 v[232:235], v28 offset:10240
    v_mfma_f32_16x16x32_bf16 v[96:99], v[124:127], v[152:155], v[96:99]
    ds_read_b64 v[200:201], v20 offset:3008
    v_mfma_f32_16x16x32_bf16 v[100:103], v[124:127], v[156:159], v[100:103]
    ds_read_b64 v[202:203], v20 offset:3016
    v_mfma_f32_16x16x32_bf16 v[104:107], v[124:127], v[160:163], v[104:107]
    ds_read_b128 v[236:239], v28 offset:12288
    v_mfma_f32_16x16x32_bf16 v[108:111], v[124:127], v[164:167], v[108:111]
    ds_read_b64 v[204:205], v20 offset:3520
    v_mfma_f32_16x16x32_bf16 v[112:115], v[124:127], v[168:171], v[112:115]
    ds_read_b64 v[206:207], v20 offset:3528
    v_mfma_f32_16x16x32_bf16 v[96:99], v[128:131], v[148:151], v[96:99]
    ds_read_b128 v[240:243], v28 offset:14336
    v_mfma_f32_16x16x32_bf16 v[100:103], v[128:131], v[152:155], v[100:103]
    ds_read_b64 v[208:209], v20 offset:4032
    v_mfma_f32_16x16x32_bf16 v[104:107], v[128:131], v[156:159], v[104:107]
    ds_read_b64 v[210:211], v20 offset:4040
    v_mfma_f32_16x16x32_bf16 v[108:111], v[128:131], v[160:163], v[108:111]
    ds_read_b32 v16, v13 offset:8
    v_mfma_f32_16x16x32_bf16 v[112:115], v[128:131], v[164:167], v[112:115]
    v_mfma_f32_16x16x32_bf16 v[100:103], v[132:135], v[148:151], v[100:103]
    v_mfma_f32_16x16x32_bf16 v[104:107], v[132:135], v[152:155], v[104:107]
    v_mfma_f32_16x16x32_bf16 v[108:111], v[132:135], v[156:159], v[108:111]
    v_mfma_f32_16x16x32_bf16 v[112:115], v[132:135], v[160:163], v[112:115]
    v_mfma_f32_16x16x32_bf16 v[104:107], v[136:139], v[148:151], v[104:107]
    v_mfma_f32_16x16x32_bf16 v[108:111], v[136:139], v[152:155], v[108:111]
    v_mfma_f32_16x16x32_bf16 v[112:115], v[136:139], v[156:159], v[112:115]
    v_mfma_f32_16x16x32_bf16 v[108:111], v[140:143], v[148:151], v[108:111]
    v_mfma_f32_16x16x32_bf16 v[112:115], v[140:143], v[152:155], v[112:115]
    v_mfma_f32_16x16x32_bf16 v[112:115], v[144:147], v[148:151], v[112:115]
    s_waitcnt lgkmcnt(0)
LCx0_18:
    v_cmp_gt_u32 vcc, 4, v16
    s_cbranch_vccz LCx0_19
    ds_read_b32 v16, v13 offset:8
    s_waitcnt lgkmcnt(0)
    s_branch LCx0_18
LCx0_19:
    v_mfma_f32_16x16x32_bf16 v[84:87], v[180:183], v[212:215], v[84:87]
    ds_read_b128 v[164:167], v34 offset:0
    v_mfma_f32_16x16x32_bf16 v[88:91], v[180:183], v[216:219], v[88:91]
    ds_read_b128 v[168:171], v34 offset:2048
    v_mfma_f32_16x16x32_bf16 v[92:95], v[180:183], v[220:223], v[92:95]
    ds_read_b128 v[172:175], v34 offset:4096
    v_mfma_f32_16x16x32_bf16 v[96:99], v[180:183], v[224:227], v[96:99]
    ds_read_b128 v[176:179], v34 offset:6144
    v_mfma_f32_16x16x32_bf16 v[100:103], v[180:183], v[228:231], v[100:103]
    ds_read_b128 v[40:43], v35 offset:16384
    v_mfma_f32_16x16x32_bf16 v[104:107], v[180:183], v[232:235], v[104:107]
    ds_read_b128 v[56:59], v36 offset:16384
    v_mfma_f32_16x16x32_bf16 v[108:111], v[180:183], v[236:239], v[108:111]
    ds_read_b128 v[44:47], v35 offset:18432
    v_mfma_f32_16x16x32_bf16 v[112:115], v[180:183], v[240:243], v[112:115]
    ds_read_b128 v[60:63], v36 offset:18432
    v_mfma_f32_16x16x32_bf16 v[88:91], v[184:187], v[212:215], v[88:91]
    ds_read_b128 v[48:51], v35 offset:20480
    v_mfma_f32_16x16x32_bf16 v[92:95], v[184:187], v[216:219], v[92:95]
    ds_read_b128 v[64:67], v36 offset:20480
    v_mfma_f32_16x16x32_bf16 v[96:99], v[184:187], v[220:223], v[96:99]
    ds_read_b128 v[52:55], v35 offset:22528
    v_mfma_f32_16x16x32_bf16 v[100:103], v[184:187], v[224:227], v[100:103]
    ds_read_b128 v[68:71], v36 offset:22528
    v_mfma_f32_16x16x32_bf16 v[104:107], v[184:187], v[228:231], v[104:107]
    v_mfma_f32_16x16x32_bf16 v[108:111], v[184:187], v[232:235], v[108:111]
    v_mfma_f32_16x16x32_bf16 v[112:115], v[184:187], v[236:239], v[112:115]
    v_mfma_f32_16x16x32_bf16 v[92:95], v[188:191], v[212:215], v[92:95]
    v_mfma_f32_16x16x32_bf16 v[96:99], v[188:191], v[216:219], v[96:99]
    v_mfma_f32_16x16x32_bf16 v[100:103], v[188:191], v[220:223], v[100:103]
    v_mfma_f32_16x16x32_bf16 v[104:107], v[188:191], v[224:227], v[104:107]
    v_mfma_f32_16x16x32_bf16 v[108:111], v[188:191], v[228:231], v[108:111]
    v_mfma_f32_16x16x32_bf16 v[112:115], v[188:191], v[232:235], v[112:115]
    v_mfma_f32_16x16x32_bf16 v[96:99], v[192:195], v[212:215], v[96:99]
    v_mfma_f32_16x16x32_bf16 v[100:103], v[192:195], v[216:219], v[100:103]
    v_mfma_f32_16x16x32_bf16 v[104:107], v[192:195], v[220:223], v[104:107]
    v_mfma_f32_16x16x32_bf16 v[108:111], v[192:195], v[224:227], v[108:111]
    v_mfma_f32_16x16x32_bf16 v[112:115], v[192:195], v[228:231], v[112:115]
    v_mfma_f32_16x16x32_bf16 v[100:103], v[196:199], v[212:215], v[100:103]
    v_mfma_f32_16x16x32_bf16 v[104:107], v[196:199], v[216:219], v[104:107]
    v_mfma_f32_16x16x32_bf16 v[108:111], v[196:199], v[220:223], v[108:111]
    v_mfma_f32_16x16x32_bf16 v[112:115], v[196:199], v[224:227], v[112:115]
    v_mfma_f32_16x16x32_bf16 v[104:107], v[200:203], v[212:215], v[104:107]
    v_mfma_f32_16x16x32_bf16 v[108:111], v[200:203], v[216:219], v[108:111]
    v_mfma_f32_16x16x32_bf16 v[112:115], v[200:203], v[220:223], v[112:115]
    v_mfma_f32_16x16x32_bf16 v[108:111], v[204:207], v[212:215], v[108:111]
    v_mfma_f32_16x16x32_bf16 v[112:115], v[204:207], v[216:219], v[112:115]
    v_mfma_f32_16x16x32_bf16 v[112:115], v[208:211], v[212:215], v[112:115]
    v_add_u32 v11, s36, v2
    s_xor_b32 s38, s62, 1
    s_mul_i32 s38, s38, 16640
    v_add_u32 v12, s38, v2
    s_add_u32 s43, s42, 6213632
    s_add_u32 s44, s42, 8572928
    s_lshl_b32 s38, s62, 2
    s_add_u32 s38, s38, 84992
    v_mov_b32 v13, s38
    v_xor_b32 v14, 4, v13
    s_cmp_eq_u32 s41, 1
    s_cbranch_scc1 LCodd_20
    ds_write_b128 v11, v[100:103] offset:0
    ds_write_b128 v11, v[104:107] offset:1024
    ds_write_b128 v11, v[108:111] offset:2048
    ds_write_b128 v11, v[112:115] offset:3072
    ds_write_b32 v13, v15
LCsp_22:
    ds_read_b32 v16, v14
    s_waitcnt lgkmcnt(0)
    v_cmp_eq_u32 vcc, 0, v16
    s_cbranch_vccnz LCsp_22
    ds_read_b128 v[116:119], v12 offset:0
    ds_read_b128 v[120:123], v12 offset:1024
    ds_read_b128 v[124:127], v12 offset:2048
    ds_read_b128 v[128:131], v12 offset:3072
    v_mov_b32 v13, 85024
    s_mov_b64 exec, 1
    ds_add_u32 v13, v15 offset:4
    s_mov_b64 exec, -1
    s_waitcnt lgkmcnt(4)
    v_lshlrev_b32 v132, 16, v164
    v_and_b32 v136, 0xffff0000, v164
    v_lshlrev_b32 v133, 16, v165
    v_and_b32 v137, 0xffff0000, v165
    v_lshlrev_b32 v134, 16, v166
    v_and_b32 v138, 0xffff0000, v166
    v_lshlrev_b32 v135, 16, v167
    v_and_b32 v139, 0xffff0000, v167
    v_pk_fma_f32 v[140:141], v[132:133], v[40:41], v[56:57]
    v_pk_fma_f32 v[142:143], v[134:135], v[42:43], v[58:59]
    v_pk_fma_f32 v[144:145], v[136:137], v[40:41], v[56:57]
    v_pk_fma_f32 v[146:147], v[138:139], v[42:43], v[58:59]
    v_cvt_pk_bf16_f32 v180, v84, v116
    v_cvt_pk_bf16_f32 v181, v85, v117
    v_cvt_pk_bf16_f32 v182, v86, v118
    v_cvt_pk_bf16_f32 v183, v87, v119
    v_pk_fma_f32 v[132:133], v[140:141], v[84:85], v[132:133]
    v_pk_fma_f32 v[134:135], v[142:143], v[86:87], v[134:135]
    v_pk_fma_f32 v[136:137], v[144:145], v[116:117], v[136:137]
    v_pk_fma_f32 v[138:139], v[146:147], v[118:119], v[138:139]
    v_cvt_pk_bf16_f32 v148, v132, v136
    v_cvt_pk_bf16_f32 v149, v133, v137
    v_cvt_pk_bf16_f32 v150, v134, v138
    v_cvt_pk_bf16_f32 v151, v135, v139
    buffer_store_dwordx4 v[148:151], v29, s[20:23], s43 offen sc1
    s_add_u32 s43, s43, 294912
    buffer_store_dwordx4 v[180:183], v29, s[20:23], s44 offen sc1
    s_add_u32 s44, s44, 294912
    s_waitcnt lgkmcnt(3)
    v_lshlrev_b32 v132, 16, v168
    v_and_b32 v136, 0xffff0000, v168
    v_lshlrev_b32 v133, 16, v169
    v_and_b32 v137, 0xffff0000, v169
    v_lshlrev_b32 v134, 16, v170
    v_and_b32 v138, 0xffff0000, v170
    v_lshlrev_b32 v135, 16, v171
    v_and_b32 v139, 0xffff0000, v171
    v_pk_fma_f32 v[140:141], v[132:133], v[44:45], v[60:61]
    v_pk_fma_f32 v[142:143], v[134:135], v[46:47], v[62:63]
    v_pk_fma_f32 v[144:145], v[136:137], v[44:45], v[60:61]
    v_pk_fma_f32 v[146:147], v[138:139], v[46:47], v[62:63]
    v_cvt_pk_bf16_f32 v184, v88, v120
    v_cvt_pk_bf16_f32 v185, v89, v121
    v_cvt_pk_bf16_f32 v186, v90, v122
    v_cvt_pk_bf16_f32 v187, v91, v123
    v_pk_fma_f32 v[132:133], v[140:141], v[88:89], v[132:133]
    v_pk_fma_f32 v[134:135], v[142:143], v[90:91], v[134:135]
    v_pk_fma_f32 v[136:137], v[144:145], v[120:121], v[136:137]
    v_pk_fma_f32 v[138:139], v[146:147], v[122:123], v[138:139]
    v_cvt_pk_bf16_f32 v152, v132, v136
    v_cvt_pk_bf16_f32 v153, v133, v137
    v_cvt_pk_bf16_f32 v154, v134, v138
    v_cvt_pk_bf16_f32 v155, v135, v139
    buffer_store_dwordx4 v[152:155], v29, s[20:23], s43 offen sc1
    s_add_u32 s43, s43, 294912
    buffer_store_dwordx4 v[184:187], v29, s[20:23], s44 offen sc1
    s_add_u32 s44, s44, 294912
    s_waitcnt lgkmcnt(2)
    v_lshlrev_b32 v132, 16, v172
    v_and_b32 v136, 0xffff0000, v172
    v_lshlrev_b32 v133, 16, v173
    v_and_b32 v137, 0xffff0000, v173
    v_lshlrev_b32 v134, 16, v174
    v_and_b32 v138, 0xffff0000, v174
    v_lshlrev_b32 v135, 16, v175
    v_and_b32 v139, 0xffff0000, v175
    v_pk_fma_f32 v[140:141], v[132:133], v[48:49], v[64:65]
    v_pk_fma_f32 v[142:143], v[134:135], v[50:51], v[66:67]
    v_pk_fma_f32 v[144:145], v[136:137], v[48:49], v[64:65]
    v_pk_fma_f32 v[146:147], v[138:139], v[50:51], v[66:67]
    v_cvt_pk_bf16_f32 v188, v92, v124
    v_cvt_pk_bf16_f32 v189, v93, v125
    v_cvt_pk_bf16_f32 v190, v94, v126
    v_cvt_pk_bf16_f32 v191, v95, v127
    v_pk_fma_f32 v[132:133], v[140:141], v[92:93], v[132:133]
    v_pk_fma_f32 v[134:135], v[142:143], v[94:95], v[134:135]
    v_pk_fma_f32 v[136:137], v[144:145], v[124:125], v[136:137]
    v_pk_fma_f32 v[138:139], v[146:147], v[126:127], v[138:139]
    v_cvt_pk_bf16_f32 v148, v132, v136
    v_cvt_pk_bf16_f32 v149, v133, v137
    v_cvt_pk_bf16_f32 v150, v134, v138
    v_cvt_pk_bf16_f32 v151, v135, v139
    buffer_store_dwordx4 v[148:151], v29, s[20:23], s43 offen sc1
    s_add_u32 s43, s43, 294912
    buffer_store_dwordx4 v[188:191], v29, s[20:23], s44 offen sc1
    s_add_u32 s44, s44, 294912
    s_waitcnt lgkmcnt(1)
    v_lshlrev_b32 v132, 16, v176
    v_and_b32 v136, 0xffff0000, v176
    v_lshlrev_b32 v133, 16, v177
    v_and_b32 v137, 0xffff0000, v177
    v_lshlrev_b32 v134, 16, v178
    v_and_b32 v138, 0xffff0000, v178
    v_lshlrev_b32 v135, 16, v179
    v_and_b32 v139, 0xffff0000, v179
    v_pk_fma_f32 v[140:141], v[132:133], v[52:53], v[68:69]
    v_pk_fma_f32 v[142:143], v[134:135], v[54:55], v[70:71]
    v_pk_fma_f32 v[144:145], v[136:137], v[52:53], v[68:69]
    v_pk_fma_f32 v[146:147], v[138:139], v[54:55], v[70:71]
    v_cvt_pk_bf16_f32 v192, v96, v128
    v_cvt_pk_bf16_f32 v193, v97, v129
    v_cvt_pk_bf16_f32 v194, v98, v130
    v_cvt_pk_bf16_f32 v195, v99, v131
    v_pk_fma_f32 v[132:133], v[140:141], v[96:97], v[132:133]
    v_pk_fma_f32 v[134:135], v[142:143], v[98:99], v[134:135]
    v_pk_fma_f32 v[136:137], v[144:145], v[128:129], v[136:137]
    v_pk_fma_f32 v[138:139], v[146:147], v[130:131], v[138:139]
    v_cvt_pk_bf16_f32 v152, v132, v136
    v_cvt_pk_bf16_f32 v153, v133, v137
    v_cvt_pk_bf16_f32 v154, v134, v138
    v_cvt_pk_bf16_f32 v155, v135, v139
    buffer_store_dwordx4 v[152:155], v29, s[20:23], s43 offen sc1
    s_add_u32 s43, s43, 294912
    buffer_store_dwordx4 v[192:195], v29, s[20:23], s44 offen sc1
    s_add_u32 s44, s44, 294912
    s_branch LCfin_21
LCodd_20:
    s_nop 7
    ds_write_b128 v11, v[84:87] offset:0
    ds_write_b128 v11, v[88:91] offset:1024
    ds_write_b128 v11, v[92:95] offset:2048
    ds_write_b128 v11, v[96:99] offset:3072
    ds_write_b32 v13, v15
LCsp_23:
    ds_read_b32 v16, v14
    s_waitcnt lgkmcnt(0)
    v_cmp_eq_u32 vcc, 0, v16
    s_cbranch_vccnz LCsp_23
    ds_read_b128 v[116:119], v12 offset:0
    ds_read_b128 v[120:123], v12 offset:1024
    ds_read_b128 v[124:127], v12 offset:2048
    ds_read_b128 v[128:131], v12 offset:3072
    v_mov_b32 v13, 85024
    s_mov_b64 exec, 1
    ds_add_u32 v13, v15 offset:4
    s_mov_b64 exec, -1
    s_waitcnt lgkmcnt(4)
    v_lshlrev_b32 v132, 16, v164
    v_and_b32 v136, 0xffff0000, v164
    v_lshlrev_b32 v133, 16, v165
    v_and_b32 v137, 0xffff0000, v165
    v_lshlrev_b32 v134, 16, v166
    v_and_b32 v138, 0xffff0000, v166
    v_lshlrev_b32 v135, 16, v167
    v_and_b32 v139, 0xffff0000, v167
    v_pk_fma_f32 v[140:141], v[132:133], v[40:41], v[56:57]
    v_pk_fma_f32 v[142:143], v[134:135], v[42:43], v[58:59]
    v_pk_fma_f32 v[144:145], v[136:137], v[40:41], v[56:57]
    v_pk_fma_f32 v[146:147], v[138:139], v[42:43], v[58:59]
    v_cvt_pk_bf16_f32 v180, v116, v100
    v_cvt_pk_bf16_f32 v181, v117, v101
    v_cvt_pk_bf16_f32 v182, v118, v102
    v_cvt_pk_bf16_f32 v183, v119, v103
    v_pk_fma_f32 v[132:133], v[140:141], v[116:117], v[132:133]
    v_pk_fma_f32 v[134:135], v[142:143], v[118:119], v[134:135]
    v_pk_fma_f32 v[136:137], v[144:145], v[100:101], v[136:137]
    v_pk_fma_f32 v[138:139], v[146:147], v[102:103], v[138:139]
    v_cvt_pk_bf16_f32 v148, v132, v136
    v_cvt_pk_bf16_f32 v149, v133, v137
    v_cvt_pk_bf16_f32 v150, v134, v138
    v_cvt_pk_bf16_f32 v151, v135, v139
    buffer_store_dwordx4 v[148:151], v29, s[20:23], s43 offen sc1
    s_add_u32 s43, s43, 294912
    buffer_store_dwordx4 v[180:183], v29, s[20:23], s44 offen sc1
    s_add_u32 s44, s44, 294912
    s_waitcnt lgkmcnt(3)
    v_lshlrev_b32 v132, 16, v168
    v_and_b32 v136, 0xffff0000, v168
    v_lshlrev_b32 v133, 16, v169
    v_and_b32 v137, 0xffff0000, v169
    v_lshlrev_b32 v134, 16, v170
    v_and_b32 v138, 0xffff0000, v170
    v_lshlrev_b32 v135, 16, v171
    v_and_b32 v139, 0xffff0000, v171
    v_pk_fma_f32 v[140:141], v[132:133], v[44:45], v[60:61]
    v_pk_fma_f32 v[142:143], v[134:135], v[46:47], v[62:63]
    v_pk_fma_f32 v[144:145], v[136:137], v[44:45], v[60:61]
    v_pk_fma_f32 v[146:147], v[138:139], v[46:47], v[62:63]
    v_cvt_pk_bf16_f32 v184, v120, v104
    v_cvt_pk_bf16_f32 v185, v121, v105
    v_cvt_pk_bf16_f32 v186, v122, v106
    v_cvt_pk_bf16_f32 v187, v123, v107
    v_pk_fma_f32 v[132:133], v[140:141], v[120:121], v[132:133]
    v_pk_fma_f32 v[134:135], v[142:143], v[122:123], v[134:135]
    v_pk_fma_f32 v[136:137], v[144:145], v[104:105], v[136:137]
    v_pk_fma_f32 v[138:139], v[146:147], v[106:107], v[138:139]
    v_cvt_pk_bf16_f32 v152, v132, v136
    v_cvt_pk_bf16_f32 v153, v133, v137
    v_cvt_pk_bf16_f32 v154, v134, v138
    v_cvt_pk_bf16_f32 v155, v135, v139
    buffer_store_dwordx4 v[152:155], v29, s[20:23], s43 offen sc1
    s_add_u32 s43, s43, 294912
    buffer_store_dwordx4 v[184:187], v29, s[20:23], s44 offen sc1
    s_add_u32 s44, s44, 294912
    s_waitcnt lgkmcnt(2)
    v_lshlrev_b32 v132, 16, v172
    v_and_b32 v136, 0xffff0000, v172
    v_lshlrev_b32 v133, 16, v173
    v_and_b32 v137, 0xffff0000, v173
    v_lshlrev_b32 v134, 16, v174
    v_and_b32 v138, 0xffff0000, v174
    v_lshlrev_b32 v135, 16, v175
    v_and_b32 v139, 0xffff0000, v175
    v_pk_fma_f32 v[140:141], v[132:133], v[48:49], v[64:65]
    v_pk_fma_f32 v[142:143], v[134:135], v[50:51], v[66:67]
    v_pk_fma_f32 v[144:145], v[136:137], v[48:49], v[64:65]
    v_pk_fma_f32 v[146:147], v[138:139], v[50:51], v[66:67]
    v_cvt_pk_bf16_f32 v188, v124, v108
    v_cvt_pk_bf16_f32 v189, v125, v109
    v_cvt_pk_bf16_f32 v190, v126, v110
    v_cvt_pk_bf16_f32 v191, v127, v111
    v_pk_fma_f32 v[132:133], v[140:141], v[124:125], v[132:133]
    v_pk_fma_f32 v[134:135], v[142:143], v[126:127], v[134:135]
    v_pk_fma_f32 v[136:137], v[144:145], v[108:109], v[136:137]
    v_pk_fma_f32 v[138:139], v[146:147], v[110:111], v[138:139]
    v_cvt_pk_bf16_f32 v148, v132, v136
    v_cvt_pk_bf16_f32 v149, v133, v137
    v_cvt_pk_bf16_f32 v150, v134, v138
    v_cvt_pk_bf16_f32 v151, v135, v139
    buffer_store_dwordx4 v[148:151], v29, s[20:23], s43 offen sc1
    s_add_u32 s43, s43, 294912
    buffer_store_dwordx4 v[188:191], v29, s[20:23], s44 offen sc1
    s_add_u32 s44, s44, 294912
    s_waitcnt lgkmcnt(1)
    v_lshlrev_b32 v132, 16, v176
    v_and_b32 v136, 0xffff0000, v176
    v_lshlrev_b32 v133, 16, v177
    v_and_b32 v137, 0xffff0000, v177
    v_lshlrev_b32 v134, 16, v178
    v_and_b32 v138, 0xffff0000, v178
    v_lshlrev_b32 v135, 16, v179
    v_and_b32 v139, 0xffff0000, v179
    v_pk_fma_f32 v[140:141], v[132:133], v[52:53], v[68:69]
    v_pk_fma_f32 v[142:143], v[134:135], v[54:55], v[70:71]
    v_pk_fma_f32 v[144:145], v[136:137], v[52:53], v[68:69]
    v_pk_fma_f32 v[146:147], v[138:139], v[54:55], v[70:71]
    v_cvt_pk_bf16_f32 v192, v128, v112
    v_cvt_pk_bf16_f32 v193, v129, v113
    v_cvt_pk_bf16_f32 v194, v130, v114
    v_cvt_pk_bf16_f32 v195, v131, v115
    v_pk_fma_f32 v[132:133], v[140:141], v[128:129], v[132:133]
    v_pk_fma_f32 v[134:135], v[142:143], v[130:131], v[134:135]
    v_pk_fma_f32 v[136:137], v[144:145], v[112:113], v[136:137]
    v_pk_fma_f32 v[138:139], v[146:147], v[114:115], v[138:139]
    v_cvt_pk_bf16_f32 v152, v132, v136
    v_cvt_pk_bf16_f32 v153, v133, v137
    v_cvt_pk_bf16_f32 v154, v134, v138
    v_cvt_pk_bf16_f32 v155, v135, v139
    buffer_store_dwordx4 v[152:155], v29, s[20:23], s43 offen sc1
    s_add_u32 s43, s43, 294912
    buffer_store_dwordx4 v[192:195], v29, s[20:23], s44 offen sc1
    s_add_u32 s44, s44, 294912
LCfin_21:
    v_mov_b32 v13, 85024
    s_mov_b64 exec, 1
    s_waitcnt vmcnt(0)
    ds_add_rtn_u32 v16, v13, v15
    s_waitcnt lgkmcnt(0)
    v_readfirstlane_b32 s38, v16
    s_mov_b64 exec, -1
    s_setprio 0
    s_cmp_eq_u32 s38, 3
    s_cbranch_scc0 Lyl_24
    s_lshl_b32 s57, s2, 4
    s_add_u32 s57, s57, 69632
    v_mov_b32 v10, s6
    v_lshlrev_b32 v11, 12, v1
    s_mov_b64 exec, 0xff
    buffer_store_dword v10, v11, s[20:23], s57 offen sc1
    s_mov_b64 exec, -1
Lyl_24:
    s_branch Ljoin_7
LClo_17:
    v_lshlrev_b32 v10, 4, v0
    s_and_b32 s56, s2, 7
    s_lshl_b32 s56, s56, 12
    s_add_u32 s56, s56, 4096
    v_lshrrev_b32 v12, 2, v1
    v_lshrrev_b32 v13, 4, v1
    v_sub_u32 v13, v1, v13
    v_and_b32 v13, 3, v13
    v_mul_u32_u24 v12, 9216, v12
    v_lshl_add_u32 v12, v13, 4, v12
    s_lshl_b32 s38, s61, 6
    v_add_u32 v12, s38, v12
    s_mul_i32 s38, s3, 589824
    s_add_u32 s38, s38, 1495040
    s_lshl_b32 s39, s3, 12
    s_add_u32 s39, s39, 68608
    s_mov_b32 s83, 0
Lpoll_25:
    buffer_load_dword v11, v10, s[20:23], s56 offen sc1
    s_add_u32 s83, s83, 1
    s_waitcnt vmcnt(0)
    v_cmp_ne_u32 vcc, s6, v11
    s_cbranch_vccz Lpolld_26
    s_cmp_lt_u32 s83, 524288
    s_cbranch_scc1 Lpoll_25
Lpolld_26:
    s_mov_b32 m0, s39
    s_add_u32 s39, s39, 1024
    buffer_load_dwordx4 v12, s[20:23], s38 offen sc1 lds
    s_add_u32 s38, s38, 147456
    s_mov_b32 m0, s39
    s_add_u32 s39, s39, 1024
    buffer_load_dwordx4 v12, s[20:23], s38 offen sc1 lds
    s_add_u32 s38, s38, 147456
    s_mov_b32 m0, s39
    s_add_u32 s39, s39, 1024
    buffer_load_dwordx4 v12, s[20:23], s38 offen sc1 lds
    s_add_u32 s38, s38, 147456
    s_mov_b32 m0, s39
    s_add_u32 s39, s39, 1024
    buffer_load_dwordx4 v12, s[20:23], s38 offen sc1 lds
    s_add_u32 s38, s38, 147456
    s_waitcnt vmcnt(0)
    s_barrier
    s_add_u32 s56, s2, s3
    s_cmp_eq_u32 s56, 0
    s_cbranch_scc0 Lne_27
    s_mov_b32 s56, 0
    v_mov_b32 v12, s6
    v_mov_b32 v13, 0
    s_mov_b64 exec, 1
    buffer_store_dword v12, v13, s[20:23], s56 offen sc1
    s_mov_b64 exec, -1
Lne_27:
    v_lshrrev_b32 v12, 2, v1
    v_lshrrev_b32 v13, 4, v1
    v_sub_u32 v13, v1, v13
    v_and_b32 v13, 3, v13
    v_lshlrev_b32 v13, 4, v13
    v_lshl_add_u32 v14, v12, 6, v13
    v_mul_u32_u24 v12, 9216, v12
    s_lshl_b32 s38, s61, 6
    v_add3_u32 v12, v12, v13, s38
    s_mul_i32 s38, s3, 589824
    s_add_u32 s38, s38, 3854336
    s_lshl_b32 s39, s3, 12
    s_add_u32 s40, s39, 1298432
    s_add_u32 s39, s39, 86016
    s_mov_b32 m0, s39
    s_add_u32 s39, s39, 1024
    buffer_load_dwordx4 v12, s[20:23], s38 offen sc1 lds
    s_add_u32 s38, s38, 147456
    s_mov_b32 m0, s39
    s_add_u32 s39, s39, 1024
    buffer_load_dwordx4 v12, s[20:23], s38 offen sc1 lds
    s_add_u32 s38, s38, 147456
    s_mov_b32 m0, s39
    s_add_u32 s39, s39, 1024
    buffer_load_dwordx4 v12, s[20:23], s38 offen sc1 lds
    s_add_u32 s38, s38, 147456
    s_mov_b32 m0, s39
    s_add_u32 s39, s39, 1024
    buffer_load_dwordx4 v12, s[20:23], s38 offen sc1 lds
    s_add_u32 s38, s38, 147456
    s_add_u32 m0, s39, 12288
    s_nop 0
    buffer_load_dwordx4 v14, s[20:23], s40 offen offset:0 sc1 lds
    buffer_load_dwordx4 v14, s[20:23], s40 offen offset:1024 sc1 lds
    buffer_load_dwordx4 v14, s[20:23], s40 offen offset:2048 sc1 lds
    buffer_load_dwordx4 v14, s[20:23], s40 offen offset:3072 sc1 lds
    v_mov_b32 v13, 85024
    v_mov_b32 v15, 1
    s_waitcnt vmcnt(0)
    s_mov_b64 exec, 1
    ds_add_u32 v13, v15 offset:8
    s_mov_b64 exec, -1
    v_add_u32 v11, 64, v1
    v_min_u32 v11, 71, v11
    v_lshlrev_b32 v10, 4, v1
    v_lshlrev_b32 v11, 4, v11
    s_and_b32 s56, s2, 7
    s_lshl_b32 s56, s56, 12
    s_add_u32 s56, s56, 102400
    s_mov_b32 s83, 0
Lpoll_28:
    buffer_load_dword v12, v10, s[20:23], s56 offen sc1
    buffer_load_dword v13, v11, s[20:23], s56 offen sc1
    s_add_u32 s83, s83, 1
    s_waitcnt vmcnt(0)
    v_xor_b32 v12, s6, v12
    v_xor_b32 v13, s6, v13
    v_or_b32 v12, v12, v13
    v_cmp_ne_u32 vcc, 0, v12
    s_cbranch_vccz Lpolld_29
    s_cmp_lt_u32 s83, 524288
    s_cbranch_scc1 Lpoll_28
Lpolld_29:
    s_mul_i32 s56, s5, 73728
    s_lshl_b32 s57, s3, 10
    s_add_u32 s56, s56, s57
    s_add_u32 s56, s56, 10932224
    buffer_load_dwordx4 v[160:163], v2, s[20:23], s56 offen sc1
    s_add_u32 s56, s56, 4096
    buffer_load_dwordx4 v[164:167], v2, s[20:23], s56 offen sc1
    s_add_u32 s56, s56, 4096
    buffer_load_dwordx4 v[168:171], v2, s[20:23], s56 offen sc1
    s_add_u32 s56, s56, 4096
    buffer_load_dwordx4 v[172:175], v2, s[20:23], s56 offen sc1
    s_add_u32 s56, s56, 4096
    buffer_load_dwordx4 v[176:179], v2, s[20:23], s56 offen sc1
    s_add_u32 s56, s56, 4096
    buffer_load_dwordx4 v[180:183], v2, s[20:23], s56 offen sc1
    s_add_u32 s56, s56, 4096
    buffer_load_dwordx4 v[184:187], v2, s[20:23], s56 offen sc1
    s_add_u32 s56, s56, 4096
    buffer_load_dwordx4 v[188:191], v2, s[20:23], s56 offen sc1
    s_add_u32 s56, s56, 4096
    buffer_load_dwordx4 v[192:195], v2, s[20:23], s56 offen sc1
    s_add_u32 s56, s56, 4096
    buffer_load_dwordx4 v[196:199], v2, s[20:23], s56 offen sc1
    s_add_u32 s56, s56, 4096
    buffer_load_dwordx4 v[200:203], v2, s[20:23], s56 offen sc1
    s_add_u32 s56, s56, 4096
    buffer_load_dwordx4 v[204:207], v2, s[20:23], s56 offen sc1
    s_add_u32 s56, s56, 4096
    buffer_load_dwordx4 v[208:211], v2, s[20:23], s56 offen sc1
    s_add_u32 s56, s56, 4096
    buffer_load_dwordx4 v[212:215], v2, s[20:23], s56 offen sc1
    s_add_u32 s56, s56, 4096
    buffer_load_dwordx4 v[216:219], v2, s[20:23], s56 offen sc1
    s_add_u32 s56, s56, 4096
    buffer_load_dwordx4 v[220:223], v2, s[20:23], s56 offen sc1
    s_add_u32 s56, s56, 4096
    buffer_load_dwordx4 v[224:227], v2, s[20:23], s56 offen sc1
    s_add_u32 s56, s56, 4096
    buffer_load_dwordx4 v[228:231], v2, s[20:23], s56 offen sc1
    s_add_u32 s56, s56, 4096
    s_mov_b32 s56, 0x3f803f80
    s_waitcnt vmcnt(17)
    v_dot2_f32_bf16 v12, v160, s56, 0
    v_dot2_f32_bf16 v13, v161, s56, 0
    v_dot2_f32_bf16 v12, v162, s56, v12
    v_dot2_f32_bf16 v13, v163, s56, v13
    s_waitcnt vmcnt(16)
    v_dot2_f32_bf16 v12, v164, s56, v12
    v_dot2_f32_bf16 v13, v165, s56, v13
    v_dot2_f32_bf16 v12, v166, s56, v12
    v_dot2_f32_bf16 v13, v167, s56, v13
    s_waitcnt vmcnt(15)
    v_dot2_f32_bf16 v12, v168, s56, v12
    v_dot2_f32_bf16 v13, v169, s56, v13
    v_dot2_f32_bf16 v12, v170, s56, v12
    v_dot2_f32_bf16 v13, v171, s56, v13
    s_waitcnt vmcnt(14)
    v_dot2_f32_bf16 v12, v172, s56, v12
    v_dot2_f32_bf16 v13, v173, s56, v13
    v_dot2_f32_bf16 v12, v174, s56, v12
    v_dot2_f32_bf16 v13, v175, s56, v13
    s_waitcnt vmcnt(13)
    v_dot2_f32_bf16 v12, v176, s56, v12
    v_dot2_f32_bf16 v13, v177, s56, v13
    v_dot2_f32_bf16 v12, v178, s56, v12
    v_dot2_f32_bf16 v13, v179, s56, v13
    s_waitcnt vmcnt(12)
    v_dot2_f32_bf16 v12, v180, s56, v12
    v_dot2_f32_bf16 v13, v181, s56, v13
    v_dot2_f32_bf16 v12, v182, s56, v12
    v_dot2_f32_bf16 v13, v183, s56, v13
    s_waitcnt vmcnt(11)
    v_dot2_f32_bf16 v12, v184, s56, v12
    v_dot2_f32_bf16 v13, v185, s56, v13
    v_dot2_f32_bf16 v12, v186, s56, v12
    v_dot2_f32_bf16 v13, v187, s56, v13
    s_waitcnt vmcnt(10)
    v_dot2_f32_bf16 v12, v188, s56, v12
    v_dot2_f32_bf16 v13, v189, s56, v13
    v_dot2_f32_bf16 v12, v190, s56, v12
    v_dot2_f32_bf16 v13, v191, s56, v13
    s_waitcnt vmcnt(9)
    v_dot2_f32_bf16 v12, v192, s56, v12
    v_dot2_f32_bf16 v13, v193, s56, v13
    v_dot2_f32_bf16 v12, v194, s56, v12
    v_dot2_f32_bf16 v13, v195, s56, v13
    s_waitcnt vmcnt(8)
    v_dot2_f32_bf16 v12, v196, s56, v12
    v_dot2_f32_bf16 v13, v197, s56, v13
    v_dot2_f32_bf16 v12, v198, s56, v12
    v_dot2_f32_bf16 v13, v199, s56, v13
    s_waitcnt vmcnt(7)
    v_dot2_f32_bf16 v12, v200, s56, v12
    v_dot2_f32_bf16 v13, v201, s56, v13
    v_dot2_f32_bf16 v12, v202, s56, v12
    v_dot2_f32_bf16 v13, v203, s56, v13
    s_waitcnt vmcnt(6)
    v_dot2_f32_bf16 v12, v204, s56, v12
    v_dot2_f32_bf16 v13, v205, s56, v13
    v_dot2_f32_bf16 v12, v206, s56, v12
    v_dot2_f32_bf16 v13, v207, s56, v13
    s_waitcnt vmcnt(5)
    v_dot2_f32_bf16 v12, v208, s56, v12
    v_dot2_f32_bf16 v13, v209, s56, v13
    v_dot2_f32_bf16 v12, v210, s56, v12
    v_dot2_f32_bf16 v13, v211, s56, v13
    s_waitcnt vmcnt(4)
    v_dot2_f32_bf16 v12, v212, s56, v12
    v_dot2_f32_bf16 v13, v213, s56, v13
    v_dot2_f32_bf16 v12, v214, s56, v12
    v_dot2_f32_bf16 v13, v215, s56, v13
    s_waitcnt vmcnt(3)
    v_dot2_f32_bf16 v12, v216, s56, v12
    v_dot2_f32_bf16 v13, v217, s56, v13
    v_dot2_f32_bf16 v12, v218, s56, v12
    v_dot2_f32_bf16 v13, v219, s56, v13
    s_waitcnt vmcnt(2)
    v_dot2_f32_bf16 v12, v220, s56, v12
    v_dot2_f32_bf16 v13, v221, s56, v13
    v_dot2_f32_bf16 v12, v222, s56, v12
    v_dot2_f32_bf16 v13, v223, s56, v13
    s_waitcnt vmcnt(1)
    v_dot2_f32_bf16 v12, v224, s56, v12
    v_dot2_f32_bf16 v13, v225, s56, v13
    v_dot2_f32_bf16 v12, v226, s56, v12
    v_dot2_f32_bf16 v13, v227, s56, v13
    s_waitcnt vmcnt(0)
    v_dot2_f32_bf16 v12, v228, s56, v12
    v_dot2_f32_bf16 v13, v229, s56, v13
    v_dot2_f32_bf16 v12, v230, s56, v12
    v_dot2_f32_bf16 v13, v231, s56, v13
    v_and_b32 v10, 31, v1
    s_and_b32 s56, s3, 1
    s_lshl_b32 s56, s56, 7
    s_add_u32 s56, s56, 85248
    v_add_f32 v12, v12, v13
    v_mov_b32 v13, v12
    v_lshl_add_u32 v10, v10, 2, s56
    s_nop 0
    v_permlane32_swap_b32 v12, v13
    v_add_f32 v12, v12, v13
    s_mov_b32 exec_hi, 0
    ds_add_f32 v10, v12
    s_mov_b32 exec_hi, -1
    v_mov_b32 v18, 85028
Lgate_30:
    ds_read_b32 v19, v18
    s_waitcnt lgkmcnt(0)
    v_cmp_gt_u32 vcc, 4, v19
    s_cbranch_vccnz Lgate_30
    s_lshl_b32 s56, s3, 10
    s_add_u32 s56, s56, 86016
    v_add_u32 v4, s56, v2
    v_add_u32 v5, 65536, v4
    ds_write_b128 v4, v[160:163] offset:0
    ds_write_b128 v4, v[164:167] offset:4096
    ds_write_b128 v4, v[168:171] offset:8192
    ds_write_b128 v4, v[172:175] offset:12288
    ds_write_b128 v4, v[176:179] offset:16384
    ds_write_b128 v4, v[180:183] offset:20480
    ds_write_b128 v4, v[184:187] offset:24576
    ds_write_b128 v4, v[188:191] offset:28672
    ds_write_b128 v4, v[192:195] offset:32768
    ds_write_b128 v4, v[196:199] offset:36864
    ds_write_b128 v4, v[200:203] offset:40960
    ds_write_b128 v4, v[204:207] offset:45056
    ds_write_b128 v4, v[208:211] offset:49152
    ds_write_b128 v4, v[212:215] offset:53248
    ds_write_b128 v4, v[216:219] offset:57344
    ds_write_b128 v4, v[220:223] offset:61440
    ds_write_b128 v5, v[224:227] offset:0
    ds_write_b128 v5, v[228:231] offset:4096
    s_branch Ljoin_7
Lprep_6:
    s_mov_b32 s36, s24
    s_mov_b32 s37, s25
    s_mov_b32 s38, 1990656
    s_mov_b32 s39, 0x20000
    s_mov_b32 s40, s26
    s_mov_b32 s41, s27
    s_mov_b32 s42, 663552
    s_mov_b32 s43, 0x20000
    s_sub_u32 s32, s2, 144
    s_cmp_ge_u32 s32, 72
    s_cbranch_scc1 LPwof_32
    v_and_b32 v3, 15, v1
    v_lshlrev_b32 v3, 1, v3
    v_lshrrev_b32 v4, 4, v1
    s_lshl_b32 s44, s3, 2
    v_add_u32 v5, s44, v4
    v_mul_u32_u24 v5, 18, v5
    v_add_u32 v6, 560, v3
    v_cmp_gt_u32 vcc, 16, v3
    s_nop 1
    v_cndmask_b32 v6, v6, v3, vcc
    v_add_lshl_u32 v6, v6, v5, 1
    v_add_u32 v7, 1152, v3
    v_add_u32 v8, 574, v3
    v_cmp_gt_u32 vcc, 18, v3
    s_nop 1
    v_cndmask_b32 v7, v8, v7, vcc
    v_subrev_u32 v8, 4, v3
    v_cmp_gt_u32 vcc, 20, v3
    s_nop 1
    v_cndmask_b32 v7, v8, v7, vcc
    v_add_lshl_u32 v7, v7, v5, 1
    v_cmp_gt_u32 vcc, 22, v3
    s_nop 1
    v_cndmask_b32 v8, 0, -1, vcc
    v_and_b32 v9, 27, v3
    v_cmp_eq_u32 vcc, 24, v9
    v_mov_b32 v9, 0x3f803f80
    s_nop 0
    v_cndmask_b32 v9, 0, v9, vcc
    v_and_b32 v10, 2, v4
    v_mul_u32_u24 v10, 73728, v10
    v_and_b32 v11, 1, v4
    v_add_lshl_u32 v11, v11, v3, 4
    v_add_u32 v10, v10, v11
    s_mul_i32 s48, s3, 294912
    s_lshr_b32 s49, s32, 1
    s_lshl_b32 s49, s49, 11
    s_add_u32 s48, s48, s49
    s_and_b32 s49, s32, 1
    s_lshl_b32 s49, s49, 9
    s_add_u32 s48, s48, s49
    s_add_u32 s48, s48, 10932224
    s_add_u32 s49, s48, 73728
    s_mov_b32 s51, 0x05040100
    s_mov_b32 s52, 0x07060302
    ds_read_b32 v16, v6 offset:0
    ds_read_b32 v17, v6 offset:3456
    ds_read_b32 v18, v6 offset:6912
    ds_read_b32 v19, v6 offset:10368
    ds_read_b32 v20, v6 offset:13824
    ds_read_b32 v21, v6 offset:17280
    ds_read_b32 v22, v6 offset:20736
    ds_read_b32 v23, v6 offset:24192
    ds_read_b32 v24, v7 offset:0
    ds_read_b32 v25, v7 offset:3456
    ds_read_b32 v26, v7 offset:6912
    ds_read_b32 v27, v7 offset:10368
    ds_read_b32 v28, v7 offset:13824
    ds_read_b32 v29, v7 offset:17280
    ds_read_b32 v30, v7 offset:20736
    ds_read_b32 v31, v7 offset:24192
    s_waitcnt lgkmcnt(8)
    v_perm_b32 v32, v17, v16, s51
    v_perm_b32 v36, v17, v16, s52
    v_perm_b32 v33, v19, v18, s51
    v_perm_b32 v37, v19, v18, s52
    v_perm_b32 v34, v21, v20, s51
    v_perm_b32 v38, v21, v20, s52
    v_perm_b32 v35, v23, v22, s51
    v_perm_b32 v39, v23, v22, s52
    v_permlane16_swap_b32 v32, v36
    v_permlane16_swap_b32 v33, v37
    v_permlane16_swap_b32 v34, v38
    v_permlane16_swap_b32 v35, v39
    buffer_store_dwordx4 v[32:35], v10, s[20:23], s48 offen offset:0 sc1
    buffer_store_dwordx4 v[36:39], v10, s[20:23], s49 offen offset:0 sc1
    s_waitcnt lgkmcnt(0)
    v_perm_b32 v40, v25, v24, s51
    v_perm_b32 v44, v25, v24, s52
    v_perm_b32 v41, v27, v26, s51
    v_perm_b32 v45, v27, v26, s52
    v_perm_b32 v42, v29, v28, s51
    v_perm_b32 v46, v29, v28, s52
    v_perm_b32 v43, v31, v30, s51
    v_perm_b32 v47, v31, v30, s52
    v_and_or_b32 v40, v40, v8, v9
    v_and_b32 v44, v44, v8
    v_and_or_b32 v41, v41, v8, v9
    v_and_b32 v45, v45, v8
    v_and_or_b32 v42, v42, v8, v9
    v_and_b32 v46, v46, v8
    v_and_or_b32 v43, v43, v8, v9
    v_and_b32 v47, v47, v8
    v_permlane16_swap_b32 v40, v44
    v_permlane16_swap_b32 v41, v45
    v_permlane16_swap_b32 v42, v46
    v_permlane16_swap_b32 v43, v47
    buffer_store_dwordx4 v[40:43], v10, s[20:23], s48 offen offset:1024 sc1
    buffer_store_dwordx4 v[44:47], v10, s[20:23], s49 offen offset:1024 sc1
    s_waitcnt vmcnt(0)
    s_barrier
    s_cmp_eq_u32 s3, 4
    s_cbranch_scc0 LPnf_34
    s_lshl_b32 s57, s32, 4
    s_add_u32 s57, s57, 102400
    v_mov_b32 v10, s6
    v_lshlrev_b32 v11, 12, v1
    s_mov_b64 exec, 0xff
    buffer_store_dword v10, v11, s[20:23], s57 offen sc1
    s_mov_b64 exec, -1
LPnf_34:
    s_branch LPlo_31
LPwof_32:
    s_sub_u32 s32, s32, 72
    s_mul_i32 s33, s3, 40
    s_add_u32 s32, s32, s33
    s_cmp_ge_u32 s32, 162
    s_cbranch_scc1 LPlo_31
    s_mov_b32 s35, s32
    s_mul_i32 s33, s35, 7282
    s_lshr_b32 s33, s33, 16
    s_mul_i32 s34, s33, 9
    s_sub_u32 s34, s35, s34
    s_lshl_b32 s34, s34, 6
    v_add_u32 v3, s34, v1
    v_lshlrev_b32 v4, 1, v3
    v_mul_u32_u24 v5, 911, v3
    v_lshrrev_b32 v5, 16, v5
    v_mul_u32_u24 v6, 72, v5
    v_sub_u32 v6, v3, v6
    v_mul_u32_u24 v7, 82944, v5
    v_lshrrev_b32 v8, 3, v6
    v_lshl_add_u32 v7, v8, 8, v7
    v_and_b32 v6, 7, v6
    v_lshl_add_u32 v7, v6, 4, v7
    s_mul_i32 s48, s33, 4608
    s_add_u32 s48, s48, 13291520
    s_cmp_ge_u32 s33, 16
    s_cbranch_scc1 LPext_35
    s_mul_i32 s45, s33, 41472
    s_add_u32 s49, s45, 0
    buffer_load_ushort v16, v4, s[40:43], s49 offen
    s_add_u32 s49, s45, 1152
    buffer_load_ushort v17, v4, s[40:43], s49 offen
    s_add_u32 s49, s45, 2304
    buffer_load_ushort v18, v4, s[40:43], s49 offen
    s_add_u32 s49, s45, 3456
    buffer_load_ushort v19, v4, s[40:43], s49 offen
    s_add_u32 s49, s45, 9216
    buffer_load_ushort v20, v4, s[40:43], s49 offen
    s_add_u32 s49, s45, 10368
    buffer_load_ushort v21, v4, s[40:43], s49 offen
    s_add_u32 s49, s45, 11520
    buffer_load_ushort v22, v4, s[40:43], s49 offen
    s_add_u32 s49, s45, 12672
    buffer_load_ushort v23, v4, s[40:43], s49 offen
    s_add_u32 s49, s45, 4608
    buffer_load_ushort v24, v4, s[40:43], s49 offen
    s_add_u32 s49, s45, 5760
    buffer_load_ushort v25, v4, s[40:43], s49 offen
    s_add_u32 s49, s45, 6912
    buffer_load_ushort v26, v4, s[40:43], s49 offen
    s_add_u32 s49, s45, 8064
    buffer_load_ushort v27, v4, s[40:43], s49 offen
    s_add_u32 s49, s45, 13824
    buffer_load_ushort v28, v4, s[40:43], s49 offen
    s_add_u32 s49, s45, 14976
    buffer_load_ushort v29, v4, s[40:43], s49 offen
    s_add_u32 s49, s45, 16128
    buffer_load_ushort v30, v4, s[40:43], s49 offen
    s_add_u32 s49, s45, 17280
    buffer_load_ushort v31, v4, s[40:43], s49 offen
    s_add_u32 s49, s45, 20736
    buffer_load_ushort v32, v4, s[40:43], s49 offen
    s_add_u32 s49, s45, 21888
    buffer_load_ushort v33, v4, s[40:43], s49 offen
    s_add_u32 s49, s45, 23040
    buffer_load_ushort v34, v4, s[40:43], s49 offen
    s_add_u32 s49, s45, 24192
    buffer_load_ushort v35, v4, s[40:43], s49 offen
    s_add_u32 s49, s45, 29952
    buffer_load_ushort v36, v4, s[40:43], s49 offen
    s_add_u32 s49, s45, 31104
    buffer_load_ushort v37, v4, s[40:43], s49 offen
    s_add_u32 s49, s45, 32256
    buffer_load_ushort v38, v4, s[40:43], s49 offen
    s_add_u32 s49, s45, 33408
    buffer_load_ushort v39, v4, s[40:43], s49 offen
    s_add_u32 s49, s45, 25344
    buffer_load_ushort v40, v4, s[40:43], s49 offen
    s_add_u32 s49, s45, 26496
    buffer_load_ushort v41, v4, s[40:43], s49 offen
    s_add_u32 s49, s45, 27648
    buffer_load_ushort v42, v4, s[40:43], s49 offen
    s_add_u32 s49, s45, 28800
    buffer_load_ushort v43, v4, s[40:43], s49 offen
    s_add_u32 s49, s45, 34560
    buffer_load_ushort v44, v4, s[40:43], s49 offen
    s_add_u32 s49, s45, 35712
    buffer_load_ushort v45, v4, s[40:43], s49 offen
    s_add_u32 s49, s45, 36864
    buffer_load_ushort v46, v4, s[40:43], s49 offen
    s_add_u32 s49, s45, 38016
    buffer_load_ushort v47, v4, s[40:43], s49 offen
    s_branch LPjoin_36
LPext_35:
    s_sub_u32 s45, s33, 16
    s_mul_i32 s45, s45, 331776
    s_add_u32 s49, s45, 18432
    buffer_load_ushort v16, v4, s[40:43], s49 offen
    s_add_u32 s49, s45, 19584
    buffer_load_ushort v17, v4, s[40:43], s49 offen
    s_add_u32 s49, s45, 39168
    buffer_load_ushort v18, v4, s[40:43], s49 offen
    s_add_u32 s49, s45, 40320
    buffer_load_ushort v19, v4, s[40:43], s49 offen
    s_add_u32 s49, s45, 59904
    buffer_load_ushort v20, v4, s[40:43], s49 offen
    s_add_u32 s49, s45, 61056
    buffer_load_ushort v21, v4, s[40:43], s49 offen
    s_add_u32 s49, s45, 80640
    buffer_load_ushort v22, v4, s[40:43], s49 offen
    s_add_u32 s49, s45, 81792
    buffer_load_ushort v23, v4, s[40:43], s49 offen
    s_add_u32 s49, s45, 101376
    buffer_load_ushort v24, v4, s[40:43], s49 offen
    s_add_u32 s49, s45, 102528
    buffer_load_ushort v25, v4, s[40:43], s49 offen
    s_add_u32 s49, s45, 122112
    buffer_load_ushort v26, v4, s[40:43], s49 offen
    s_add_u32 s49, s45, 123264
    buffer_load_ushort v27, v4, s[40:43], s49 offen
    s_add_u32 s49, s45, 142848
    buffer_load_ushort v28, v4, s[40:43], s49 offen
    s_add_u32 s49, s45, 144000
    buffer_load_ushort v29, v4, s[40:43], s49 offen
    s_add_u32 s49, s45, 163584
    buffer_load_ushort v30, v4, s[40:43], s49 offen
    s_add_u32 s49, s45, 164736
    buffer_load_ushort v31, v4, s[40:43], s49 offen
    s_add_u32 s49, s45, 184320
    buffer_load_ushort v32, v4, s[40:43], s49 offen
    s_add_u32 s49, s45, 185472
    buffer_load_ushort v33, v4, s[40:43], s49 offen
    s_add_u32 s49, s45, 205056
    buffer_load_ushort v34, v4, s[40:43], s49 offen
    s_add_u32 s49, s45, 206208
    buffer_load_ushort v35, v4, s[40:43], s49 offen
    s_add_u32 s49, s45, 225792
    buffer_load_ushort v36, v4, s[40:43], s49 offen
    s_add_u32 s49, s45, 226944
    buffer_load_ushort v37, v4, s[40:43], s49 offen
    s_add_u32 s49, s45, 246528
    buffer_load_ushort v38, v4, s[40:43], s49 offen
    s_add_u32 s49, s45, 247680
    buffer_load_ushort v39, v4, s[40:43], s49 offen
    s_add_u32 s49, s45, 267264
    buffer_load_ushort v40, v4, s[40:43], s49 offen
    s_add_u32 s49, s45, 268416
    buffer_load_ushort v41, v4, s[40:43], s49 offen
    s_add_u32 s49, s45, 288000
    buffer_load_ushort v42, v4, s[40:43], s49 offen
    s_add_u32 s49, s45, 289152
    buffer_load_ushort v43, v4, s[40:43], s49 offen
    s_add_u32 s49, s45, 308736
    buffer_load_ushort v44, v4, s[40:43], s49 offen
    s_add_u32 s49, s45, 309888
    buffer_load_ushort v45, v4, s[40:43], s49 offen
    s_add_u32 s49, s45, 329472
    buffer_load_ushort v46, v4, s[40:43], s49 offen
    s_add_u32 s49, s45, 330624
    buffer_load_ushort v47, v4, s[40:43], s49 offen
LPjoin_36:
    s_waitcnt vmcnt(24)
    v_lshl_or_b32 v16, v17, 16, v16
    v_lshl_or_b32 v17, v19, 16, v18
    v_lshl_or_b32 v18, v21, 16, v20
    v_lshl_or_b32 v19, v23, 16, v22
    buffer_store_dwordx4 v[16:19], v7, s[20:23], s48 offen offset:0 sc1
    s_waitcnt vmcnt(17)
    v_lshl_or_b32 v24, v25, 16, v24
    v_lshl_or_b32 v25, v27, 16, v26
    v_lshl_or_b32 v26, v29, 16, v28
    v_lshl_or_b32 v27, v31, 16, v30
    buffer_store_dwordx4 v[24:27], v7, s[20:23], s48 offen offset:128 sc1
    s_waitcnt vmcnt(10)
    v_lshl_or_b32 v32, v33, 16, v32
    v_lshl_or_b32 v33, v35, 16, v34
    v_lshl_or_b32 v34, v37, 16, v36
    v_lshl_or_b32 v35, v39, 16, v38
    buffer_store_dwordx4 v[32:35], v7, s[20:23], s48 offen offset:2304 sc1
    s_waitcnt vmcnt(3)
    v_lshl_or_b32 v40, v41, 16, v40
    v_lshl_or_b32 v41, v43, 16, v42
    v_lshl_or_b32 v42, v45, 16, v44
    v_lshl_or_b32 v43, v47, 16, v46
    buffer_store_dwordx4 v[40:43], v7, s[20:23], s48 offen offset:2432 sc1
LPdone_33:
    s_lshl_b32 s57, s32, 6
    s_add_u32 s57, s57, 217088
    s_waitcnt vmcnt(0)
    v_mov_b32 v10, s6
    v_mov_b32 v11, 0
    s_mov_b64 exec, 1
    buffer_store_dword v10, v11, s[20:23], s57 offen sc1
    s_mov_b64 exec, -1
LPlo_31:
    s_cmp_gt_u32 s3, 3
    s_cbranch_scc1 Ljoin_7
    v_add_u32 v11, 64, v1
    v_min_u32 v11, 71, v11
    v_lshlrev_b32 v10, 4, v1
    v_lshlrev_b32 v11, 4, v11
    s_and_b32 s56, s2, 7
    s_lshl_b32 s56, s56, 12
    s_add_u32 s56, s56, 102400
    s_mov_b32 s83, 0
Lpoll_37:
    buffer_load_dword v12, v10, s[20:23], s56 offen sc1
    buffer_load_dword v13, v11, s[20:23], s56 offen sc1
    s_add_u32 s83, s83, 1
    s_waitcnt vmcnt(0)
    v_xor_b32 v12, s6, v12
    v_xor_b32 v13, s6, v13
    v_or_b32 v12, v12, v13
    v_cmp_ne_u32 vcc, 0, v12
    s_cbranch_vccz Lpolld_38
    s_cmp_lt_u32 s83, 524288
    s_cbranch_scc1 Lpoll_37
Lpolld_38:
    s_mul_i32 s56, s5, 73728
    s_lshl_b32 s57, s3, 10
    s_add_u32 s56, s56, s57
    s_add_u32 s56, s56, 10932224
    buffer_load_dwordx4 v[160:163], v2, s[20:23], s56 offen sc1
    s_add_u32 s56, s56, 4096
    buffer_load_dwordx4 v[164:167], v2, s[20:23], s56 offen sc1
    s_add_u32 s56, s56, 4096
    buffer_load_dwordx4 v[168:171], v2, s[20:23], s56 offen sc1
    s_add_u32 s56, s56, 4096
    buffer_load_dwordx4 v[172:175], v2, s[20:23], s56 offen sc1
    s_add_u32 s56, s56, 4096
    buffer_load_dwordx4 v[176:179], v2, s[20:23], s56 offen sc1
    s_add_u32 s56, s56, 4096
    buffer_load_dwordx4 v[180:183], v2, s[20:23], s56 offen sc1
    s_add_u32 s56, s56, 4096
    buffer_load_dwordx4 v[184:187], v2, s[20:23], s56 offen sc1
    s_add_u32 s56, s56, 4096
    buffer_load_dwordx4 v[188:191], v2, s[20:23], s56 offen sc1
    s_add_u32 s56, s56, 4096
    buffer_load_dwordx4 v[192:195], v2, s[20:23], s56 offen sc1
    s_add_u32 s56, s56, 4096
    buffer_load_dwordx4 v[196:199], v2, s[20:23], s56 offen sc1
    s_add_u32 s56, s56, 4096
    buffer_load_dwordx4 v[200:203], v2, s[20:23], s56 offen sc1
    s_add_u32 s56, s56, 4096
    buffer_load_dwordx4 v[204:207], v2, s[20:23], s56 offen sc1
    s_add_u32 s56, s56, 4096
    buffer_load_dwordx4 v[208:211], v2, s[20:23], s56 offen sc1
    s_add_u32 s56, s56, 4096
    buffer_load_dwordx4 v[212:215], v2, s[20:23], s56 offen sc1
    s_add_u32 s56, s56, 4096
    buffer_load_dwordx4 v[216:219], v2, s[20:23], s56 offen sc1
    s_add_u32 s56, s56, 4096
    buffer_load_dwordx4 v[220:223], v2, s[20:23], s56 offen sc1
    s_add_u32 s56, s56, 4096
    buffer_load_dwordx4 v[224:227], v2, s[20:23], s56 offen sc1
    s_add_u32 s56, s56, 4096
    buffer_load_dwordx4 v[228:231], v2, s[20:23], s56 offen sc1
    s_add_u32 s56, s56, 4096
    s_mov_b32 s56, 0x3f803f80
    s_waitcnt vmcnt(17)
    v_dot2_f32_bf16 v12, v160, s56, 0
    v_dot2_f32_bf16 v13, v161, s56, 0
    v_dot2_f32_bf16 v12, v162, s56, v12
    v_dot2_f32_bf16 v13, v163, s56, v13
    s_waitcnt vmcnt(16)
    v_dot2_f32_bf16 v12, v164, s56, v12
    v_dot2_f32_bf16 v13, v165, s56, v13
    v_dot2_f32_bf16 v12, v166, s56, v12
    v_dot2_f32_bf16 v13, v167, s56, v13
    s_waitcnt vmcnt(15)
    v_dot2_f32_bf16 v12, v168, s56, v12
    v_dot2_f32_bf16 v13, v169, s56, v13
    v_dot2_f32_bf16 v12, v170, s56, v12
    v_dot2_f32_bf16 v13, v171, s56, v13
    s_waitcnt vmcnt(14)
    v_dot2_f32_bf16 v12, v172, s56, v12
    v_dot2_f32_bf16 v13, v173, s56, v13
    v_dot2_f32_bf16 v12, v174, s56, v12
    v_dot2_f32_bf16 v13, v175, s56, v13
    s_waitcnt vmcnt(13)
    v_dot2_f32_bf16 v12, v176, s56, v12
    v_dot2_f32_bf16 v13, v177, s56, v13
    v_dot2_f32_bf16 v12, v178, s56, v12
    v_dot2_f32_bf16 v13, v179, s56, v13
    s_waitcnt vmcnt(12)
    v_dot2_f32_bf16 v12, v180, s56, v12
    v_dot2_f32_bf16 v13, v181, s56, v13
    v_dot2_f32_bf16 v12, v182, s56, v12
    v_dot2_f32_bf16 v13, v183, s56, v13
    s_waitcnt vmcnt(11)
    v_dot2_f32_bf16 v12, v184, s56, v12
    v_dot2_f32_bf16 v13, v185, s56, v13
    v_dot2_f32_bf16 v12, v186, s56, v12
    v_dot2_f32_bf16 v13, v187, s56, v13
    s_waitcnt vmcnt(10)
    v_dot2_f32_bf16 v12, v188, s56, v12
    v_dot2_f32_bf16 v13, v189, s56, v13
    v_dot2_f32_bf16 v12, v190, s56, v12
    v_dot2_f32_bf16 v13, v191, s56, v13
    s_waitcnt vmcnt(9)
    v_dot2_f32_bf16 v12, v192, s56, v12
    v_dot2_f32_bf16 v13, v193, s56, v13
    v_dot2_f32_bf16 v12, v194, s56, v12
    v_dot2_f32_bf16 v13, v195, s56, v13
    s_waitcnt vmcnt(8)
    v_dot2_f32_bf16 v12, v196, s56, v12
    v_dot2_f32_bf16 v13, v197, s56, v13
    v_dot2_f32_bf16 v12, v198, s56, v12
    v_dot2_f32_bf16 v13, v199, s56, v13
    s_waitcnt vmcnt(7)
    v_dot2_f32_bf16 v12, v200, s56, v12
    v_dot2_f32_bf16 v13, v201, s56, v13
    v_dot2_f32_bf16 v12, v202, s56, v12
    v_dot2_f32_bf16 v13, v203, s56, v13
    s_waitcnt vmcnt(6)
    v_dot2_f32_bf16 v12, v204, s56, v12
    v_dot2_f32_bf16 v13, v205, s56, v13
    v_dot2_f32_bf16 v12, v206, s56, v12
    v_dot2_f32_bf16 v13, v207, s56, v13
    s_waitcnt vmcnt(5)
    v_dot2_f32_bf16 v12, v208, s56, v12
    v_dot2_f32_bf16 v13, v209, s56, v13
    v_dot2_f32_bf16 v12, v210, s56, v12
    v_dot2_f32_bf16 v13, v211, s56, v13
    s_waitcnt vmcnt(4)
    v_dot2_f32_bf16 v12, v212, s56, v12
    v_dot2_f32_bf16 v13, v213, s56, v13
    v_dot2_f32_bf16 v12, v214, s56, v12
    v_dot2_f32_bf16 v13, v215, s56, v13
    s_waitcnt vmcnt(3)
    v_dot2_f32_bf16 v12, v216, s56, v12
    v_dot2_f32_bf16 v13, v217, s56, v13
    v_dot2_f32_bf16 v12, v218, s56, v12
    v_dot2_f32_bf16 v13, v219, s56, v13
    s_waitcnt vmcnt(2)
    v_dot2_f32_bf16 v12, v220, s56, v12
    v_dot2_f32_bf16 v13, v221, s56, v13
    v_dot2_f32_bf16 v12, v222, s56, v12
    v_dot2_f32_bf16 v13, v223, s56, v13
    s_waitcnt vmcnt(1)
    v_dot2_f32_bf16 v12, v224, s56, v12
    v_dot2_f32_bf16 v13, v225, s56, v13
    v_dot2_f32_bf16 v12, v226, s56, v12
    v_dot2_f32_bf16 v13, v227, s56, v13
    s_waitcnt vmcnt(0)
    v_dot2_f32_bf16 v12, v228, s56, v12
    v_dot2_f32_bf16 v13, v229, s56, v13
    v_dot2_f32_bf16 v12, v230, s56, v12
    v_dot2_f32_bf16 v13, v231, s56, v13
    v_and_b32 v10, 31, v1
    s_and_b32 s56, s3, 1
    s_lshl_b32 s56, s56, 7
    s_add_u32 s56, s56, 85248
    v_add_f32 v12, v12, v13
    v_mov_b32 v13, v12
    v_lshl_add_u32 v10, v10, 2, s56
    s_nop 0
    v_permlane32_swap_b32 v12, v13
    v_add_f32 v12, v12, v13
    s_mov_b32 exec_hi, 0
    ds_add_f32 v10, v12
    s_mov_b32 exec_hi, -1
    s_lshl_b32 s56, s3, 10
    s_add_u32 s56, s56, 86016
    v_add_u32 v4, s56, v2
    v_add_u32 v5, 65536, v4
    ds_write_b128 v4, v[160:163] offset:0
    ds_write_b128 v4, v[164:167] offset:4096
    ds_write_b128 v4, v[168:171] offset:8192
    ds_write_b128 v4, v[172:175] offset:12288
    ds_write_b128 v4, v[176:179] offset:16384
    ds_write_b128 v4, v[180:183] offset:20480
    ds_write_b128 v4, v[184:187] offset:24576
    ds_write_b128 v4, v[188:191] offset:28672
    ds_write_b128 v4, v[192:195] offset:32768
    ds_write_b128 v4, v[196:199] offset:36864
    ds_write_b128 v4, v[200:203] offset:40960
    ds_write_b128 v4, v[204:207] offset:45056
    ds_write_b128 v4, v[208:211] offset:49152
    ds_write_b128 v4, v[212:215] offset:53248
    ds_write_b128 v4, v[216:219] offset:57344
    ds_write_b128 v4, v[220:223] offset:61440
    ds_write_b128 v5, v[224:227] offset:0
    ds_write_b128 v5, v[228:231] offset:4096
Ljoin_7:
    s_mov_b32 s49, s5
Ltop_8:
    v_and_b32 v3, 31, v1
    v_lshrrev_b32 v4, 5, v1
    s_lshl_b32 s8, s4, 3
    s_add_u32 s8, s8, s3
    s_mul_i32 s11, s8, 36864
    v_add_u32 v8, 86016, v2
    v_add_u32 v9, 151552, v2
    s_cmp_lg_u32 s7, 0
    s_cbranch_scc1 LGl1_39
    s_and_b32 s9, s3, 3
    s_lshr_b32 s10, s3, 2
    v_and_b32 v3, 31, v1
    v_lshrrev_b32 v4, 5, v1
    v_lshlrev_b32 v148, 2, v3
    v_lshlrev_b32 v156, 2, v1
    s_lshr_b32 s57, s3, 1
    s_mul_i32 s57, s57, 4864
    s_add_u32 s57, s57, 105472
    s_and_b32 s58, s3, 1
    s_lshl_b32 s59, s58, 10
    s_add_u32 s59, s59, s57
    v_add_u32 v144, s59, v2
    s_lshl_b32 s59, s58, 7
    s_add_u32 s59, s59, s57
    v_add_u32 v149, s59, v148
    s_mul_i32 s59, s58, 1280
    s_add_u32 s59, s59, s57
    v_add_u32 v150, s59, v2
    v_and_b32 v15, 1, v1
    v_mov_b32 v16, 0x05040100
    v_mov_b32 v17, 0x03020706
    v_cmp_eq_u32 vcc, 1, v15
    v_lshrrev_b32 v18, 1, v1
    v_mul_u32_u24 v18, 320, v18
    v_cndmask_b32 v146, v16, v17, vcc
    v_lshl_add_u32 v18, v15, 4, v18
    v_add_u32 v147, s59, v18
    v_lshrrev_b32 v17, 3, v3
    v_mul_u32_u24 v17, 320, v17
    v_and_b32 v18, 6, v3
    v_lshl_add_u32 v17, v18, 1, v17
    v_lshl_add_u32 v17, v15, 4, v17
    v_lshl_add_u32 v17, v4, 6, v17
    v_add_u32 v145, s59, v17
    s_lshl_b32 s59, s3, 10
    s_add_u32 s59, s59, 86016
    v_add_u32 v151, s59, v2
    s_lshl_b32 s59, s3, 7
    s_add_u32 s59, s59, 94208
    v_add_u32 v152, s59, v148
    s_lshl_b32 s59, s9, 11
    s_add_u32 s59, s59, 86016
    v_add_u32 v153, s59, v2
    s_lshl_b32 s59, s9, 8
    s_add_u32 s59, s59, 94208
    v_add_u32 v154, s59, v156
    v_min_u32 v17, 19, v3
    v_cmp_eq_u32 vcc, 22, v3
    v_mul_u32_u24 v18, 320, v4
    s_nop 0
    v_cndmask_b32 v17, v17, 18, vcc
    v_lshl_add_u32 v155, v17, 4, v18
    s_mul_i32 s57, s10, 4864
    s_add_u32 s57, s57, 86016
    v_add_u32 v157, s57, v2
    v_add_u32 v158, s57, v156
    v_add_u32 v159, s57, v155
    s_bfe_u32 s47, s2, 0x30003
    s_mul_i32 s47, s47, 82944
    s_lshl_b32 s48, s9, 10
    s_add_u32 s47, s47, s48
    s_add_u32 s47, s47, 13291520
    s_mul_i32 s42, s9, 4864
    s_add_u32 s42, s42, 86016
    s_mul_i32 s16, s5, 155648
    s_add_u32 s16, s16, s7
    s_add_u32 s16, s16, 16580608
    s_mul_i32 s57, s9, 4864
    s_add_u32 s41, s16, s57
    s_lshr_b32 s57, s3, 1
    s_mul_i32 s57, s57, 4864
    s_mul_i32 s58, s4, 19456
    s_add_u32 s57, s57, s58
    s_add_u32 s57, s57, s16
    s_and_b32 s58, s3, 1
    s_lshl_b32 s24, s58, 10
    s_add_u32 s24, s24, s57
    s_lshl_b32 s17, s58, 7
    s_add_u32 s17, s17, s57
    s_mul_i32 s25, s58, 1280
    s_add_u32 s25, s25, s57
    s_lshl_b32 s27, s5, 12
    s_add_u32 s27, s27, s7
    s_add_u32 s27, s27, 16318464
    s_lshl_b32 s18, s8, 6
    s_add_u32 s18, s18, s27
    s_lshl_b32 s57, s4, 3
    s_lshl_b32 s58, s9, 1
    s_add_u32 s57, s57, s58
    s_add_u32 s57, s57, s10
    s_lshr_b32 s58, s5, 1
    s_lshl_b32 s59, s57, 5
    s_add_u32 s58, s58, s59
    s_lshl_b32 s58, s58, 10
    s_and_b32 s59, s5, 1
    s_lshl_b32 s59, s59, 9
    s_add_u32 s50, s58, s59
    s_add_u32 s50, s50, s7
    s_add_u32 s50, s50, 21561344
    s_lshl_b32 s58, s57, 12
    s_lshr_b32 s59, s5, 2
    s_lshl_b32 s59, s59, 8
    s_add_u32 s58, s58, s59
    s_and_b32 s59, s5, 3
    s_lshl_b32 s59, s59, 2
    s_add_u32 s51, s58, s59
    s_add_u32 s51, s51, s7
    s_add_u32 s51, s51, 23658496
    s_lshl_b32 s57, s57, 5
    s_add_u32 s57, s57, s5
    s_lshl_b32 s52, s57, 6
    s_add_u32 s52, s52, s7
    s_add_u32 s52, s52, 16449536
    s_mov_b32 s40, 2
    s_cmp_eq_u32 s7, 0
    s_cselect_b32 s29, 0, 8
    s_add_u32 s29, s29, 85504
    s_add_u32 s30, s4, 1
    s_and_b32 s30, s30, 7
    s_lshl_b32 s30, s30, 3
    s_add_u32 s46, s30, 8
    s_and_b32 s46, s46, 63
    s_mov_b32 s31, 0
    s_mul_i32 s45, s9, 2432
    s_lshr_b32 s57, s30, 3
    s_mul_i32 s57, s57, 19456
    s_add_u32 s57, s57, s16
    s_add_u32 s44, s57, s45
    s_add_u32 s45, s45, 124928
    s_cmp_eq_u32 s10, 0
    s_cselect_b32 s28, 0, 2
    s_mov_b32 s57, s41
    s_add_u32 s58, s4, 3
    s_and_b32 s58, s58, 7
    s_mul_i32 s58, s58, 19456
    s_add_u32 s63, s58, s57
    s_add_u32 s58, s4, 4
    s_and_b32 s58, s58, 7
    s_mul_i32 s58, s58, 19456
    s_add_u32 s64, s58, s57
    s_add_u32 s58, s4, 5
    s_and_b32 s58, s58, 7
    s_mul_i32 s58, s58, 19456
    s_add_u32 s65, s58, s57
    s_add_u32 s58, s4, 6
    s_and_b32 s58, s58, 7
    s_mul_i32 s58, s58, 19456
    s_add_u32 s66, s58, s57
    s_add_u32 s58, s4, 7
    s_and_b32 s58, s58, 7
    s_mul_i32 s58, s58, 19456
    s_add_u32 s67, s58, s57
    s_mov_b32 s14, 0x3ae38e39
    s_mov_b32 s15, 0x3eae1a93
    v_and_b32 v10, 255, v0
    s_mov_b32 s56, 161
    s_cmp_gt_u32 s3, 3
    s_cselect_b32 s56, s56, 143
    v_min_u32 v10, s56, v10
    s_cselect_b32 s56, 6, 4
    v_lshlrev_b32 v10, s56, v10
    s_and_b32 s57, s2, 7
    s_lshl_b32 s57, s57, 12
    s_add_u32 s57, s57, 69632
    s_cmp_gt_u32 s3, 3
    s_cselect_b32 s56, 217088, s57
    s_add_u32 s11, s11, 6217728
    s_add_u32 s12, s20, s11
    s_addc_u32 s13, s21, 0
    s_and_b32 s57, s2, 7
    s_lshl_b32 s57, s57, 6
    s_add_u32 s57, s57, 200704
    v_lshlrev_b32 v105, 9, v3
    s_lshl_b32 s58, s4, 3
    s_lshr_b32 s59, s5, 2
    s_add_u32 s58, s58, s59
    s_lshl_b32 s58, s58, 2
    s_and_b32 s59, s5, 3
    s_add_u32 s58, s58, s59
    s_mul_i32 s60, s58, 9216
    s_lshl_b32 s61, s3, 10
    s_add_u32 s60, s60, s61
    s_add_u32 s60, s60, 6213632
    v_mov_b32 v100, 0
    v_mov_b32 v101, 0
    v_mov_b32 v102, 0
    v_mov_b32 v103, 0
    s_lshl_b32 s58, s58, 8
    s_add_u32 s58, s58, 135168
    v_lshrrev_b32 v12, 4, v1
    v_and_b32 v11, 7, v1
    v_lshl_add_u32 v12, v11, 2, v12
    s_lshl_b32 s59, s3, 7
    s_add_u32 s59, s59, 159744
    v_lshl_add_u32 v104, v12, 2, s59
    s_mov_b32 s83, 0
Lpoll_41:
    buffer_load_dword v11, v10, s[20:23], s56 offen sc1
    s_add_u32 s83, s83, 1
    s_waitcnt vmcnt(0)
    v_cmp_ne_u32 vcc, s6, v11
    s_cbranch_vccz Lpolld_42
    s_cmp_lt_u32 s83, 524288
    s_cbranch_scc1 Lpoll_41
Lpolld_42:
Lnwo_43:
    s_waitcnt lgkmcnt(0)
    s_barrier
    buffer_load_dwordx4 v[96:99], v2, s[20:23], s60 offen sc1
    s_cmp_lg_u32 s3, 7
    s_cbranch_scc1 LGnsq_47
    buffer_load_dwordx4 v[100:103], v2, s[20:23], s60 offen offset:1024 sc1
LGnsq_47:
    global_load_dword v64, v156, s[12:13] offset:-4096 sc1
    global_load_dword v65, v156, s[12:13] offset:-3840 sc1
    global_load_dword v66, v156, s[12:13] offset:-3584 sc1
    global_load_dword v67, v156, s[12:13] offset:-3328 sc1
    global_load_dword v68, v156, s[12:13] offset:-3072 sc1
    global_load_dword v69, v156, s[12:13] offset:-2816 sc1
    global_load_dword v70, v156, s[12:13] offset:-2560 sc1
    global_load_dword v71, v156, s[12:13] offset:-2304 sc1
    global_load_dword v72, v156, s[12:13] offset:-2048 sc1
    global_load_dword v73, v156, s[12:13] offset:-1792 sc1
    global_load_dword v74, v156, s[12:13] offset:-1536 sc1
    global_load_dword v75, v156, s[12:13] offset:-1280 sc1
    global_load_dword v76, v156, s[12:13] offset:-1024 sc1
    global_load_dword v77, v156, s[12:13] offset:-768 sc1
    global_load_dword v78, v156, s[12:13] offset:-512 sc1
    global_load_dword v79, v156, s[12:13] offset:-256 sc1
    global_load_dword v80, v156, s[12:13] offset:0 sc1
    global_load_dword v81, v156, s[12:13] offset:256 sc1
    global_load_dword v82, v156, s[12:13] offset:512 sc1
    global_load_dword v83, v156, s[12:13] offset:768 sc1
    global_load_dword v84, v156, s[12:13] offset:1024 sc1
    global_load_dword v85, v156, s[12:13] offset:1280 sc1
    global_load_dword v86, v156, s[12:13] offset:1536 sc1
    global_load_dword v87, v156, s[12:13] offset:1792 sc1
    v_lshlrev_b32 v10, 4, v4
    v_add_u32 v10, 85248, v10
    ds_read_b128 v[116:119], v10 offset:0
    ds_read_b128 v[120:123], v10 offset:32
    ds_read_b128 v[124:127], v10 offset:64
    ds_read_b128 v[128:131], v10 offset:96
    ds_read_b128 v[132:135], v10 offset:128
    ds_read_b128 v[136:139], v10 offset:160
    ds_read_b128 v[140:143], v10 offset:192
    s_lshl_b32 s62, s8, 10
    s_add_u32 s62, s62, 135168
    v_lshlrev_b32 v6, 3, v3
    v_lshl_add_u32 v6, v4, 9, v6
    ds_read_b128 v[16:19], v8 offset:0
    ds_read_b128 v[20:23], v8 offset:1024
    ds_read_b128 v[24:27], v8 offset:2048
    ds_read_b128 v[28:31], v8 offset:3072
    s_waitcnt vmcnt(20) lgkmcnt(2)
    v_mfma_f32_32x32x16_bf16 v[48:63], v[20:23], v[64:67], 0
    v_mfma_f32_32x32x16_bf16 v[32:47], v[16:19], v[64:67], 0
    global_load_dword v64, v156, s[12:13] offset:2048 sc1
    global_load_dword v65, v156, s[12:13] offset:2304 sc1
    global_load_dword v66, v156, s[12:13] offset:2560 sc1
    global_load_dword v67, v156, s[12:13] offset:2816 sc1
    buffer_load_dword v5, v105, s[20:23], s57 offen sc1
    v_dot2_f32_bf16 v112, v96, v96, 0
    v_dot2_f32_bf16 v113, v97, v97, 0
    v_dot2_f32_bf16 v114, v98, v98, 0
    v_dot2_f32_bf16 v115, v99, v99, 0
    v_dot2_f32_bf16 v112, v100, v100, v112
    v_dot2_f32_bf16 v113, v101, v101, v113
    v_dot2_f32_bf16 v114, v102, v102, v114
    v_dot2_f32_bf16 v115, v103, v103, v115
    s_nop 1
    v_permlane32_swap_b32 v112, v114
    v_permlane32_swap_b32 v113, v115
    v_add_f32 v112, v112, v114
    v_add_f32 v113, v113, v115
    s_nop 1
    v_permlane16_swap_b32 v112, v113
    v_add_f32 v112, v112, v113
    s_nop 1
    v_add_f32_dpp v112, v112, v112 row_ror:8 row_mask:0xf bank_mask:0xf
    ds_write_b32 v104, v112
    ds_read_b128 v[16:19], v8 offset:4096
    ds_read_b128 v[20:23], v8 offset:5120
    s_waitcnt vmcnt(20) lgkmcnt(2)
    v_mfma_f32_32x32x16_bf16 v[48:63], v[28:31], v[68:71], v[48:63]
    v_mfma_f32_32x32x16_bf16 v[32:47], v[24:27], v[68:71], v[32:47]
    global_load_dword v68, v156, s[12:13] offset:3072 sc1
    global_load_dword v69, v156, s[12:13] offset:3328 sc1
    global_load_dword v70, v156, s[12:13] offset:3584 sc1
    global_load_dword v71, v156, s[12:13] offset:3840 sc1
    s_add_u32 s12, s12, 8192
    s_addc_u32 s13, s13, 0
    ds_read_b128 v[24:27], v8 offset:6144
    ds_read_b128 v[28:31], v8 offset:7168
    s_waitcnt vmcnt(20) lgkmcnt(2)
    v_mfma_f32_32x32x16_bf16 v[48:63], v[20:23], v[72:75], v[48:63]
    v_mfma_f32_32x32x16_bf16 v[32:47], v[16:19], v[72:75], v[32:47]
    global_load_dword v72, v156, s[12:13] offset:-4096 sc1
    global_load_dword v73, v156, s[12:13] offset:-3840 sc1
    global_load_dword v74, v156, s[12:13] offset:-3584 sc1
    global_load_dword v75, v156, s[12:13] offset:-3328 sc1
    ds_read_b128 v[16:19], v8 offset:8192
    ds_read_b128 v[20:23], v8 offset:9216
    s_waitcnt vmcnt(20) lgkmcnt(2)
    v_mfma_f32_32x32x16_bf16 v[48:63], v[28:31], v[76:79], v[48:63]
    v_mfma_f32_32x32x16_bf16 v[32:47], v[24:27], v[76:79], v[32:47]
    global_load_dword v76, v156, s[12:13] offset:-3072 sc1
    global_load_dword v77, v156, s[12:13] offset:-2816 sc1
    global_load_dword v78, v156, s[12:13] offset:-2560 sc1
    global_load_dword v79, v156, s[12:13] offset:-2304 sc1
    ds_read_b128 v[24:27], v8 offset:10240
    ds_read_b128 v[28:31], v8 offset:11264
    s_waitcnt vmcnt(20) lgkmcnt(2)
    v_mfma_f32_32x32x16_bf16 v[48:63], v[20:23], v[80:83], v[48:63]
    v_mfma_f32_32x32x16_bf16 v[32:47], v[16:19], v[80:83], v[32:47]
    global_load_dword v80, v156, s[12:13] offset:-2048 sc1
    global_load_dword v81, v156, s[12:13] offset:-1792 sc1
    global_load_dword v82, v156, s[12:13] offset:-1536 sc1
    global_load_dword v83, v156, s[12:13] offset:-1280 sc1
    ds_read_b128 v[16:19], v8 offset:12288
    ds_read_b128 v[20:23], v8 offset:13312
    s_waitcnt vmcnt(20) lgkmcnt(2)
    v_mfma_f32_32x32x16_bf16 v[48:63], v[28:31], v[84:87], v[48:63]
    v_mfma_f32_32x32x16_bf16 v[32:47], v[24:27], v[84:87], v[32:47]
    global_load_dword v84, v156, s[12:13] offset:-1024 sc1
    global_load_dword v85, v156, s[12:13] offset:-768 sc1
    global_load_dword v86, v156, s[12:13] offset:-512 sc1
    global_load_dword v87, v156, s[12:13] offset:-256 sc1
    ds_read_b128 v[24:27], v8 offset:14336
    ds_read_b128 v[28:31], v8 offset:15360
    s_waitcnt vmcnt(20) lgkmcnt(2)
    v_mfma_f32_32x32x16_bf16 v[48:63], v[20:23], v[64:67], v[48:63]
    v_mfma_f32_32x32x16_bf16 v[32:47], v[16:19], v[64:67], v[32:47]
    global_load_dword v64, v156, s[12:13] offset:0 sc1
    global_load_dword v65, v156, s[12:13] offset:256 sc1
    global_load_dword v66, v156, s[12:13] offset:512 sc1
    global_load_dword v67, v156, s[12:13] offset:768 sc1
    ds_read_b128 v[16:19], v8 offset:16384
    ds_read_b128 v[20:23], v8 offset:17408
    s_waitcnt vmcnt(20) lgkmcnt(2)
    v_mfma_f32_32x32x16_bf16 v[48:63], v[28:31], v[68:71], v[48:63]
    v_mfma_f32_32x32x16_bf16 v[32:47], v[24:27], v[68:71], v[32:47]
    global_load_dword v68, v156, s[12:13] offset:1024 sc1
    global_load_dword v69, v156, s[12:13] offset:1280 sc1
    global_load_dword v70, v156, s[12:13] offset:1536 sc1
    global_load_dword v71, v156, s[12:13] offset:1792 sc1
    ds_read_b128 v[24:27], v8 offset:18432
    ds_read_b128 v[28:31], v8 offset:19456
    s_waitcnt vmcnt(20) lgkmcnt(2)
    v_mfma_f32_32x32x16_bf16 v[48:63], v[20:23], v[72:75], v[48:63]
    v_mfma_f32_32x32x16_bf16 v[32:47], v[16:19], v[72:75], v[32:47]
    global_load_dword v72, v156, s[12:13] offset:2048 sc1
    global_load_dword v73, v156, s[12:13] offset:2304 sc1
    global_load_dword v74, v156, s[12:13] offset:2560 sc1
    global_load_dword v75, v156, s[12:13] offset:2816 sc1
    ds_read_b128 v[16:19], v8 offset:20480
    ds_read_b128 v[20:23], v8 offset:21504
    s_waitcnt vmcnt(20) lgkmcnt(2)
    v_mfma_f32_32x32x16_bf16 v[48:63], v[28:31], v[76:79], v[48:63]
    v_mfma_f32_32x32x16_bf16 v[32:47], v[24:27], v[76:79], v[32:47]
    global_load_dword v76, v156, s[12:13] offset:3072 sc1
    global_load_dword v77, v156, s[12:13] offset:3328 sc1
    global_load_dword v78, v156, s[12:13] offset:3584 sc1
    global_load_dword v79, v156, s[12:13] offset:3840 sc1
    s_add_u32 s12, s12, 8192
    s_addc_u32 s13, s13, 0
    ds_read_b128 v[24:27], v8 offset:22528
    ds_read_b128 v[28:31], v8 offset:23552
    s_waitcnt vmcnt(20) lgkmcnt(2)
    v_mfma_f32_32x32x16_bf16 v[48:63], v[20:23], v[80:83], v[48:63]
    v_mfma_f32_32x32x16_bf16 v[32:47], v[16:19], v[80:83], v[32:47]
    global_load_dword v80, v156, s[12:13] offset:-4096 sc1
    global_load_dword v81, v156, s[12:13] offset:-3840 sc1
    global_load_dword v82, v156, s[12:13] offset:-3584 sc1
    global_load_dword v83, v156, s[12:13] offset:-3328 sc1
    ds_read_b128 v[16:19], v8 offset:24576
    ds_read_b128 v[20:23], v8 offset:25600
    s_waitcnt vmcnt(20) lgkmcnt(2)
    v_mfma_f32_32x32x16_bf16 v[48:63], v[28:31], v[84:87], v[48:63]
    v_mfma_f32_32x32x16_bf16 v[32:47], v[24:27], v[84:87], v[32:47]
    global_load_dword v84, v156, s[12:13] offset:-3072 sc1
    global_load_dword v85, v156, s[12:13] offset:-2816 sc1
    global_load_dword v86, v156, s[12:13] offset:-2560 sc1
    global_load_dword v87, v156, s[12:13] offset:-2304 sc1
    ds_read_b128 v[24:27], v8 offset:26624
    ds_read_b128 v[28:31], v8 offset:27648
    s_waitcnt vmcnt(20) lgkmcnt(2)
    v_mfma_f32_32x32x16_bf16 v[48:63], v[20:23], v[64:67], v[48:63]
    v_mfma_f32_32x32x16_bf16 v[32:47], v[16:19], v[64:67], v[32:47]
    global_load_dword v64, v156, s[12:13] offset:-2048 sc1
    global_load_dword v65, v156, s[12:13] offset:-1792 sc1
    global_load_dword v66, v156, s[12:13] offset:-1536 sc1
    global_load_dword v67, v156, s[12:13] offset:-1280 sc1
    ds_read_b128 v[16:19], v8 offset:28672
    ds_read_b128 v[20:23], v8 offset:29696
    s_waitcnt vmcnt(20) lgkmcnt(2)
    v_mfma_f32_32x32x16_bf16 v[48:63], v[28:31], v[68:71], v[48:63]
    v_mfma_f32_32x32x16_bf16 v[32:47], v[24:27], v[68:71], v[32:47]
    global_load_dword v68, v156, s[12:13] offset:-1024 sc1
    global_load_dword v69, v156, s[12:13] offset:-768 sc1
    global_load_dword v70, v156, s[12:13] offset:-512 sc1
    global_load_dword v71, v156, s[12:13] offset:-256 sc1
    ds_read_b128 v[24:27], v8 offset:30720
    ds_read_b128 v[28:31], v8 offset:31744
    s_waitcnt vmcnt(20) lgkmcnt(2)
    v_mfma_f32_32x32x16_bf16 v[48:63], v[20:23], v[72:75], v[48:63]
    v_mfma_f32_32x32x16_bf16 v[32:47], v[16:19], v[72:75], v[32:47]
    global_load_dword v72, v156, s[12:13] offset:0 sc1
    global_load_dword v73, v156, s[12:13] offset:256 sc1
    global_load_dword v74, v156, s[12:13] offset:512 sc1
    global_load_dword v75, v156, s[12:13] offset:768 sc1
    ds_read_b128 v[16:19], v8 offset:32768
    ds_read_b128 v[20:23], v8 offset:33792
    s_waitcnt vmcnt(20) lgkmcnt(2)
    v_mfma_f32_32x32x16_bf16 v[48:63], v[28:31], v[76:79], v[48:63]
    v_mfma_f32_32x32x16_bf16 v[32:47], v[24:27], v[76:79], v[32:47]
    global_load_dword v76, v156, s[12:13] offset:1024 sc1
    global_load_dword v77, v156, s[12:13] offset:1280 sc1
    global_load_dword v78, v156, s[12:13] offset:1536 sc1
    global_load_dword v79, v156, s[12:13] offset:1792 sc1
    ds_read_b128 v[24:27], v8 offset:34816
    ds_read_b128 v[28:31], v8 offset:35840
    s_waitcnt vmcnt(20) lgkmcnt(2)
    v_mfma_f32_32x32x16_bf16 v[48:63], v[20:23], v[80:83], v[48:63]
    v_mfma_f32_32x32x16_bf16 v[32:47], v[16:19], v[80:83], v[32:47]
    global_load_dword v80, v156, s[12:13] offset:2048 sc1
    global_load_dword v81, v156, s[12:13] offset:2304 sc1
    global_load_dword v82, v156, s[12:13] offset:2560 sc1
    global_load_dword v83, v156, s[12:13] offset:2816 sc1
    ds_read_b128 v[16:19], v8 offset:36864
    ds_read_b128 v[20:23], v8 offset:37888
    s_waitcnt vmcnt(20) lgkmcnt(2)
    v_mfma_f32_32x32x16_bf16 v[48:63], v[28:31], v[84:87], v[48:63]
    v_mfma_f32_32x32x16_bf16 v[32:47], v[24:27], v[84:87], v[32:47]
    global_load_dword v84, v156, s[12:13] offset:3072 sc1
    global_load_dword v85, v156, s[12:13] offset:3328 sc1
    global_load_dword v86, v156, s[12:13] offset:3584 sc1
    global_load_dword v87, v156, s[12:13] offset:3840 sc1
    s_add_u32 s12, s12, 8192
    s_addc_u32 s13, s13, 0
    ds_read_b128 v[24:27], v8 offset:38912
    ds_read_b128 v[28:31], v8 offset:39936
    s_waitcnt vmcnt(20) lgkmcnt(2)
    v_mfma_f32_32x32x16_bf16 v[48:63], v[20:23], v[64:67], v[48:63]
    v_mfma_f32_32x32x16_bf16 v[32:47], v[16:19], v[64:67], v[32:47]
    global_load_dword v64, v156, s[12:13] offset:-4096 sc1
    global_load_dword v65, v156, s[12:13] offset:-3840 sc1
    global_load_dword v66, v156, s[12:13] offset:-3584 sc1
    global_load_dword v67, v156, s[12:13] offset:-3328 sc1
    ds_read_b128 v[16:19], v8 offset:40960
    ds_read_b128 v[20:23], v8 offset:41984
    s_waitcnt vmcnt(20) lgkmcnt(2)
    v_mfma_f32_32x32x16_bf16 v[48:63], v[28:31], v[68:71], v[48:63]
    v_mfma_f32_32x32x16_bf16 v[32:47], v[24:27], v[68:71], v[32:47]
    global_load_dword v68, v156, s[12:13] offset:-3072 sc1
    global_load_dword v69, v156, s[12:13] offset:-2816 sc1
    global_load_dword v70, v156, s[12:13] offset:-2560 sc1
    global_load_dword v71, v156, s[12:13] offset:-2304 sc1
    ds_read_b128 v[24:27], v8 offset:43008
    ds_read_b128 v[28:31], v8 offset:44032
    s_waitcnt vmcnt(20) lgkmcnt(2)
    s_barrier
    v_mfma_f32_32x32x16_bf16 v[48:63], v[20:23], v[72:75], v[48:63]
    v_mfma_f32_32x32x16_bf16 v[32:47], v[16:19], v[72:75], v[32:47]
    global_load_dword v72, v156, s[12:13] offset:-2048 sc1
    global_load_dword v73, v156, s[12:13] offset:-1792 sc1
    global_load_dword v74, v156, s[12:13] offset:-1536 sc1
    global_load_dword v75, v156, s[12:13] offset:-1280 sc1
    s_cmp_eq_u32 s3, 0
    s_cbranch_scc1 LGsq_45
LGsqb_46:
    ds_read_b128 v[16:19], v8 offset:45056
    ds_read_b128 v[20:23], v8 offset:46080
    s_waitcnt vmcnt(20) lgkmcnt(2)
    v_mfma_f32_32x32x16_bf16 v[48:63], v[28:31], v[76:79], v[48:63]
    v_mfma_f32_32x32x16_bf16 v[32:47], v[24:27], v[76:79], v[32:47]
    global_load_dword v76, v156, s[12:13] offset:-1024 sc1
    global_load_dword v77, v156, s[12:13] offset:-768 sc1
    global_load_dword v78, v156, s[12:13] offset:-512 sc1
    global_load_dword v79, v156, s[12:13] offset:-256 sc1
    ds_read_b128 v[24:27], v8 offset:47104
    ds_read_b128 v[28:31], v8 offset:48128
    s_waitcnt vmcnt(20) lgkmcnt(2)
    v_mfma_f32_32x32x16_bf16 v[48:63], v[20:23], v[80:83], v[48:63]
    v_mfma_f32_32x32x16_bf16 v[32:47], v[16:19], v[80:83], v[32:47]
    global_load_dword v80, v156, s[12:13] offset:0 sc1
    global_load_dword v81, v156, s[12:13] offset:256 sc1
    global_load_dword v82, v156, s[12:13] offset:512 sc1
    global_load_dword v83, v156, s[12:13] offset:768 sc1
    ds_read_b128 v[16:19], v8 offset:49152
    ds_read_b128 v[20:23], v8 offset:50176
    s_waitcnt vmcnt(20) lgkmcnt(2)
    v_mfma_f32_32x32x16_bf16 v[48:63], v[28:31], v[84:87], v[48:63]
    v_mfma_f32_32x32x16_bf16 v[32:47], v[24:27], v[84:87], v[32:47]
    global_load_dword v84, v156, s[12:13] offset:1024 sc1
    global_load_dword v85, v156, s[12:13] offset:1280 sc1
    global_load_dword v86, v156, s[12:13] offset:1536 sc1
    global_load_dword v87, v156, s[12:13] offset:1792 sc1
    ds_read_b128 v[24:27], v8 offset:51200
    ds_read_b128 v[28:31], v8 offset:52224
    s_waitcnt vmcnt(20) lgkmcnt(2)
    v_mfma_f32_32x32x16_bf16 v[48:63], v[20:23], v[64:67], v[48:63]
    v_mfma_f32_32x32x16_bf16 v[32:47], v[16:19], v[64:67], v[32:47]
    global_load_dword v64, v156, s[12:13] offset:2048 sc1
    global_load_dword v65, v156, s[12:13] offset:2304 sc1
    global_load_dword v66, v156, s[12:13] offset:2560 sc1
    global_load_dword v67, v156, s[12:13] offset:2816 sc1
    ds_read_b128 v[16:19], v8 offset:53248
    ds_read_b128 v[20:23], v8 offset:54272
    s_waitcnt vmcnt(20) lgkmcnt(2)
    v_mfma_f32_32x32x16_bf16 v[48:63], v[28:31], v[68:71], v[48:63]
    v_mfma_f32_32x32x16_bf16 v[32:47], v[24:27], v[68:71], v[32:47]
    global_load_dword v68, v156, s[12:13] offset:3072 sc1
    global_load_dword v69, v156, s[12:13] offset:3328 sc1
    global_load_dword v70, v156, s[12:13] offset:3584 sc1
    global_load_dword v71, v156, s[12:13] offset:3840 sc1
    s_add_u32 s12, s12, 8192
    s_addc_u32 s13, s13, 0
    ds_read_b128 v[24:27], v8 offset:55296
    ds_read_b128 v[28:31], v8 offset:56320
    s_waitcnt vmcnt(20) lgkmcnt(2)
    v_mfma_f32_32x32x16_bf16 v[48:63], v[20:23], v[72:75], v[48:63]
    v_mfma_f32_32x32x16_bf16 v[32:47], v[16:19], v[72:75], v[32:47]
    global_load_dword v72, v156, s[12:13] offset:-4096 sc1
    global_load_dword v73, v156, s[12:13] offset:-3840 sc1
    global_load_dword v74, v156, s[12:13] offset:-3584 sc1
    global_load_dword v75, v156, s[12:13] offset:-3328 sc1
    ds_read_b128 v[16:19], v8 offset:57344
    ds_read_b128 v[20:23], v8 offset:58368
    s_waitcnt vmcnt(20) lgkmcnt(2)
    v_mfma_f32_32x32x16_bf16 v[48:63], v[28:31], v[76:79], v[48:63]
    v_mfma_f32_32x32x16_bf16 v[32:47], v[24:27], v[76:79], v[32:47]
    global_load_dword v76, v156, s[12:13] offset:-3072 sc1
    global_load_dword v77, v156, s[12:13] offset:-2816 sc1
    global_load_dword v78, v156, s[12:13] offset:-2560 sc1
    global_load_dword v79, v156, s[12:13] offset:-2304 sc1
    ds_read_b128 v[24:27], v8 offset:59392
    ds_read_b128 v[28:31], v8 offset:60416
    s_waitcnt vmcnt(20) lgkmcnt(2)
    v_mfma_f32_32x32x16_bf16 v[48:63], v[20:23], v[80:83], v[48:63]
    v_mfma_f32_32x32x16_bf16 v[32:47], v[16:19], v[80:83], v[32:47]
    global_load_dword v80, v156, s[12:13] offset:-2048 sc1
    global_load_dword v81, v156, s[12:13] offset:-1792 sc1
    global_load_dword v82, v156, s[12:13] offset:-1536 sc1
    global_load_dword v83, v156, s[12:13] offset:-1280 sc1
    ds_read_b128 v[16:19], v8 offset:61440
    ds_read_b128 v[20:23], v8 offset:62464
    s_waitcnt vmcnt(20) lgkmcnt(2)
    v_mfma_f32_32x32x16_bf16 v[48:63], v[28:31], v[84:87], v[48:63]
    v_mfma_f32_32x32x16_bf16 v[32:47], v[24:27], v[84:87], v[32:47]
    global_load_dword v84, v156, s[12:13] offset:-1024 sc1
    global_load_dword v85, v156, s[12:13] offset:-768 sc1
    global_load_dword v86, v156, s[12:13] offset:-512 sc1
    global_load_dword v87, v156, s[12:13] offset:-256 sc1
    ds_read_b128 v[24:27], v8 offset:63488
    ds_read_b128 v[28:31], v8 offset:64512
    s_waitcnt vmcnt(20) lgkmcnt(2)
    v_mfma_f32_32x32x16_bf16 v[48:63], v[20:23], v[64:67], v[48:63]
    v_mfma_f32_32x32x16_bf16 v[32:47], v[16:19], v[64:67], v[32:47]
    ds_read_b128 v[16:19], v9 offset:0
    ds_read_b128 v[20:23], v9 offset:1024
    s_waitcnt vmcnt(16) lgkmcnt(2)
    v_mfma_f32_32x32x16_bf16 v[48:63], v[28:31], v[68:71], v[48:63]
    v_mfma_f32_32x32x16_bf16 v[32:47], v[24:27], v[68:71], v[32:47]
    ds_read_b128 v[24:27], v9 offset:2048
    ds_read_b128 v[28:31], v9 offset:3072
    s_waitcnt vmcnt(12) lgkmcnt(2)
    v_mfma_f32_32x32x16_bf16 v[48:63], v[20:23], v[72:75], v[48:63]
    v_mfma_f32_32x32x16_bf16 v[32:47], v[16:19], v[72:75], v[32:47]
    buffer_load_dwordx2 v[12:13], v6, s[20:23], s62 offen sc1
    buffer_load_dwordx2 v[14:15], v6, s[20:23], s62 offen offset:256 sc1
    ds_read_b128 v[16:19], v9 offset:4096
    ds_read_b128 v[20:23], v9 offset:5120
    s_waitcnt vmcnt(10) lgkmcnt(2)
    v_mfma_f32_32x32x16_bf16 v[48:63], v[28:31], v[76:79], v[48:63]
    v_mfma_f32_32x32x16_bf16 v[32:47], v[24:27], v[76:79], v[32:47]
    ds_read_b128 v[24:27], v9 offset:6144
    ds_read_b128 v[28:31], v9 offset:7168
    s_waitcnt vmcnt(6) lgkmcnt(2)
    v_mfma_f32_32x32x16_bf16 v[48:63], v[20:23], v[80:83], v[48:63]
    v_mfma_f32_32x32x16_bf16 v[32:47], v[16:19], v[80:83], v[32:47]
    s_waitcnt vmcnt(0) lgkmcnt(0)
    v_mfma_f32_32x32x16_bf16 v[48:63], v[28:31], v[84:87], v[48:63]
    v_mfma_f32_32x32x16_bf16 v[32:47], v[24:27], v[84:87], v[32:47]
    s_getreg_b32 s56, hwreg(HW_REG_XCC_ID, 0, 4)
    v_cmp_ne_u32 vcc, s56, v5
    s_nop 0
    s_cmp_eq_u64 vcc, 0
    s_cselect_b32 s53, 1, 0
    s_mov_b32 s83, 0
LGsag_49:
    v_xor_b32 v13, s6, v13
    v_xor_b32 v15, s6, v15
    v_or_b32 v13, v13, v15
    v_cmp_ne_u32 vcc, 0, v13
    s_cbranch_vccz LGsok_48
    buffer_load_dwordx2 v[12:13], v6, s[20:23], s62 offen sc1
    buffer_load_dwordx2 v[14:15], v6, s[20:23], s62 offen offset:256 sc1
    s_add_u32 s83, s83, 1
    s_waitcnt vmcnt(0)
    s_cmp_lt_u32 s83, 524288
    s_cbranch_scc1 LGsag_49
LGsok_48:
    v_add_f32 v7, v12, v14
    v_mov_b32 v9, v7
    s_nop 1
    v_permlane32_swap_b32 v7, v9
    v_add_f32 v7, v7, v9
    s_branch LGepi_40
LGl1_39:
    v_lshlrev_b32 v10, 3, v3
    v_lshl_add_u32 v10, v4, 10, v10
    s_lshl_b32 s56, s8, 11
    s_and_b32 s57, s2, 0
    s_lshl_b32 s57, s57, 17
    s_add_u32 s56, s56, s57
    s_add_u32 s56, s56, 249856
    s_add_u32 s12, s11, 13959168
    s_waitcnt lgkmcnt(0)
    s_barrier
    buffer_load_dwordx2 v[32:33], v10, s[20:23], s56 offen offset:0 sc1
    buffer_load_dwordx2 v[34:35], v10, s[20:23], s56 offen offset:256 sc1
    buffer_load_dwordx2 v[36:37], v10, s[20:23], s56 offen offset:512 sc1
    buffer_load_dwordx2 v[38:39], v10, s[20:23], s56 offen offset:768 sc1
    s_mul_i32 s16, s5, 155648
    s_add_u32 s16, s16, s7
    s_add_u32 s16, s16, 16580608
    s_mul_i32 s57, s9, 4864
    s_add_u32 s41, s16, s57
    s_lshr_b32 s57, s3, 1
    s_mul_i32 s57, s57, 4864
    s_mul_i32 s58, s4, 19456
    s_add_u32 s57, s57, s58
    s_add_u32 s57, s57, s16
    s_and_b32 s58, s3, 1
    s_lshl_b32 s24, s58, 10
    s_add_u32 s24, s24, s57
    s_lshl_b32 s17, s58, 7
    s_add_u32 s17, s17, s57
    s_mul_i32 s25, s58, 1280
    s_add_u32 s25, s25, s57
    s_lshl_b32 s27, s5, 12
    s_add_u32 s27, s27, s7
    s_add_u32 s27, s27, 16318464
    s_lshl_b32 s18, s8, 6
    s_add_u32 s18, s18, s27
    s_lshl_b32 s57, s4, 3
    s_lshl_b32 s58, s9, 1
    s_add_u32 s57, s57, s58
    s_add_u32 s57, s57, s10
    s_lshr_b32 s58, s5, 1
    s_lshl_b32 s59, s57, 5
    s_add_u32 s58, s58, s59
    s_lshl_b32 s58, s58, 10
    s_and_b32 s59, s5, 1
    s_lshl_b32 s59, s59, 9
    s_add_u32 s50, s58, s59
    s_add_u32 s50, s50, s7
    s_add_u32 s50, s50, 21561344
    s_lshl_b32 s58, s57, 12
    s_lshr_b32 s59, s5, 2
    s_lshl_b32 s59, s59, 8
    s_add_u32 s58, s58, s59
    s_and_b32 s59, s5, 3
    s_lshl_b32 s59, s59, 2
    s_add_u32 s51, s58, s59
    s_add_u32 s51, s51, s7
    s_add_u32 s51, s51, 23658496
    s_lshl_b32 s57, s57, 5
    s_add_u32 s57, s57, s5
    s_lshl_b32 s52, s57, 6
    s_add_u32 s52, s52, s7
    s_add_u32 s52, s52, 16449536
    s_mov_b32 s40, 2
    s_cmp_eq_u32 s7, 0
    s_cselect_b32 s29, 0, 8
    s_add_u32 s29, s29, 85504
    s_add_u32 s30, s4, 1
    s_and_b32 s30, s30, 7
    s_lshl_b32 s30, s30, 3
    s_add_u32 s46, s30, 8
    s_and_b32 s46, s46, 63
    s_mov_b32 s31, 0
    s_mul_i32 s45, s9, 2432
    s_lshr_b32 s57, s30, 3
    s_mul_i32 s57, s57, 19456
    s_add_u32 s57, s57, s16
    s_add_u32 s44, s57, s45
    s_add_u32 s45, s45, 124928
    s_cmp_eq_u32 s10, 0
    s_cselect_b32 s28, 0, 2
    s_mov_b32 s57, s41
    s_add_u32 s58, s4, 3
    s_and_b32 s58, s58, 7
    s_mul_i32 s58, s58, 19456
    s_add_u32 s63, s58, s57
    s_add_u32 s58, s4, 4
    s_and_b32 s58, s58, 7
    s_mul_i32 s58, s58, 19456
    s_add_u32 s64, s58, s57
    s_add_u32 s58, s4, 5
    s_and_b32 s58, s58, 7
    s_mul_i32 s58, s58, 19456
    s_add_u32 s65, s58, s57
    s_add_u32 s58, s4, 6
    s_and_b32 s58, s58, 7
    s_mul_i32 s58, s58, 19456
    s_add_u32 s66, s58, s57
    s_add_u32 s58, s4, 7
    s_and_b32 s58, s58, 7
    s_mul_i32 s58, s58, 19456
    s_add_u32 s67, s58, s57
    s_mov_b32 s14, 0x3ae38e39
    s_mov_b32 s15, 0x3eae1a93
    s_mov_b32 s83, 0
    s_branch Lfxc_52
Lfxp_50:
    buffer_load_dwordx2 v[32:33], v10, s[20:23], s56 offen offset:0 sc1
    buffer_load_dwordx2 v[34:35], v10, s[20:23], s56 offen offset:256 sc1
    buffer_load_dwordx2 v[36:37], v10, s[20:23], s56 offen offset:512 sc1
    buffer_load_dwordx2 v[38:39], v10, s[20:23], s56 offen offset:768 sc1
Lfxc_52:
    s_add_u32 s83, s83, 1
    s_waitcnt vmcnt(0)
    v_xor_b32 v33, s6, v33
    v_xor_b32 v35, s6, v35
    v_xor_b32 v37, s6, v37
    v_xor_b32 v39, s6, v39
    v_or3_b32 v33, v33, v35, v37
    v_or_b32 v33, v33, v39
    v_cmp_ne_u32 vcc, 0, v33
    s_cbranch_vccz Lfxd_51
    s_cmp_lt_u32 s83, 524288
    s_cbranch_scc1 Lfxp_50
Lfxd_51:
    buffer_load_dwordx4 v[64:67], v2, s[20:23], s12 offen offset:0 sc1
    buffer_load_dwordx4 v[68:71], v2, s[20:23], s12 offen offset:1024 sc1
    buffer_load_dwordx4 v[72:75], v2, s[20:23], s12 offen offset:2048 sc1
    buffer_load_dwordx4 v[76:79], v2, s[20:23], s12 offen offset:3072 sc1
    s_add_u32 s12, s12, 4096
    buffer_load_dwordx4 v[80:83], v2, s[20:23], s12 offen offset:0 sc1
    buffer_load_dwordx4 v[84:87], v2, s[20:23], s12 offen offset:1024 sc1
    v_lshlrev_b32 v10, 4, v4
    v_add_u32 v10, 85248, v10
    ds_read_b128 v[116:119], v10 offset:0
    ds_read_b128 v[120:123], v10 offset:32
    ds_read_b128 v[124:127], v10 offset:64
    ds_read_b128 v[128:131], v10 offset:96
    ds_read_b128 v[132:135], v10 offset:128
    ds_read_b128 v[136:139], v10 offset:160
    ds_read_b128 v[140:143], v10 offset:192
    v_add_f32 v32, v32, v34
    v_add_f32 v36, v36, v38
    v_add_f32 v7, v32, v36
    v_mov_b32 v6, v7
    s_nop 1
    v_permlane32_swap_b32 v7, v6
    v_add_f32 v7, v7, v6
    ds_read_b128 v[16:19], v8 offset:0
    ds_read_b128 v[20:23], v8 offset:1024
    ds_read_b128 v[24:27], v8 offset:2048
    ds_read_b128 v[28:31], v8 offset:3072
    s_waitcnt vmcnt(5) lgkmcnt(2)
    v_mfma_f32_32x32x16_bf16 v[48:63], v[20:23], v[64:67], 0
    v_mfma_f32_32x32x16_bf16 v[32:47], v[16:19], v[64:67], 0
    buffer_load_dwordx4 v[64:67], v2, s[20:23], s12 offen offset:2048 sc1
    ds_read_b128 v[16:19], v8 offset:4096
    ds_read_b128 v[20:23], v8 offset:5120
    s_waitcnt vmcnt(5) lgkmcnt(2)
    v_mfma_f32_32x32x16_bf16 v[48:63], v[28:31], v[68:71], v[48:63]
    v_mfma_f32_32x32x16_bf16 v[32:47], v[24:27], v[68:71], v[32:47]
    buffer_load_dwordx4 v[68:71], v2, s[20:23], s12 offen offset:3072 sc1
    s_add_u32 s12, s12, 4096
    ds_read_b128 v[24:27], v8 offset:6144
    ds_read_b128 v[28:31], v8 offset:7168
    s_waitcnt vmcnt(5) lgkmcnt(2)
    v_mfma_f32_32x32x16_bf16 v[48:63], v[20:23], v[72:75], v[48:63]
    v_mfma_f32_32x32x16_bf16 v[32:47], v[16:19], v[72:75], v[32:47]
    buffer_load_dwordx4 v[72:75], v2, s[20:23], s12 offen offset:0 sc1
    ds_read_b128 v[16:19], v8 offset:8192
    ds_read_b128 v[20:23], v8 offset:9216
    s_waitcnt vmcnt(5) lgkmcnt(2)
    v_mfma_f32_32x32x16_bf16 v[48:63], v[28:31], v[76:79], v[48:63]
    v_mfma_f32_32x32x16_bf16 v[32:47], v[24:27], v[76:79], v[32:47]
    buffer_load_dwordx4 v[76:79], v2, s[20:23], s12 offen offset:1024 sc1
    ds_read_b128 v[24:27], v8 offset:10240
    ds_read_b128 v[28:31], v8 offset:11264
    s_waitcnt vmcnt(5) lgkmcnt(2)
    v_mfma_f32_32x32x16_bf16 v[48:63], v[20:23], v[80:83], v[48:63]
    v_mfma_f32_32x32x16_bf16 v[32:47], v[16:19], v[80:83], v[32:47]
    buffer_load_dwordx4 v[80:83], v2, s[20:23], s12 offen offset:2048 sc1
    ds_read_b128 v[16:19], v8 offset:12288
    ds_read_b128 v[20:23], v8 offset:13312
    s_waitcnt vmcnt(5) lgkmcnt(2)
    v_mfma_f32_32x32x16_bf16 v[48:63], v[28:31], v[84:87], v[48:63]
    v_mfma_f32_32x32x16_bf16 v[32:47], v[24:27], v[84:87], v[32:47]
    buffer_load_dwordx4 v[84:87], v2, s[20:23], s12 offen offset:3072 sc1
    s_add_u32 s12, s12, 4096
    ds_read_b128 v[24:27], v8 offset:14336
    ds_read_b128 v[28:31], v8 offset:15360
    s_waitcnt vmcnt(5) lgkmcnt(2)
    v_mfma_f32_32x32x16_bf16 v[48:63], v[20:23], v[64:67], v[48:63]
    v_mfma_f32_32x32x16_bf16 v[32:47], v[16:19], v[64:67], v[32:47]
    buffer_load_dwordx4 v[64:67], v2, s[20:23], s12 offen offset:0 sc1
    ds_read_b128 v[16:19], v8 offset:16384
    ds_read_b128 v[20:23], v8 offset:17408
    s_waitcnt vmcnt(5) lgkmcnt(2)
    v_mfma_f32_32x32x16_bf16 v[48:63], v[28:31], v[68:71], v[48:63]
    v_mfma_f32_32x32x16_bf16 v[32:47], v[24:27], v[68:71], v[32:47]
    buffer_load_dwordx4 v[68:71], v2, s[20:23], s12 offen offset:1024 sc1
    ds_read_b128 v[24:27], v8 offset:18432
    ds_read_b128 v[28:31], v8 offset:19456
    s_waitcnt vmcnt(5) lgkmcnt(2)
    v_mfma_f32_32x32x16_bf16 v[48:63], v[20:23], v[72:75], v[48:63]
    v_mfma_f32_32x32x16_bf16 v[32:47], v[16:19], v[72:75], v[32:47]
    buffer_load_dwordx4 v[72:75], v2, s[20:23], s12 offen offset:2048 sc1
    ds_read_b128 v[16:19], v8 offset:20480
    ds_read_b128 v[20:23], v8 offset:21504
    s_waitcnt vmcnt(5) lgkmcnt(2)
    v_mfma_f32_32x32x16_bf16 v[48:63], v[28:31], v[76:79], v[48:63]
    v_mfma_f32_32x32x16_bf16 v[32:47], v[24:27], v[76:79], v[32:47]
    buffer_load_dwordx4 v[76:79], v2, s[20:23], s12 offen offset:3072 sc1
    s_add_u32 s12, s12, 4096
    ds_read_b128 v[24:27], v8 offset:22528
    ds_read_b128 v[28:31], v8 offset:23552
    s_waitcnt vmcnt(5) lgkmcnt(2)
    v_mfma_f32_32x32x16_bf16 v[48:63], v[20:23], v[80:83], v[48:63]
    v_mfma_f32_32x32x16_bf16 v[32:47], v[16:19], v[80:83], v[32:47]
    buffer_load_dwordx4 v[80:83], v2, s[20:23], s12 offen offset:0 sc1
    ds_read_b128 v[16:19], v8 offset:24576
    ds_read_b128 v[20:23], v8 offset:25600
    s_waitcnt vmcnt(5) lgkmcnt(2)
    v_mfma_f32_32x32x16_bf16 v[48:63], v[28:31], v[84:87], v[48:63]
    v_mfma_f32_32x32x16_bf16 v[32:47], v[24:27], v[84:87], v[32:47]
    buffer_load_dwordx4 v[84:87], v2, s[20:23], s12 offen offset:1024 sc1
    ds_read_b128 v[24:27], v8 offset:26624
    ds_read_b128 v[28:31], v8 offset:27648
    s_waitcnt vmcnt(5) lgkmcnt(2)
    v_mfma_f32_32x32x16_bf16 v[48:63], v[20:23], v[64:67], v[48:63]
    v_mfma_f32_32x32x16_bf16 v[32:47], v[16:19], v[64:67], v[32:47]
    buffer_load_dwordx4 v[64:67], v2, s[20:23], s12 offen offset:2048 sc1
    ds_read_b128 v[16:19], v8 offset:28672
    ds_read_b128 v[20:23], v8 offset:29696
    s_waitcnt vmcnt(5) lgkmcnt(2)
    v_mfma_f32_32x32x16_bf16 v[48:63], v[28:31], v[68:71], v[48:63]
    v_mfma_f32_32x32x16_bf16 v[32:47], v[24:27], v[68:71], v[32:47]
    buffer_load_dwordx4 v[68:71], v2, s[20:23], s12 offen offset:3072 sc1
    s_add_u32 s12, s12, 4096
    ds_read_b128 v[24:27], v8 offset:30720
    ds_read_b128 v[28:31], v8 offset:31744
    s_waitcnt vmcnt(5) lgkmcnt(2)
    v_mfma_f32_32x32x16_bf16 v[48:63], v[20:23], v[72:75], v[48:63]
    v_mfma_f32_32x32x16_bf16 v[32:47], v[16:19], v[72:75], v[32:47]
    buffer_load_dwordx4 v[72:75], v2, s[20:23], s12 offen offset:0 sc1
    ds_read_b128 v[16:19], v8 offset:32768
    ds_read_b128 v[20:23], v8 offset:33792
    s_waitcnt vmcnt(5) lgkmcnt(2)
    v_mfma_f32_32x32x16_bf16 v[48:63], v[28:31], v[76:79], v[48:63]
    v_mfma_f32_32x32x16_bf16 v[32:47], v[24:27], v[76:79], v[32:47]
    buffer_load_dwordx4 v[76:79], v2, s[20:23], s12 offen offset:1024 sc1
    ds_read_b128 v[24:27], v8 offset:34816
    ds_read_b128 v[28:31], v8 offset:35840
    s_waitcnt vmcnt(5) lgkmcnt(2)
    v_mfma_f32_32x32x16_bf16 v[48:63], v[20:23], v[80:83], v[48:63]
    v_mfma_f32_32x32x16_bf16 v[32:47], v[16:19], v[80:83], v[32:47]
    buffer_load_dwordx4 v[80:83], v2, s[20:23], s12 offen offset:2048 sc1
    ds_read_b128 v[16:19], v8 offset:36864
    ds_read_b128 v[20:23], v8 offset:37888
    s_waitcnt vmcnt(5) lgkmcnt(2)
    v_mfma_f32_32x32x16_bf16 v[48:63], v[28:31], v[84:87], v[48:63]
    v_mfma_f32_32x32x16_bf16 v[32:47], v[24:27], v[84:87], v[32:47]
    buffer_load_dwordx4 v[84:87], v2, s[20:23], s12 offen offset:3072 sc1
    s_add_u32 s12, s12, 4096
    ds_read_b128 v[24:27], v8 offset:38912
    ds_read_b128 v[28:31], v8 offset:39936
    s_waitcnt vmcnt(5) lgkmcnt(2)
    v_mfma_f32_32x32x16_bf16 v[48:63], v[20:23], v[64:67], v[48:63]
    v_mfma_f32_32x32x16_bf16 v[32:47], v[16:19], v[64:67], v[32:47]
    buffer_load_dwordx4 v[64:67], v2, s[20:23], s12 offen offset:0 sc1
    ds_read_b128 v[16:19], v8 offset:40960
    ds_read_b128 v[20:23], v8 offset:41984
    s_waitcnt vmcnt(5) lgkmcnt(2)
    v_mfma_f32_32x32x16_bf16 v[48:63], v[28:31], v[68:71], v[48:63]
    v_mfma_f32_32x32x16_bf16 v[32:47], v[24:27], v[68:71], v[32:47]
    buffer_load_dwordx4 v[68:71], v2, s[20:23], s12 offen offset:1024 sc1
    ds_read_b128 v[24:27], v8 offset:43008
    ds_read_b128 v[28:31], v8 offset:44032
    s_waitcnt vmcnt(5) lgkmcnt(2)
    s_barrier
    v_mfma_f32_32x32x16_bf16 v[48:63], v[20:23], v[72:75], v[48:63]
    v_mfma_f32_32x32x16_bf16 v[32:47], v[16:19], v[72:75], v[32:47]
    buffer_load_dwordx4 v[72:75], v2, s[20:23], s12 offen offset:2048 sc1
    ds_read_b128 v[16:19], v8 offset:45056
    ds_read_b128 v[20:23], v8 offset:46080
    s_waitcnt vmcnt(5) lgkmcnt(2)
    v_mfma_f32_32x32x16_bf16 v[48:63], v[28:31], v[76:79], v[48:63]
    v_mfma_f32_32x32x16_bf16 v[32:47], v[24:27], v[76:79], v[32:47]
    buffer_load_dwordx4 v[76:79], v2, s[20:23], s12 offen offset:3072 sc1
    s_add_u32 s12, s12, 4096
    ds_read_b128 v[24:27], v8 offset:47104
    ds_read_b128 v[28:31], v8 offset:48128
    s_waitcnt vmcnt(5) lgkmcnt(2)
    v_mfma_f32_32x32x16_bf16 v[48:63], v[20:23], v[80:83], v[48:63]
    v_mfma_f32_32x32x16_bf16 v[32:47], v[16:19], v[80:83], v[32:47]
    buffer_load_dwordx4 v[80:83], v2, s[20:23], s12 offen offset:0 sc1
    ds_read_b128 v[16:19], v8 offset:49152
    ds_read_b128 v[20:23], v8 offset:50176
    s_waitcnt vmcnt(5) lgkmcnt(2)
    v_mfma_f32_32x32x16_bf16 v[48:63], v[28:31], v[84:87], v[48:63]
    v_mfma_f32_32x32x16_bf16 v[32:47], v[24:27], v[84:87], v[32:47]
    buffer_load_dwordx4 v[84:87], v2, s[20:23], s12 offen offset:1024 sc1
    ds_read_b128 v[24:27], v8 offset:51200
    ds_read_b128 v[28:31], v8 offset:52224
    s_waitcnt vmcnt(5) lgkmcnt(2)
    v_mfma_f32_32x32x16_bf16 v[48:63], v[20:23], v[64:67], v[48:63]
    v_mfma_f32_32x32x16_bf16 v[32:47], v[16:19], v[64:67], v[32:47]
    buffer_load_dwordx4 v[64:67], v2, s[20:23], s12 offen offset:2048 sc1
    ds_read_b128 v[16:19], v8 offset:53248
    ds_read_b128 v[20:23], v8 offset:54272
    s_waitcnt vmcnt(5) lgkmcnt(2)
    v_mfma_f32_32x32x16_bf16 v[48:63], v[28:31], v[68:71], v[48:63]
    v_mfma_f32_32x32x16_bf16 v[32:47], v[24:27], v[68:71], v[32:47]
    buffer_load_dwordx4 v[68:71], v2, s[20:23], s12 offen offset:3072 sc1
    s_add_u32 s12, s12, 4096
    ds_read_b128 v[24:27], v8 offset:55296
    ds_read_b128 v[28:31], v8 offset:56320
    s_waitcnt vmcnt(5) lgkmcnt(2)
    v_mfma_f32_32x32x16_bf16 v[48:63], v[20:23], v[72:75], v[48:63]
    v_mfma_f32_32x32x16_bf16 v[32:47], v[16:19], v[72:75], v[32:47]
    buffer_load_dwordx4 v[72:75], v2, s[20:23], s12 offen offset:0 sc1
    ds_read_b128 v[16:19], v8 offset:57344
    ds_read_b128 v[20:23], v8 offset:58368
    s_waitcnt vmcnt(5) lgkmcnt(2)
    v_mfma_f32_32x32x16_bf16 v[48:63], v[28:31], v[76:79], v[48:63]
    v_mfma_f32_32x32x16_bf16 v[32:47], v[24:27], v[76:79], v[32:47]
    buffer_load_dwordx4 v[76:79], v2, s[20:23], s12 offen offset:1024 sc1
    ds_read_b128 v[24:27], v8 offset:59392
    ds_read_b128 v[28:31], v8 offset:60416
    s_waitcnt vmcnt(5) lgkmcnt(2)
    v_mfma_f32_32x32x16_bf16 v[48:63], v[20:23], v[80:83], v[48:63]
    v_mfma_f32_32x32x16_bf16 v[32:47], v[16:19], v[80:83], v[32:47]
    buffer_load_dwordx4 v[80:83], v2, s[20:23], s12 offen offset:2048 sc1
    ds_read_b128 v[16:19], v8 offset:61440
    ds_read_b128 v[20:23], v8 offset:62464
    s_waitcnt vmcnt(5) lgkmcnt(2)
    v_mfma_f32_32x32x16_bf16 v[48:63], v[28:31], v[84:87], v[48:63]
    v_mfma_f32_32x32x16_bf16 v[32:47], v[24:27], v[84:87], v[32:47]
    buffer_load_dwordx4 v[84:87], v2, s[20:23], s12 offen offset:3072 sc1
    s_add_u32 s12, s12, 4096
    ds_read_b128 v[24:27], v8 offset:63488
    ds_read_b128 v[28:31], v8 offset:64512
    s_waitcnt vmcnt(5) lgkmcnt(2)
    v_mfma_f32_32x32x16_bf16 v[48:63], v[20:23], v[64:67], v[48:63]
    v_mfma_f32_32x32x16_bf16 v[32:47], v[16:19], v[64:67], v[32:47]
    ds_read_b128 v[16:19], v9 offset:0
    ds_read_b128 v[20:23], v9 offset:1024
    s_waitcnt vmcnt(4) lgkmcnt(2)
    v_mfma_f32_32x32x16_bf16 v[48:63], v[28:31], v[68:71], v[48:63]
    v_mfma_f32_32x32x16_bf16 v[32:47], v[24:27], v[68:71], v[32:47]
    ds_read_b128 v[24:27], v9 offset:2048
    ds_read_b128 v[28:31], v9 offset:3072
    s_waitcnt vmcnt(3) lgkmcnt(2)
    v_mfma_f32_32x32x16_bf16 v[48:63], v[20:23], v[72:75], v[48:63]
    v_mfma_f32_32x32x16_bf16 v[32:47], v[16:19], v[72:75], v[32:47]
    ds_read_b128 v[16:19], v9 offset:4096
    ds_read_b128 v[20:23], v9 offset:5120
    s_waitcnt vmcnt(2) lgkmcnt(2)
    v_mfma_f32_32x32x16_bf16 v[48:63], v[28:31], v[76:79], v[48:63]
    v_mfma_f32_32x32x16_bf16 v[32:47], v[24:27], v[76:79], v[32:47]
    ds_read_b128 v[24:27], v9 offset:6144
    ds_read_b128 v[28:31], v9 offset:7168
    s_waitcnt vmcnt(1) lgkmcnt(2)
    v_mfma_f32_32x32x16_bf16 v[48:63], v[20:23], v[80:83], v[48:63]
    v_mfma_f32_32x32x16_bf16 v[32:47], v[16:19], v[80:83], v[32:47]
    s_waitcnt vmcnt(0) lgkmcnt(0)
    v_mfma_f32_32x32x16_bf16 v[48:63], v[28:31], v[84:87], v[48:63]
    v_mfma_f32_32x32x16_bf16 v[32:47], v[24:27], v[84:87], v[32:47]
LGepi_40:
    v_mul_f32 v7, s14, v7
    v_mov_b32 v88, 0x3f803f80
    v_and_b32 v9, 1, v1
    v_cmp_eq_u32 s[58:59], 1, v9
    v_cmp_eq_u32 vcc, 1, v4
    s_nop 5
    v_mul_f32 v10, s14, v60
    v_fma_f32 v7, -v10, v10, v7
    v_max_f32 v7, 0, v7
    v_add_f32 v7, 0x3727c5ac, v7
    v_rsq_f32 v11, v7
    v_cndmask_b32 v88, v88, 0, s[58:59]
    v_pk_fma_f32 v[48:49], v[10:11], v[132:133], v[48:49] op_sel_hi:[0,1,1] neg_lo:[1,0,0] neg_hi:[1,0,0]
    v_pk_fma_f32 v[50:51], v[10:11], v[134:135], v[50:51] op_sel_hi:[0,1,1] neg_lo:[1,0,0] neg_hi:[1,0,0]
    v_pk_fma_f32 v[52:53], v[10:11], v[136:137], v[52:53] op_sel_hi:[0,1,1] neg_lo:[1,0,0] neg_hi:[1,0,0]
    v_pk_fma_f32 v[54:55], v[10:11], v[138:139], v[54:55] op_sel_hi:[0,1,1] neg_lo:[1,0,0] neg_hi:[1,0,0]
    v_pk_fma_f32 v[56:57], v[10:11], v[140:141], v[56:57] op_sel_hi:[0,1,1] neg_lo:[1,0,0] neg_hi:[1,0,0]
    v_pk_fma_f32 v[58:59], v[10:11], v[142:143], v[58:59] op_sel_hi:[0,1,1] neg_lo:[1,0,0] neg_hi:[1,0,0]
    v_mul_f32 v12, s15, v11
    v_mov_b32 v89, v88
    v_cndmask_b32 v13, v11, v12, vcc
    v_pk_mul_f32 v[48:49], v[48:49], v[10:11] op_sel:[0,1] op_sel_hi:[1,1]
    v_pk_mul_f32 v[50:51], v[50:51], v[10:11] op_sel:[0,1] op_sel_hi:[1,1]
    v_pk_mul_f32 v[52:53], v[52:53], v[10:11] op_sel:[0,1] op_sel_hi:[1,1]
    v_pk_mul_f32 v[54:55], v[54:55], v[10:11] op_sel:[0,1] op_sel_hi:[1,1]
    v_pk_mul_f32 v[56:57], v[56:57], v[12:13] op_sel:[0,1] op_sel_hi:[1,1]
    v_pk_mul_f32 v[58:59], v[58:59], v[10:11] op_sel:[0,1] op_sel_hi:[1,1]
    v_cvt_pk_bf16_f32 v104, v48, v49
    v_cvt_pk_bf16_f32 v105, v50, v51
    v_cvt_pk_bf16_f32 v106, v52, v53
    v_cvt_pk_bf16_f32 v107, v54, v55
    v_cvt_pk_bf16_f32 v108, v56, v57
    v_cvt_pk_bf16_f32 v109, v58, v59
    v_mov_b32 v90, v88
    v_mov_b32 v91, v88
    v_mov_b32_dpp v80, v104 quad_perm:[1,0,3,2] row_mask:0xf bank_mask:0xf
    v_mov_b32_dpp v81, v105 quad_perm:[1,0,3,2] row_mask:0xf bank_mask:0xf
    v_mov_b32_dpp v82, v106 quad_perm:[1,0,3,2] row_mask:0xf bank_mask:0xf
    v_mov_b32_dpp v83, v107 quad_perm:[1,0,3,2] row_mask:0xf bank_mask:0xf
    v_mov_b32_dpp v84, v108 quad_perm:[1,0,3,2] row_mask:0xf bank_mask:0xf
    v_perm_b32 v80, v80, v104, v146
    v_perm_b32 v81, v81, v105, v146
    v_perm_b32 v82, v82, v106, v146
    v_perm_b32 v83, v83, v107, v146
    v_perm_b32 v84, v84, v108, v146
    ds_write_b32 v145, v80 offset:2304
    ds_write_b32 v145, v81 offset:2336
    ds_write_b32 v145, v82 offset:2432
    ds_write_b32 v145, v83 offset:2464
    s_mov_b64 exec, 0xff
    ds_write_b128 v147, v[88:91] offset:2592
    s_mov_b64 exec, 0xffffffff
    ds_write_b32 v145, v84 offset:2560
    ds_write_b32 v149, v109 offset:2048
    s_not_b64 exec, exec
    ds_write_b32 v152, v108
    s_mov_b64 exec, -1
    ds_read_b128 v[112:115], v150 offset:2304
    ds_read_b128 v[6:9], v150 offset:3328
    v_pk_fma_f32 v[40:41], v[10:11], v[124:125], v[40:41] op_sel_hi:[0,1,1] neg_lo:[1,0,0] neg_hi:[1,0,0]
    v_pk_fma_f32 v[42:43], v[10:11], v[126:127], v[42:43] op_sel_hi:[0,1,1] neg_lo:[1,0,0] neg_hi:[1,0,0]
    v_pk_fma_f32 v[44:45], v[10:11], v[128:129], v[44:45] op_sel_hi:[0,1,1] neg_lo:[1,0,0] neg_hi:[1,0,0]
    v_pk_fma_f32 v[46:47], v[10:11], v[130:131], v[46:47] op_sel_hi:[0,1,1] neg_lo:[1,0,0] neg_hi:[1,0,0]
    v_pk_mul_f32 v[40:41], v[40:41], v[10:11] op_sel:[0,1] op_sel_hi:[1,1]
    v_pk_mul_f32 v[42:43], v[42:43], v[10:11] op_sel:[0,1] op_sel_hi:[1,1]
    v_pk_mul_f32 v[44:45], v[44:45], v[10:11] op_sel:[0,1] op_sel_hi:[1,1]
    v_pk_mul_f32 v[46:47], v[46:47], v[10:11] op_sel:[0,1] op_sel_hi:[1,1]
    v_cvt_pk_bf16_f32 v128, v40, v41
    v_cvt_pk_bf16_f32 v129, v42, v43
    v_cvt_pk_bf16_f32 v130, v44, v45
    v_cvt_pk_bf16_f32 v131, v46, v47
    v_cndmask_b32 v124, 0, v108, vcc
    v_cndmask_b32 v125, v109, 0, vcc
    buffer_store_dwordx4 v[128:131], v2, s[20:23], s24 offen sc1
    s_waitcnt lgkmcnt(0)
    buffer_store_dwordx4 v[112:115], v2, s[20:23], s25 offen offset:2304 sc1
    s_mov_b32 exec_hi, 0
    buffer_store_dword v125, v148, s[20:23], s17 offen offset:2048 sc1
    s_mov_b32 exec_lo, 0xffff
    buffer_store_dwordx4 v[6:9], v2, s[20:23], s25 offen offset:3328 sc1
    s_mov_b64 exec, -1
Lkvl_53:
    ds_write_b128 v144, v[128:131]
    v_pk_fma_f32 v[32:33], v[10:11], v[116:117], v[32:33] op_sel_hi:[0,1,1] neg_lo:[1,0,0] neg_hi:[1,0,0]
    v_pk_fma_f32 v[34:35], v[10:11], v[118:119], v[34:35] op_sel_hi:[0,1,1] neg_lo:[1,0,0] neg_hi:[1,0,0]
    v_pk_fma_f32 v[36:37], v[10:11], v[120:121], v[36:37] op_sel_hi:[0,1,1] neg_lo:[1,0,0] neg_hi:[1,0,0]
    v_pk_fma_f32 v[38:39], v[10:11], v[122:123], v[38:39] op_sel_hi:[0,1,1] neg_lo:[1,0,0] neg_hi:[1,0,0]
    v_pk_mul_f32 v[32:33], v[32:33], v[12:13] op_sel:[0,0] op_sel_hi:[1,0]
    v_pk_mul_f32 v[34:35], v[34:35], v[12:13] op_sel:[0,0] op_sel_hi:[1,0]
    v_pk_mul_f32 v[36:37], v[36:37], v[12:13] op_sel:[0,0] op_sel_hi:[1,0]
    v_pk_mul_f32 v[38:39], v[38:39], v[12:13] op_sel:[0,0] op_sel_hi:[1,0]
    v_cvt_pk_bf16_f32 v132, v32, v33
    v_cvt_pk_bf16_f32 v133, v34, v35
    v_cvt_pk_bf16_f32 v134, v36, v37
    v_cvt_pk_bf16_f32 v135, v38, v39
    ds_write_b128 v151, v[132:135]
    s_waitcnt lgkmcnt(0)
    s_barrier
    ds_read_b128 v[12:15], v153
    ds_read_b128 v[16:19], v153 offset:1024
    ds_read_b128 v[20:23], v157 offset:19456
    ds_read_b32 v10, v154
    ds_read_b32 v24, v158 offset:21504
    ds_read_b128 v[28:31], v159 offset:21760
    ds_read_b128 v[32:35], v159 offset:22400
    v_dot2_f32_bf16 v46, v124, v124, 0
    v_dot2_f32_bf16 v47, v125, v125, 0
    v_dot2_f32_bf16 v46, v132, v132, v46
    v_dot2_f32_bf16 v47, v128, v128, v47
    v_dot2_f32_bf16 v46, v133, v133, v46
    v_dot2_f32_bf16 v47, v129, v129, v47
    v_dot2_f32_bf16 v46, v134, v134, v46
    v_dot2_f32_bf16 v47, v130, v130, v47
    v_dot2_f32_bf16 v46, v135, v135, v46
    v_dot2_f32_bf16 v47, v131, v131, v47
    v_mov_b32 v26, 0xdddddddd
    v_mov_b32 v11, 0
    v_mov_b32 v25, 0
    s_waitcnt lgkmcnt(4)
    v_mfma_f32_32x32x16_bf16 v[80:95], v[20:23], v[12:15], 0
    v_mfma_f32_32x32x16_bf16 v[96:111], v[20:23], v[16:19], 0
    ds_read_b128 v[20:23], v157 offset:20480
    v_permlane32_swap_b32 v46, v47
    v_add_f32 v46, v46, v47
    v_mov_b32 v136, 0
    v_mov_b32 v137, 0
    v_mov_b32 v138, 0
    v_mov_b32 v139, 0
    v_mov_b32 v140, 0
    v_mov_b32 v141, 0
    v_mov_b32 v142, 0
    v_mov_b32 v143, 0
    s_waitcnt lgkmcnt(3)
    v_mfma_f32_32x32x4_2b_bf16 v[80:111], v[24:25], v[10:11], v[80:111] cbsz:1 abid:0
    v_max_f32_dpp v46, v46, v46 quad_perm:[1,0,3,2] row_mask:0xf bank_mask:0xf
    v_mov_b32 v79, 0
    v_mov_b32 v78, 0
    v_max_f32_dpp v46, v46, v46 quad_perm:[2,3,0,1] row_mask:0xf bank_mask:0xf
    v_mov_b32 v77, 0
    v_mov_b32 v76, 0
    v_max_f32_dpp v46, v46, v46 row_half_mirror row_mask:0xf bank_mask:0xf
    v_mov_b32 v75, 0
    v_mov_b32 v74, 0
    v_max_f32_dpp v46, v46, v46 row_mirror row_mask:0xf bank_mask:0xf
    v_mov_b32 v73, 0
    v_mov_b32 v72, 0
    v_max_f32_dpp v46, v46, v46 row_bcast:15 row_mask:0xa bank_mask:0xf
    v_mov_b32 v71, 0
    v_mov_b32 v70, 0
    v_readlane_b32 s26, v46, 63
    v_readlane_b32 s56, v46, 31
    v_mov_b32 v40, 0
    v_mov_b32 v41, 0
    v_mov_b32 v42, 0
    v_mov_b32 v43, 0
    v_mov_b32 v48, 0
    v_mov_b32 v49, 0
    v_mov_b32 v50, 0
    v_mov_b32 v51, 0
    v_mov_b32 v52, 0
    v_mov_b32 v53, 0
    v_mov_b32 v54, 0
    v_mov_b32 v55, 0
    v_mov_b32 v56, 0
    v_mov_b32 v57, 0
    v_mov_b32 v58, 0
    v_mov_b32 v59, 0
    v_mov_b32 v60, 0
    v_mov_b32 v61, 0
    v_mov_b32 v62, 0
    v_mov_b32 v63, 0
    v_mov_b32 v64, 0
    v_mov_b32 v65, 0
    v_mov_b32 v66, 0
    v_mov_b32 v67, 0
    v_mov_b32 v68, 0
    v_mov_b32 v69, 0
    s_add_u32 s26, s26, 0xffff
    s_and_b32 s26, s26, 0xffff0000
    s_add_u32 s56, s56, 0xffff
    s_lshr_b32 s56, s56, 16
    s_or_b32 s26, s26, s56
    s_cmp_eq_u32 s10, 0
    s_cbranch_scc1 LisA_56
    v_mov_b32 v44, s26
    v_mov_b32 v45, s6
    v_mov_b32 v46, 0
    s_waitcnt vmcnt(0)
    s_mov_b64 exec, 1
    buffer_store_dwordx2 v[44:45], v46, s[20:23], s18 offen sc1
    s_mov_b64 exec, -1
    s_branch LAgo_57
LisA_56:
    s_setprio 1
LAgo_57:
    s_waitcnt lgkmcnt(0)
    v_exp_f32 v80, v80
    v_exp_f32 v81, v81
    v_smfmac_f32_32x32x32_bf16 v[64:79], v[40:43], v[136:143], v26
    ds_read_b128 v[36:39], v159 offset:23040
    v_exp_f32 v82, v82
    v_exp_f32 v83, v83
    v_exp_f32 v84, v84
    v_mfma_f32_32x32x16_bf16 v[112:127], v[20:23], v[12:15], 0
    ds_read_b128 v[40:43], v159 offset:23680
    v_exp_f32 v85, v85
    v_exp_f32 v86, v86
    v_exp_f32 v87, v87
    v_mfma_f32_32x32x16_bf16 v[128:143], v[20:23], v[16:19], 0
    ds_read_b128 v[20:23], v157 offset:29184
    v_exp_f32 v88, v88
    v_exp_f32 v89, v89
    v_exp_f32 v90, v90
    v_exp_f32 v91, v91
    v_smfmac_f32_32x32x32_bf16 v[48:63], v[28:31], v[80:87], v26
    s_nop 0
    v_exp_f32 v92, v92
    v_exp_f32 v93, v93
    v_exp_f32 v94, v94
    v_mfma_f32_32x32x4_2b_bf16 v[112:143], v[24:25], v[10:11], v[112:143] cbsz:1 abid:1
    v_exp_f32 v95, v95
    v_exp_f32 v96, v96
    v_exp_f32 v97, v97
    v_exp_f32 v98, v98
    v_exp_f32 v99, v99
    v_exp_f32 v100, v100
    v_exp_f32 v101, v101
    v_exp_f32 v102, v102
    v_smfmac_f32_32x32x32_bf16 v[48:63], v[32:35], v[88:95], v26
    ds_read_b32 v24, v158 offset:31232
    v_exp_f32 v103, v103
    v_exp_f32 v104, v104
    v_exp_f32 v105, v105
    v_exp_f32 v106, v106
    v_smfmac_f32_32x32x32_bf16 v[64:79], v[28:31], v[96:103], v26
    s_waitcnt lgkmcnt(1)
    v_exp_f32 v107, v107
    v_exp_f32 v108, v108
    v_exp_f32 v109, v109
    v_exp_f32 v110, v110
    v_exp_f32 v111, v111
    s_cmp_eq_u32 s10, 0
    s_cbranch_scc0 LnoA_58
    v_mov_b32 v44, s26
    v_mov_b32 v45, s6
    v_mov_b32 v46, 0
    s_waitcnt vmcnt(0)
    s_mov_b64 exec, 1
    buffer_store_dwordx2 v[44:45], v46, s[20:23], s18 offen sc1
    s_mov_b64 exec, -1
LnoA_58:
    v_exp_f32 v112, v112
    v_exp_f32 v113, v113
    v_smfmac_f32_32x32x32_bf16 v[64:79], v[32:35], v[104:111], v26
    ds_read_b128 v[28:31], v159 offset:31488
    v_exp_f32 v114, v114
    v_exp_f32 v115, v115
    v_exp_f32 v116, v116
    v_mfma_f32_32x32x16_bf16 v[80:95], v[20:23], v[12:15], 0
    ds_read_b128 v[32:35], v159 offset:32128
    v_exp_f32 v117, v117
    v_exp_f32 v118, v118
    v_exp_f32 v119, v119
    v_mfma_f32_32x32x16_bf16 v[96:111], v[20:23], v[16:19], 0
    ds_read_b128 v[20:23], v157 offset:30208
    v_exp_f32 v120, v120
    v_exp_f32 v121, v121
    v_exp_f32 v122, v122
    v_exp_f32 v123, v123
    v_smfmac_f32_32x32x32_bf16 v[48:63], v[36:39], v[112:119], v26
    s_waitcnt lgkmcnt(3)
    v_exp_f32 v124, v124
    v_exp_f32 v125, v125
    v_exp_f32 v126, v126
    v_mfma_f32_32x32x4_2b_bf16 v[80:111], v[24:25], v[10:11], v[80:111] cbsz:1 abid:0
    v_exp_f32 v127, v127
    v_exp_f32 v128, v128
    v_exp_f32 v129, v129
    v_exp_f32 v130, v130
    v_exp_f32 v131, v131
    v_exp_f32 v132, v132
    v_exp_f32 v133, v133
    v_exp_f32 v134, v134
    v_smfmac_f32_32x32x32_bf16 v[48:63], v[40:43], v[120:127], v26
    v_exp_f32 v135, v135
    v_exp_f32 v136, v136
    v_exp_f32 v137, v137
    v_exp_f32 v138, v138
    v_smfmac_f32_32x32x32_bf16 v[64:79], v[36:39], v[128:135], v26
    s_waitcnt lgkmcnt(0)
    v_exp_f32 v139, v139
    v_exp_f32 v140, v140
    v_exp_f32 v141, v141
    v_exp_f32 v142, v142
    v_exp_f32 v143, v143
    s_cmp_eq_u32 s10, 0
    s_cbranch_scc0 LAn1_65
    v_lshlrev_b32 v46, 6, v1
    buffer_load_dwordx2 v[44:45], v46, s[20:23], s27 offen sc1
LAn1_65:
    v_exp_f32 v80, v80
    v_exp_f32 v81, v81
    v_smfmac_f32_32x32x32_bf16 v[64:79], v[40:43], v[136:143], v26
    ds_read_b128 v[36:39], v159 offset:32768
    v_exp_f32 v82, v82
    v_exp_f32 v83, v83
    v_exp_f32 v84, v84
    v_mfma_f32_32x32x16_bf16 v[112:127], v[20:23], v[12:15], 0
    ds_read_b128 v[40:43], v159 offset:33408
    v_exp_f32 v85, v85
    v_exp_f32 v86, v86
    v_exp_f32 v87, v87
    v_mfma_f32_32x32x16_bf16 v[128:143], v[20:23], v[16:19], 0
    v_exp_f32 v88, v88
    v_exp_f32 v89, v89
    v_exp_f32 v90, v90
    v_exp_f32 v91, v91
    v_smfmac_f32_32x32x32_bf16 v[48:63], v[28:31], v[80:87], v26
    s_nop 0
    v_exp_f32 v92, v92
    v_exp_f32 v93, v93
    v_exp_f32 v94, v94
    s_nop 0
    v_mfma_f32_32x32x4_2b_bf16 v[112:143], v[24:25], v[10:11], v[112:143] cbsz:1 abid:1
    v_exp_f32 v95, v95
    v_exp_f32 v96, v96
    v_exp_f32 v97, v97
    v_exp_f32 v98, v98
    v_exp_f32 v99, v99
    v_exp_f32 v100, v100
    v_exp_f32 v101, v101
    v_exp_f32 v102, v102
    v_smfmac_f32_32x32x32_bf16 v[48:63], v[32:35], v[88:95], v26
    v_exp_f32 v103, v103
    v_exp_f32 v104, v104
    v_exp_f32 v105, v105
    v_exp_f32 v106, v106
    v_smfmac_f32_32x32x32_bf16 v[64:79], v[28:31], v[96:103], v26
    s_waitcnt lgkmcnt(0)
    v_exp_f32 v107, v107
    v_exp_f32 v108, v108
    v_exp_f32 v109, v109
    v_exp_f32 v110, v110
    v_exp_f32 v111, v111
    s_cmp_eq_u32 s10, 0
    s_cbranch_scc1 LAearly_63
LAearlyb_64:
    v_exp_f32 v112, v112
    v_exp_f32 v113, v113
    v_smfmac_f32_32x32x32_bf16 v[64:79], v[32:35], v[104:111], v26
    v_exp_f32 v114, v114
    v_exp_f32 v115, v115
    v_exp_f32 v116, v116
    v_exp_f32 v117, v117
    v_exp_f32 v118, v118
    v_exp_f32 v119, v119
    v_exp_f32 v120, v120
    v_exp_f32 v121, v121
    v_exp_f32 v122, v122
    v_exp_f32 v123, v123
    v_smfmac_f32_32x32x32_bf16 v[48:63], v[36:39], v[112:119], v26
    s_waitcnt lgkmcnt(3)
    v_exp_f32 v124, v124
    v_exp_f32 v125, v125
    v_exp_f32 v126, v126
    v_exp_f32 v127, v127
    v_exp_f32 v128, v128
    v_exp_f32 v129, v129
    v_exp_f32 v130, v130
    v_exp_f32 v131, v131
    v_exp_f32 v132, v132
    v_exp_f32 v133, v133
    v_exp_f32 v134, v134
    v_smfmac_f32_32x32x32_bf16 v[48:63], v[40:43], v[120:127], v26
    v_exp_f32 v135, v135
    v_exp_f32 v136, v136
    v_exp_f32 v137, v137
    v_exp_f32 v138, v138
    v_smfmac_f32_32x32x32_bf16 v[64:79], v[36:39], v[128:135], v26
    s_waitcnt lgkmcnt(0)
    v_exp_f32 v139, v139
    v_exp_f32 v140, v140
    v_exp_f32 v141, v141
    v_exp_f32 v142, v142
    v_exp_f32 v143, v143
    s_cmp_eq_u32 s10, 0
    s_cbranch_scc0 LApreJ_60
    s_cmp_lg_u32 s28, 0
    s_cbranch_scc1 LAhave_66
    s_mov_b32 s83, 0
LApl_67:
    buffer_load_dwordx2 v[44:45], v46, s[20:23], s27 offen sc1
    s_add_u32 s83, s83, 1
    s_waitcnt vmcnt(0)
    v_cmp_ne_u32 vcc, s6, v45
    s_nop 0
    s_lshr_b64 s[60:61], vcc, s30
    s_and_b32 s56, s60, 15
    s_cbranch_scc1 LApn_68
    s_branch LApg_69
LApn_68:
    s_cmp_lt_u32 s83, 524288
    s_cbranch_scc1 LApl_67
LApg_69:
    s_add_u32 m0, s45, 0
    s_add_u32 s59, s44, 0
    buffer_load_dwordx4 v2, s[20:23], s59 offen sc1 lds
    buffer_load_dwordx4 v2, s[20:23], s59 offen offset:1024 sc1 lds
    s_mov_b64 exec, 0xffffff
    buffer_load_dwordx4 v2, s[20:23], s59 offen offset:2048 sc1 lds
    s_mov_b64 exec, -1
    s_mov_b32 s28, 4
    s_and_b32 s56, s60, 0xf0
    s_cbranch_scc1 LAhave_66
    s_add_u32 m0, s45, 9728
    s_add_u32 s59, s44, 9728
    buffer_load_dwordx4 v2, s[20:23], s59 offen sc1 lds
    buffer_load_dwordx4 v2, s[20:23], s59 offen offset:1024 sc1 lds
    s_mov_b64 exec, 0xffffff
    buffer_load_dwordx4 v2, s[20:23], s59 offen offset:2048 sc1 lds
    s_mov_b64 exec, -1
    s_mov_b32 s28, 1
    s_lshr_b64 s[60:61], vcc, s46
    s_and_b32 s56, s60, 0xff
    s_cbranch_scc1 LAhave_66
    s_add_u32 s56, s40, s4
    s_and_b32 s56, s56, 7
    s_mul_i32 s56, s56, 19456
    s_add_u32 s57, s40, 1
    s_and_b32 s57, s57, 3
    s_mul_i32 s57, s57, 19456
    s_add_u32 s57, s57, s42
    s_add_u32 s56, s56, s41
    s_mov_b32 m0, s57
    s_add_u32 s40, s40, 1
    buffer_load_dwordx4 v2, s[20:23], s56 offen offset:0 sc1 lds
    buffer_load_dwordx4 v2, s[20:23], s56 offen offset:1024 sc1 lds
    buffer_load_dwordx4 v2, s[20:23], s56 offen offset:2048 sc1 lds
    buffer_load_dwordx4 v2, s[20:23], s56 offen offset:3072 sc1 lds
    s_add_u32 m0, s57, 4096
    s_add_u32 s56, s56, 4096
    s_mov_b32 exec_hi, 0xffff
    buffer_load_dwordx4 v2, s[20:23], s56 offen sc1 lds
    s_mov_b32 exec_hi, -1
    s_mov_b32 s28, 3
LAhave_66:
    buffer_load_dwordx2 v[44:45], v46, s[20:23], s27 offen sc1
    s_cmp_eq_u32 s28, 4
    s_cbranch_scc0 LApreJ_60
    s_waitcnt vmcnt(0)
    v_cmp_ne_u32 vcc, s6, v45
    s_nop 0
    s_lshr_b64 s[60:61], vcc, s30
    s_and_b32 s56, s60, 240
    s_cbranch_scc1 LApreJ_60
    s_add_u32 m0, s45, 9728
    s_add_u32 s59, s44, 9728
    buffer_load_dwordx4 v2, s[20:23], s59 offen sc1 lds
    buffer_load_dwordx4 v2, s[20:23], s59 offen offset:1024 sc1 lds
    s_mov_b64 exec, 0xffffff
    buffer_load_dwordx4 v2, s[20:23], s59 offen offset:2048 sc1 lds
    s_mov_b64 exec, -1
    s_mov_b32 s28, 1
    s_lshr_b64 s[60:61], vcc, s46
    s_and_b32 s56, s60, 0xff
    s_cbranch_scc1 LApreJ_60a
    s_add_u32 s56, s40, s4
    s_and_b32 s56, s56, 7
    s_mul_i32 s56, s56, 19456
    s_add_u32 s57, s40, 1
    s_and_b32 s57, s57, 3
    s_mul_i32 s57, s57, 19456
    s_add_u32 s57, s57, s42
    s_add_u32 s56, s56, s41
    s_mov_b32 m0, s57
    s_add_u32 s40, s40, 1
    buffer_load_dwordx4 v2, s[20:23], s56 offen offset:0 sc1 lds
    buffer_load_dwordx4 v2, s[20:23], s56 offen offset:1024 sc1 lds
    buffer_load_dwordx4 v2, s[20:23], s56 offen offset:2048 sc1 lds
    buffer_load_dwordx4 v2, s[20:23], s56 offen offset:3072 sc1 lds
    s_add_u32 m0, s57, 4096
    s_add_u32 s56, s56, 4096
    s_mov_b32 exec_hi, 0xffff
    buffer_load_dwordx4 v2, s[20:23], s56 offen sc1 lds
    s_mov_b32 exec_hi, -1
    s_mov_b32 s28, 3
LApreJ_60a:
    buffer_load_dwordx2 v[44:45], v46, s[20:23], s27 offen sc1
LApreJ_60:
    s_lshl_b32 s56, s3, 11
    s_lshl_b32 s57, s3, 10
    s_add_u32 s56, s56, 105472
    s_add_u32 s57, s57, 121856
    v_add_u32 v27, s56, v2
    v_add_u32 v252, s57, v2
    s_xor_b32 s58, s3, 4
    s_lshl_b32 s56, s58, 11
    s_lshl_b32 s57, s58, 10
    s_add_u32 s56, s56, 105472
    s_add_u32 s57, s57, 121856
    v_add_u32 v6, s56, v2
    v_add_u32 v7, s57, v2
    v_bfe_u32 v8, v1, 4, 1
    v_lshrrev_b32 v9, 5, v1
    v_and_b32 v47, 15, v1
    v_lshlrev_b32 v47, 4, v47
    v_lshl_add_u32 v9, v9, 8, v47
    v_lshl_add_u32 v9, v8, 14, v9
    v_lshl_add_u32 v8, v8, 11, v47
    v_add_u32 v3, 58368, v157
    v_add_u32 v4, 58368, v158
    v_add_u32 v5, 58368, v159
    s_waitcnt vmcnt(9)
    s_cmp_eq_u32 s28, 3
    s_cbranch_scc1 LApreJ_60w
    s_waitcnt vmcnt(4)
LApreJ_60w:
    s_barrier
    ds_read_b128 v[20:23], v157 offset:38912
    ds_read_b32 v24, v158 offset:40960
    ds_read_b128 v[28:31], v159 offset:41216
    ds_read_b128 v[32:35], v159 offset:41856
    s_waitcnt lgkmcnt(3)
    v_mfma_f32_32x32x16_bf16 v[80:95], v[20:23], v[12:15], 0
    v_mfma_f32_32x32x16_bf16 v[96:111], v[20:23], v[16:19], 0
    ds_read_b128 v[20:23], v157 offset:39936
    s_waitcnt lgkmcnt(3)
    s_nop 7
    v_mfma_f32_32x32x4_2b_bf16 v[80:111], v[24:25], v[10:11], v[80:111] cbsz:1 abid:0
    s_nop 15
    s_nop 2
    s_waitcnt lgkmcnt(0)
    v_exp_f32 v80, v80
    v_exp_f32 v81, v81
    v_smfmac_f32_32x32x32_bf16 v[64:79], v[40:43], v[136:143], v26
    ds_read_b128 v[36:39], v159 offset:42496
    v_exp_f32 v82, v82
    v_exp_f32 v83, v83
    v_exp_f32 v84, v84
    v_mfma_f32_32x32x16_bf16 v[112:127], v[20:23], v[12:15], 0
    ds_read_b128 v[40:43], v159 offset:43136
    v_exp_f32 v85, v85
    v_exp_f32 v86, v86
    v_exp_f32 v87, v87
    v_mfma_f32_32x32x16_bf16 v[128:143], v[20:23], v[16:19], 0
    s_cmp_eq_u32 s28, 4
    s_cbranch_scc1 Lh0_78p
Lh0_78q:
    s_waitcnt vmcnt(6)
    s_cmp_eq_u32 s28, 3
    s_cbranch_scc1 Lh0_78w
    s_waitcnt vmcnt(0)
Lh0_78w:
    s_barrier
    s_cmp_eq_u32 s28, 1
    s_cbranch_scc1 Lh0_78
Lh0b_79:
    ds_read_b128 v[20:23], v157 offset:48640
    v_exp_f32 v88, v88
    v_exp_f32 v89, v89
    v_exp_f32 v90, v90
    v_exp_f32 v91, v91
    v_smfmac_f32_32x32x32_bf16 v[48:63], v[28:31], v[80:87], v26
    s_nop 0
    v_exp_f32 v92, v92
    v_exp_f32 v93, v93
    v_exp_f32 v94, v94
    v_mfma_f32_32x32x4_2b_bf16 v[112:143], v[24:25], v[10:11], v[112:143] cbsz:1 abid:1
    v_exp_f32 v95, v95
    v_exp_f32 v96, v96
    v_exp_f32 v97, v97
    v_exp_f32 v98, v98
    v_exp_f32 v99, v99
    v_exp_f32 v100, v100
    v_exp_f32 v101, v101
    v_exp_f32 v102, v102
    v_smfmac_f32_32x32x32_bf16 v[48:63], v[32:35], v[88:95], v26
    ds_read_b32 v24, v158 offset:50688
    v_exp_f32 v103, v103
    v_exp_f32 v104, v104
    v_exp_f32 v105, v105
    v_exp_f32 v106, v106
    v_smfmac_f32_32x32x32_bf16 v[64:79], v[28:31], v[96:103], v26
    s_waitcnt lgkmcnt(1)
    v_exp_f32 v107, v107
    v_exp_f32 v108, v108
    v_exp_f32 v109, v109
    v_exp_f32 v110, v110
    v_exp_f32 v111, v111
    v_exp_f32 v112, v112
    v_exp_f32 v113, v113
    v_smfmac_f32_32x32x32_bf16 v[64:79], v[32:35], v[104:111], v26
    ds_read_b128 v[28:31], v159 offset:50944
    v_exp_f32 v114, v114
    v_exp_f32 v115, v115
    v_exp_f32 v116, v116
    v_mfma_f32_32x32x16_bf16 v[80:95], v[20:23], v[12:15], 0
    ds_read_b128 v[32:35], v159 offset:51584
    v_exp_f32 v117, v117
    v_exp_f32 v118, v118
    v_exp_f32 v119, v119
    v_mfma_f32_32x32x16_bf16 v[96:111], v[20:23], v[16:19], 0
    ds_read_b128 v[20:23], v157 offset:49664
    v_exp_f32 v120, v120
    v_exp_f32 v121, v121
    v_exp_f32 v122, v122
    v_exp_f32 v123, v123
    v_smfmac_f32_32x32x32_bf16 v[48:63], v[36:39], v[112:119], v26
    s_waitcnt lgkmcnt(3)
    v_exp_f32 v124, v124
    v_exp_f32 v125, v125
    v_exp_f32 v126, v126
    v_mfma_f32_32x32x4_2b_bf16 v[80:111], v[24:25], v[10:11], v[80:111] cbsz:1 abid:0
    v_exp_f32 v127, v127
    v_exp_f32 v128, v128
    v_exp_f32 v129, v129
    v_exp_f32 v130, v130
    v_exp_f32 v131, v131
    v_exp_f32 v132, v132
    v_exp_f32 v133, v133
    v_exp_f32 v134, v134
    v_smfmac_f32_32x32x32_bf16 v[48:63], v[40:43], v[120:127], v26
    v_exp_f32 v135, v135
    v_exp_f32 v136, v136
    v_exp_f32 v137, v137
    v_exp_f32 v138, v138
    v_smfmac_f32_32x32x32_bf16 v[64:79], v[36:39], v[128:135], v26
    s_waitcnt lgkmcnt(0)
    v_exp_f32 v139, v139
    v_exp_f32 v140, v140
    v_exp_f32 v141, v141
    v_exp_f32 v142, v142
    v_exp_f32 v143, v143
    v_exp_f32 v80, v80
    v_exp_f32 v81, v81
    v_smfmac_f32_32x32x32_bf16 v[64:79], v[40:43], v[136:143], v26
    ds_read_b128 v[36:39], v159 offset:52224
    v_exp_f32 v82, v82
    v_exp_f32 v83, v83
    v_exp_f32 v84, v84
    v_mfma_f32_32x32x16_bf16 v[112:127], v[20:23], v[12:15], 0
    ds_read_b128 v[40:43], v159 offset:52864
    v_exp_f32 v85, v85
    v_exp_f32 v86, v86
    v_exp_f32 v87, v87
    v_mfma_f32_32x32x16_bf16 v[128:143], v[20:23], v[16:19], 0
    s_cmp_eq_u32 s28, 2
    s_cbranch_scc0 LAhook_61
LAhookb_62:
    s_waitcnt vmcnt(0) lgkmcnt(0)
    s_barrier
    s_cmp_eq_u32 s10, 1
    s_cbranch_scc1 Ljob_70
Ljobb_71:
    ds_read_b128 v[20:23], v3 offset:0
    v_exp_f32 v88, v88
    v_exp_f32 v89, v89
    v_exp_f32 v90, v90
    v_exp_f32 v91, v91
    v_smfmac_f32_32x32x32_bf16 v[48:63], v[28:31], v[80:87], v26
    s_nop 0
    v_exp_f32 v92, v92
    v_exp_f32 v93, v93
    v_exp_f32 v94, v94
    v_mfma_f32_32x32x4_2b_bf16 v[112:143], v[24:25], v[10:11], v[112:143] cbsz:1 abid:1
    v_exp_f32 v95, v95
    v_exp_f32 v96, v96
    v_exp_f32 v97, v97
    v_exp_f32 v98, v98
    v_exp_f32 v99, v99
    v_exp_f32 v100, v100
    v_exp_f32 v101, v101
    v_exp_f32 v102, v102
    v_smfmac_f32_32x32x32_bf16 v[48:63], v[32:35], v[88:95], v26
    ds_read_b32 v24, v4 offset:2048
    v_exp_f32 v103, v103
    v_exp_f32 v104, v104
    v_exp_f32 v105, v105
    v_exp_f32 v106, v106
    v_smfmac_f32_32x32x32_bf16 v[64:79], v[28:31], v[96:103], v26
    s_waitcnt lgkmcnt(1)
    v_exp_f32 v107, v107
    v_exp_f32 v108, v108
    v_exp_f32 v109, v109
    v_exp_f32 v110, v110
    v_exp_f32 v111, v111
    v_exp_f32 v112, v112
    v_exp_f32 v113, v113
    v_smfmac_f32_32x32x32_bf16 v[64:79], v[32:35], v[104:111], v26
    ds_read_b128 v[28:31], v5 offset:2304
    v_exp_f32 v114, v114
    v_exp_f32 v115, v115
    v_exp_f32 v116, v116
    v_mfma_f32_32x32x16_bf16 v[80:95], v[20:23], v[12:15], 0
    ds_read_b128 v[32:35], v5 offset:2944
    v_exp_f32 v117, v117
    v_exp_f32 v118, v118
    v_exp_f32 v119, v119
    v_mfma_f32_32x32x16_bf16 v[96:111], v[20:23], v[16:19], 0
    ds_read_b128 v[20:23], v3 offset:1024
    v_exp_f32 v120, v120
    v_exp_f32 v121, v121
    v_exp_f32 v122, v122
    v_exp_f32 v123, v123
    v_smfmac_f32_32x32x32_bf16 v[48:63], v[36:39], v[112:119], v26
    s_waitcnt lgkmcnt(3)
    v_exp_f32 v124, v124
    v_exp_f32 v125, v125
    v_exp_f32 v126, v126
    v_mfma_f32_32x32x4_2b_bf16 v[80:111], v[24:25], v[10:11], v[80:111] cbsz:1 abid:0
    v_exp_f32 v127, v127
    v_exp_f32 v128, v128
    v_exp_f32 v129, v129
    v_exp_f32 v130, v130
    v_exp_f32 v131, v131
    v_exp_f32 v132, v132
    v_exp_f32 v133, v133
    v_exp_f32 v134, v134
    v_smfmac_f32_32x32x32_bf16 v[48:63], v[40:43], v[120:127], v26
    v_exp_f32 v135, v135
    v_exp_f32 v136, v136
    v_exp_f32 v137, v137
    v_exp_f32 v138, v138
    v_smfmac_f32_32x32x32_bf16 v[64:79], v[36:39], v[128:135], v26
    s_waitcnt lgkmcnt(0)
    v_exp_f32 v139, v139
    v_exp_f32 v140, v140
    v_exp_f32 v141, v141
    v_exp_f32 v142, v142
    v_exp_f32 v143, v143
    v_exp_f32 v80, v80
    v_exp_f32 v81, v81
    v_smfmac_f32_32x32x32_bf16 v[64:79], v[40:43], v[136:143], v26
    ds_read_b128 v[36:39], v5 offset:3584
    v_exp_f32 v82, v82
    v_exp_f32 v83, v83
    v_exp_f32 v84, v84
    v_mfma_f32_32x32x16_bf16 v[112:127], v[20:23], v[12:15], 0
    ds_read_b128 v[40:43], v5 offset:4224
    v_exp_f32 v85, v85
    v_exp_f32 v86, v86
    v_exp_f32 v87, v87
    v_mfma_f32_32x32x16_bf16 v[128:143], v[20:23], v[16:19], 0
    ds_read_b128 v[20:23], v3 offset:9728
    v_exp_f32 v88, v88
    v_exp_f32 v89, v89
    v_exp_f32 v90, v90
    v_exp_f32 v91, v91
    v_smfmac_f32_32x32x32_bf16 v[48:63], v[28:31], v[80:87], v26
    s_nop 0
    v_exp_f32 v92, v92
    v_exp_f32 v93, v93
    v_exp_f32 v94, v94
    v_mfma_f32_32x32x4_2b_bf16 v[112:143], v[24:25], v[10:11], v[112:143] cbsz:1 abid:1
    v_exp_f32 v95, v95
    v_exp_f32 v96, v96
    v_exp_f32 v97, v97
    v_exp_f32 v98, v98
    v_exp_f32 v99, v99
    v_exp_f32 v100, v100
    v_exp_f32 v101, v101
    v_exp_f32 v102, v102
    v_smfmac_f32_32x32x32_bf16 v[48:63], v[32:35], v[88:95], v26
    ds_read_b32 v24, v4 offset:11776
    v_exp_f32 v103, v103
    v_exp_f32 v104, v104
    v_exp_f32 v105, v105
    v_exp_f32 v106, v106
    v_smfmac_f32_32x32x32_bf16 v[64:79], v[28:31], v[96:103], v26
    s_waitcnt lgkmcnt(1)
    v_exp_f32 v107, v107
    v_exp_f32 v108, v108
    v_exp_f32 v109, v109
    v_exp_f32 v110, v110
    v_exp_f32 v111, v111
    v_exp_f32 v112, v112
    v_exp_f32 v113, v113
    v_smfmac_f32_32x32x32_bf16 v[64:79], v[32:35], v[104:111], v26
    ds_read_b128 v[28:31], v5 offset:12032
    v_exp_f32 v114, v114
    v_exp_f32 v115, v115
    v_exp_f32 v116, v116
    v_mfma_f32_32x32x16_bf16 v[80:95], v[20:23], v[12:15], 0
    ds_read_b128 v[32:35], v5 offset:12672
    v_exp_f32 v117, v117
    v_exp_f32 v118, v118
    v_exp_f32 v119, v119
    v_mfma_f32_32x32x16_bf16 v[96:111], v[20:23], v[16:19], 0
    ds_read_b128 v[20:23], v3 offset:10752
    v_exp_f32 v120, v120
    v_exp_f32 v121, v121
    v_exp_f32 v122, v122
    v_exp_f32 v123, v123
    v_smfmac_f32_32x32x32_bf16 v[48:63], v[36:39], v[112:119], v26
    s_waitcnt lgkmcnt(3)
    v_exp_f32 v124, v124
    v_exp_f32 v125, v125
    v_exp_f32 v126, v126
    v_mfma_f32_32x32x4_2b_bf16 v[80:111], v[24:25], v[10:11], v[80:111] cbsz:1 abid:0
    v_exp_f32 v127, v127
    v_exp_f32 v128, v128
    v_exp_f32 v129, v129
    v_exp_f32 v130, v130
    v_exp_f32 v131, v131
    v_exp_f32 v132, v132
    v_exp_f32 v133, v133
    v_exp_f32 v134, v134
    v_smfmac_f32_32x32x32_bf16 v[48:63], v[40:43], v[120:127], v26
    v_exp_f32 v135, v135
    v_exp_f32 v136, v136
    v_exp_f32 v137, v137
    v_exp_f32 v138, v138
    v_smfmac_f32_32x32x32_bf16 v[64:79], v[36:39], v[128:135], v26
    s_waitcnt lgkmcnt(0)
    v_exp_f32 v139, v139
    v_exp_f32 v140, v140
    v_exp_f32 v141, v141
    v_exp_f32 v142, v142
    v_exp_f32 v143, v143
    v_exp_f32 v80, v80
    v_exp_f32 v81, v81
    v_smfmac_f32_32x32x32_bf16 v[64:79], v[40:43], v[136:143], v26
    ds_read_b128 v[36:39], v5 offset:13312
    v_exp_f32 v82, v82
    v_exp_f32 v83, v83
    v_exp_f32 v84, v84
    v_mfma_f32_32x32x16_bf16 v[112:127], v[20:23], v[12:15], 0
    ds_read_b128 v[40:43], v5 offset:13952
    v_exp_f32 v85, v85
    v_exp_f32 v86, v86
    v_exp_f32 v87, v87
    v_mfma_f32_32x32x16_bf16 v[128:143], v[20:23], v[16:19], 0
    s_waitcnt vmcnt(5) lgkmcnt(0)
    s_barrier
    s_cmp_eq_u32 s10, 1
    s_cbranch_scc1 Ljob_72
Ljobb_73:
    ds_read_b128 v[20:23], v157 offset:0
    v_exp_f32 v88, v88
    v_exp_f32 v89, v89
    v_exp_f32 v90, v90
    v_exp_f32 v91, v91
    v_smfmac_f32_32x32x32_bf16 v[48:63], v[28:31], v[80:87], v26
    s_nop 0
    v_exp_f32 v92, v92
    v_exp_f32 v93, v93
    v_exp_f32 v94, v94
    v_mfma_f32_32x32x4_2b_bf16 v[112:143], v[24:25], v[10:11], v[112:143] cbsz:1 abid:1
    v_exp_f32 v95, v95
    v_exp_f32 v96, v96
    v_exp_f32 v97, v97
    v_exp_f32 v98, v98
    v_exp_f32 v99, v99
    v_exp_f32 v100, v100
    v_exp_f32 v101, v101
    v_exp_f32 v102, v102
    v_smfmac_f32_32x32x32_bf16 v[48:63], v[32:35], v[88:95], v26
    ds_read_b32 v24, v158 offset:2048
    v_exp_f32 v103, v103
    v_exp_f32 v104, v104
    v_exp_f32 v105, v105
    v_exp_f32 v106, v106
    v_smfmac_f32_32x32x32_bf16 v[64:79], v[28:31], v[96:103], v26
    s_waitcnt lgkmcnt(1)
    v_exp_f32 v107, v107
    v_exp_f32 v108, v108
    v_exp_f32 v109, v109
    v_exp_f32 v110, v110
    v_exp_f32 v111, v111
    v_exp_f32 v112, v112
    v_exp_f32 v113, v113
    v_smfmac_f32_32x32x32_bf16 v[64:79], v[32:35], v[104:111], v26
    ds_read_b128 v[28:31], v159 offset:2304
    v_exp_f32 v114, v114
    v_exp_f32 v115, v115
    v_exp_f32 v116, v116
    v_mfma_f32_32x32x16_bf16 v[80:95], v[20:23], v[12:15], 0
    ds_read_b128 v[32:35], v159 offset:2944
    v_exp_f32 v117, v117
    v_exp_f32 v118, v118
    v_exp_f32 v119, v119
    v_mfma_f32_32x32x16_bf16 v[96:111], v[20:23], v[16:19], 0
    ds_read_b128 v[20:23], v157 offset:1024
    v_exp_f32 v120, v120
    v_exp_f32 v121, v121
    v_exp_f32 v122, v122
    v_exp_f32 v123, v123
    v_smfmac_f32_32x32x32_bf16 v[48:63], v[36:39], v[112:119], v26
    s_waitcnt lgkmcnt(3)
    v_exp_f32 v124, v124
    v_exp_f32 v125, v125
    v_exp_f32 v126, v126
    v_mfma_f32_32x32x4_2b_bf16 v[80:111], v[24:25], v[10:11], v[80:111] cbsz:1 abid:0
    v_exp_f32 v127, v127
    v_exp_f32 v128, v128
    v_exp_f32 v129, v129
    v_exp_f32 v130, v130
    v_exp_f32 v131, v131
    v_exp_f32 v132, v132
    v_exp_f32 v133, v133
    v_exp_f32 v134, v134
    v_smfmac_f32_32x32x32_bf16 v[48:63], v[40:43], v[120:127], v26
    v_exp_f32 v135, v135
    v_exp_f32 v136, v136
    v_exp_f32 v137, v137
    v_exp_f32 v138, v138
    v_smfmac_f32_32x32x32_bf16 v[64:79], v[36:39], v[128:135], v26
    s_waitcnt lgkmcnt(0)
    v_exp_f32 v139, v139
    v_exp_f32 v140, v140
    v_exp_f32 v141, v141
    v_exp_f32 v142, v142
    v_exp_f32 v143, v143
    v_exp_f32 v80, v80
    v_exp_f32 v81, v81
    v_smfmac_f32_32x32x32_bf16 v[64:79], v[40:43], v[136:143], v26
    ds_read_b128 v[36:39], v159 offset:3584
    v_exp_f32 v82, v82
    v_exp_f32 v83, v83
    v_exp_f32 v84, v84
    v_mfma_f32_32x32x16_bf16 v[112:127], v[20:23], v[12:15], 0
    ds_read_b128 v[40:43], v159 offset:4224
    v_exp_f32 v85, v85
    v_exp_f32 v86, v86
    v_exp_f32 v87, v87
    v_mfma_f32_32x32x16_bf16 v[128:143], v[20:23], v[16:19], 0
    ds_read_b128 v[20:23], v157 offset:9728
    v_exp_f32 v88, v88
    v_exp_f32 v89, v89
    v_exp_f32 v90, v90
    v_exp_f32 v91, v91
    v_smfmac_f32_32x32x32_bf16 v[48:63], v[28:31], v[80:87], v26
    s_nop 0
    v_exp_f32 v92, v92
    v_exp_f32 v93, v93
    v_exp_f32 v94, v94
    v_mfma_f32_32x32x4_2b_bf16 v[112:143], v[24:25], v[10:11], v[112:143] cbsz:1 abid:1
    v_exp_f32 v95, v95
    v_exp_f32 v96, v96
    v_exp_f32 v97, v97
    v_exp_f32 v98, v98
    v_exp_f32 v99, v99
    v_exp_f32 v100, v100
    v_exp_f32 v101, v101
    v_exp_f32 v102, v102
    v_smfmac_f32_32x32x32_bf16 v[48:63], v[32:35], v[88:95], v26
    ds_read_b32 v24, v158 offset:11776
    v_exp_f32 v103, v103
    v_exp_f32 v104, v104
    v_exp_f32 v105, v105
    v_exp_f32 v106, v106
    v_smfmac_f32_32x32x32_bf16 v[64:79], v[28:31], v[96:103], v26
    s_waitcnt lgkmcnt(1)
    v_exp_f32 v107, v107
    v_exp_f32 v108, v108
    v_exp_f32 v109, v109
    v_exp_f32 v110, v110
    v_exp_f32 v111, v111
    v_exp_f32 v112, v112
    v_exp_f32 v113, v113
    v_smfmac_f32_32x32x32_bf16 v[64:79], v[32:35], v[104:111], v26
    ds_read_b128 v[28:31], v159 offset:12032
    v_exp_f32 v114, v114
    v_exp_f32 v115, v115
    v_exp_f32 v116, v116
    v_mfma_f32_32x32x16_bf16 v[80:95], v[20:23], v[12:15], 0
    ds_read_b128 v[32:35], v159 offset:12672
    v_exp_f32 v117, v117
    v_exp_f32 v118, v118
    v_exp_f32 v119, v119
    v_mfma_f32_32x32x16_bf16 v[96:111], v[20:23], v[16:19], 0
    ds_read_b128 v[20:23], v157 offset:10752
    v_exp_f32 v120, v120
    v_exp_f32 v121, v121
    v_exp_f32 v122, v122
    v_exp_f32 v123, v123
    v_smfmac_f32_32x32x32_bf16 v[48:63], v[36:39], v[112:119], v26
    s_waitcnt lgkmcnt(3)
    v_exp_f32 v124, v124
    v_exp_f32 v125, v125
    v_exp_f32 v126, v126
    v_mfma_f32_32x32x4_2b_bf16 v[80:111], v[24:25], v[10:11], v[80:111] cbsz:1 abid:0
    v_exp_f32 v127, v127
    v_exp_f32 v128, v128
    v_exp_f32 v129, v129
    v_exp_f32 v130, v130
    v_exp_f32 v131, v131
    v_exp_f32 v132, v132
    v_exp_f32 v133, v133
    v_exp_f32 v134, v134
    v_smfmac_f32_32x32x32_bf16 v[48:63], v[40:43], v[120:127], v26
    v_exp_f32 v135, v135
    v_exp_f32 v136, v136
    v_exp_f32 v137, v137
    v_exp_f32 v138, v138
    v_smfmac_f32_32x32x32_bf16 v[64:79], v[36:39], v[128:135], v26
    s_waitcnt lgkmcnt(0)
    v_exp_f32 v139, v139
    v_exp_f32 v140, v140
    v_exp_f32 v141, v141
    v_exp_f32 v142, v142
    v_exp_f32 v143, v143
    v_exp_f32 v80, v80
    v_exp_f32 v81, v81
    v_smfmac_f32_32x32x32_bf16 v[64:79], v[40:43], v[136:143], v26
    ds_read_b128 v[36:39], v159 offset:13312
    v_exp_f32 v82, v82
    v_exp_f32 v83, v83
    v_exp_f32 v84, v84
    v_mfma_f32_32x32x16_bf16 v[112:127], v[20:23], v[12:15], 0
    ds_read_b128 v[40:43], v159 offset:13952
    v_exp_f32 v85, v85
    v_exp_f32 v86, v86
    v_exp_f32 v87, v87
    v_mfma_f32_32x32x16_bf16 v[128:143], v[20:23], v[16:19], 0
    s_waitcnt vmcnt(0) lgkmcnt(0)
    s_barrier
    s_cmp_eq_u32 s10, 1
    s_cbranch_scc1 Ljob_74
Ljobb_75:
    ds_read_b128 v[20:23], v157 offset:19456
    v_exp_f32 v88, v88
    v_exp_f32 v89, v89
    v_exp_f32 v90, v90
    v_exp_f32 v91, v91
    v_smfmac_f32_32x32x32_bf16 v[48:63], v[28:31], v[80:87], v26
    s_nop 0
    v_exp_f32 v92, v92
    v_exp_f32 v93, v93
    v_exp_f32 v94, v94
    v_mfma_f32_32x32x4_2b_bf16 v[112:143], v[24:25], v[10:11], v[112:143] cbsz:1 abid:1
    v_exp_f32 v95, v95
    v_exp_f32 v96, v96
    v_exp_f32 v97, v97
    v_exp_f32 v98, v98
    v_exp_f32 v99, v99
    v_exp_f32 v100, v100
    v_exp_f32 v101, v101
    v_exp_f32 v102, v102
    v_smfmac_f32_32x32x32_bf16 v[48:63], v[32:35], v[88:95], v26
    ds_read_b32 v24, v158 offset:21504
    v_exp_f32 v103, v103
    v_exp_f32 v104, v104
    v_exp_f32 v105, v105
    v_exp_f32 v106, v106
    v_smfmac_f32_32x32x32_bf16 v[64:79], v[28:31], v[96:103], v26
    s_waitcnt lgkmcnt(1)
    v_exp_f32 v107, v107
    v_exp_f32 v108, v108
    v_exp_f32 v109, v109
    v_exp_f32 v110, v110
    v_exp_f32 v111, v111
    v_exp_f32 v112, v112
    v_exp_f32 v113, v113
    v_smfmac_f32_32x32x32_bf16 v[64:79], v[32:35], v[104:111], v26
    ds_read_b128 v[28:31], v159 offset:21760
    v_exp_f32 v114, v114
    v_exp_f32 v115, v115
    v_exp_f32 v116, v116
    v_mfma_f32_32x32x16_bf16 v[80:95], v[20:23], v[12:15], 0
    ds_read_b128 v[32:35], v159 offset:22400
    v_exp_f32 v117, v117
    v_exp_f32 v118, v118
    v_exp_f32 v119, v119
    v_mfma_f32_32x32x16_bf16 v[96:111], v[20:23], v[16:19], 0
    ds_read_b128 v[20:23], v157 offset:20480
    v_exp_f32 v120, v120
    v_exp_f32 v121, v121
    v_exp_f32 v122, v122
    v_exp_f32 v123, v123
    v_smfmac_f32_32x32x32_bf16 v[48:63], v[36:39], v[112:119], v26
    s_waitcnt lgkmcnt(3)
    v_exp_f32 v124, v124
    v_exp_f32 v125, v125
    v_exp_f32 v126, v126
    v_mfma_f32_32x32x4_2b_bf16 v[80:111], v[24:25], v[10:11], v[80:111] cbsz:1 abid:0
    v_exp_f32 v127, v127
    v_exp_f32 v128, v128
    v_exp_f32 v129, v129
    v_exp_f32 v130, v130
    v_exp_f32 v131, v131
    v_exp_f32 v132, v132
    v_exp_f32 v133, v133
    v_exp_f32 v134, v134
    v_smfmac_f32_32x32x32_bf16 v[48:63], v[40:43], v[120:127], v26
    v_exp_f32 v135, v135
    v_exp_f32 v136, v136
    v_exp_f32 v137, v137
    v_exp_f32 v138, v138
    v_smfmac_f32_32x32x32_bf16 v[64:79], v[36:39], v[128:135], v26
    s_waitcnt lgkmcnt(0)
    v_exp_f32 v139, v139
    v_exp_f32 v140, v140
    v_exp_f32 v141, v141
    v_exp_f32 v142, v142
    v_exp_f32 v143, v143
    v_exp_f32 v80, v80
    v_exp_f32 v81, v81
    v_smfmac_f32_32x32x32_bf16 v[64:79], v[40:43], v[136:143], v26
    ds_read_b128 v[36:39], v159 offset:23040
    v_exp_f32 v82, v82
    v_exp_f32 v83, v83
    v_exp_f32 v84, v84
    v_mfma_f32_32x32x16_bf16 v[112:127], v[20:23], v[12:15], 0
    ds_read_b128 v[40:43], v159 offset:23680
    v_exp_f32 v85, v85
    v_exp_f32 v86, v86
    v_exp_f32 v87, v87
    v_mfma_f32_32x32x16_bf16 v[128:143], v[20:23], v[16:19], 0
    ds_read_b128 v[20:23], v157 offset:29184
    v_exp_f32 v88, v88
    v_exp_f32 v89, v89
    v_exp_f32 v90, v90
    v_exp_f32 v91, v91
    v_smfmac_f32_32x32x32_bf16 v[48:63], v[28:31], v[80:87], v26
    s_nop 0
    v_exp_f32 v92, v92
    v_exp_f32 v93, v93
    v_exp_f32 v94, v94
    v_mfma_f32_32x32x4_2b_bf16 v[112:143], v[24:25], v[10:11], v[112:143] cbsz:1 abid:1
    v_exp_f32 v95, v95
    v_exp_f32 v96, v96
    v_exp_f32 v97, v97
    v_exp_f32 v98, v98
    v_exp_f32 v99, v99
    v_exp_f32 v100, v100
    v_exp_f32 v101, v101
    v_exp_f32 v102, v102
    v_smfmac_f32_32x32x32_bf16 v[48:63], v[32:35], v[88:95], v26
    ds_read_b32 v24, v158 offset:31232
    v_exp_f32 v103, v103
    v_exp_f32 v104, v104
    v_exp_f32 v105, v105
    v_exp_f32 v106, v106
    v_smfmac_f32_32x32x32_bf16 v[64:79], v[28:31], v[96:103], v26
    s_waitcnt lgkmcnt(1)
    v_exp_f32 v107, v107
    v_exp_f32 v108, v108
    v_exp_f32 v109, v109
    v_exp_f32 v110, v110
    v_exp_f32 v111, v111
    v_exp_f32 v112, v112
    v_exp_f32 v113, v113
    v_smfmac_f32_32x32x32_bf16 v[64:79], v[32:35], v[104:111], v26
    ds_read_b128 v[28:31], v159 offset:31488
    v_exp_f32 v114, v114
    v_exp_f32 v115, v115
    v_exp_f32 v116, v116
    v_mfma_f32_32x32x16_bf16 v[80:95], v[20:23], v[12:15], 0
    ds_read_b128 v[32:35], v159 offset:32128
    v_exp_f32 v117, v117
    v_exp_f32 v118, v118
    v_exp_f32 v119, v119
    v_mfma_f32_32x32x16_bf16 v[96:111], v[20:23], v[16:19], 0
    ds_read_b128 v[20:23], v157 offset:30208
    v_exp_f32 v120, v120
    v_exp_f32 v121, v121
    v_exp_f32 v122, v122
    v_exp_f32 v123, v123
    v_smfmac_f32_32x32x32_bf16 v[48:63], v[36:39], v[112:119], v26
    s_waitcnt lgkmcnt(3)
    v_exp_f32 v124, v124
    v_exp_f32 v125, v125
    v_exp_f32 v126, v126
    v_mfma_f32_32x32x4_2b_bf16 v[80:111], v[24:25], v[10:11], v[80:111] cbsz:1 abid:0
    v_exp_f32 v127, v127
    v_exp_f32 v128, v128
    v_exp_f32 v129, v129
    v_exp_f32 v130, v130
    v_exp_f32 v131, v131
    v_exp_f32 v132, v132
    v_exp_f32 v133, v133
    v_exp_f32 v134, v134
    v_smfmac_f32_32x32x32_bf16 v[48:63], v[40:43], v[120:127], v26
    v_exp_f32 v135, v135
    v_exp_f32 v136, v136
    v_exp_f32 v137, v137
    v_exp_f32 v138, v138
    v_smfmac_f32_32x32x32_bf16 v[64:79], v[36:39], v[128:135], v26
    s_waitcnt lgkmcnt(0)
    v_exp_f32 v139, v139
    v_exp_f32 v140, v140
    v_exp_f32 v141, v141
    v_exp_f32 v142, v142
    v_exp_f32 v143, v143
    v_exp_f32 v80, v80
    v_exp_f32 v81, v81
    v_smfmac_f32_32x32x32_bf16 v[64:79], v[40:43], v[136:143], v26
    ds_read_b128 v[36:39], v159 offset:32768
    v_exp_f32 v82, v82
    v_exp_f32 v83, v83
    v_exp_f32 v84, v84
    v_mfma_f32_32x32x16_bf16 v[112:127], v[20:23], v[12:15], 0
    ds_read_b128 v[40:43], v159 offset:33408
    v_exp_f32 v85, v85
    v_exp_f32 v86, v86
    v_exp_f32 v87, v87
    v_mfma_f32_32x32x16_bf16 v[128:143], v[20:23], v[16:19], 0
    ds_read_b128 v[20:23], v157 offset:38912
    v_exp_f32 v88, v88
    v_exp_f32 v89, v89
    v_exp_f32 v90, v90
    v_exp_f32 v91, v91
    v_smfmac_f32_32x32x32_bf16 v[48:63], v[28:31], v[80:87], v26
    s_nop 0
    v_exp_f32 v92, v92
    v_exp_f32 v93, v93
    v_exp_f32 v94, v94
    v_mfma_f32_32x32x4_2b_bf16 v[112:143], v[24:25], v[10:11], v[112:143] cbsz:1 abid:1
    v_exp_f32 v95, v95
    v_exp_f32 v96, v96
    v_exp_f32 v97, v97
    v_exp_f32 v98, v98
    v_exp_f32 v99, v99
    v_exp_f32 v100, v100
    v_exp_f32 v101, v101
    v_exp_f32 v102, v102
    v_smfmac_f32_32x32x32_bf16 v[48:63], v[32:35], v[88:95], v26
    ds_read_b32 v24, v158 offset:40960
    v_exp_f32 v103, v103
    v_exp_f32 v104, v104
    v_exp_f32 v105, v105
    v_exp_f32 v106, v106
    v_smfmac_f32_32x32x32_bf16 v[64:79], v[28:31], v[96:103], v26
    s_waitcnt lgkmcnt(1)
    v_exp_f32 v107, v107
    v_exp_f32 v108, v108
    v_exp_f32 v109, v109
    v_exp_f32 v110, v110
    v_exp_f32 v111, v111
    v_exp_f32 v112, v112
    v_exp_f32 v113, v113
    v_smfmac_f32_32x32x32_bf16 v[64:79], v[32:35], v[104:111], v26
    ds_read_b128 v[28:31], v159 offset:41216
    v_exp_f32 v114, v114
    v_exp_f32 v115, v115
    v_exp_f32 v116, v116
    v_mfma_f32_32x32x16_bf16 v[80:95], v[20:23], v[12:15], 0
    ds_read_b128 v[32:35], v159 offset:41856
    v_exp_f32 v117, v117
    v_exp_f32 v118, v118
    v_exp_f32 v119, v119
    v_mfma_f32_32x32x16_bf16 v[96:111], v[20:23], v[16:19], 0
    ds_read_b128 v[20:23], v157 offset:39936
    v_exp_f32 v120, v120
    v_exp_f32 v121, v121
    v_exp_f32 v122, v122
    v_exp_f32 v123, v123
    v_smfmac_f32_32x32x32_bf16 v[48:63], v[36:39], v[112:119], v26
    s_waitcnt lgkmcnt(3)
    v_exp_f32 v124, v124
    v_exp_f32 v125, v125
    v_exp_f32 v126, v126
    v_mfma_f32_32x32x4_2b_bf16 v[80:111], v[24:25], v[10:11], v[80:111] cbsz:1 abid:0
    v_exp_f32 v127, v127
    v_exp_f32 v128, v128
    v_exp_f32 v129, v129
    v_exp_f32 v130, v130
    v_exp_f32 v131, v131
    v_exp_f32 v132, v132
    v_exp_f32 v133, v133
    v_exp_f32 v134, v134
    v_smfmac_f32_32x32x32_bf16 v[48:63], v[40:43], v[120:127], v26
    v_exp_f32 v135, v135
    v_exp_f32 v136, v136
    v_exp_f32 v137, v137
    v_exp_f32 v138, v138
    v_smfmac_f32_32x32x32_bf16 v[64:79], v[36:39], v[128:135], v26
    s_waitcnt lgkmcnt(0)
    v_exp_f32 v139, v139
    v_exp_f32 v140, v140
    v_exp_f32 v141, v141
    v_exp_f32 v142, v142
    v_exp_f32 v143, v143
    v_exp_f32 v80, v80
    v_exp_f32 v81, v81
    v_smfmac_f32_32x32x32_bf16 v[64:79], v[40:43], v[136:143], v26
    ds_read_b128 v[36:39], v159 offset:42496
    v_exp_f32 v82, v82
    v_exp_f32 v83, v83
    v_exp_f32 v84, v84
    v_mfma_f32_32x32x16_bf16 v[112:127], v[20:23], v[12:15], 0
    ds_read_b128 v[40:43], v159 offset:43136
    v_exp_f32 v85, v85
    v_exp_f32 v86, v86
    v_exp_f32 v87, v87
    v_mfma_f32_32x32x16_bf16 v[128:143], v[20:23], v[16:19], 0
    ds_read_b128 v[20:23], v157 offset:48640
    v_exp_f32 v88, v88
    v_exp_f32 v89, v89
    v_exp_f32 v90, v90
    v_exp_f32 v91, v91
    v_smfmac_f32_32x32x32_bf16 v[48:63], v[28:31], v[80:87], v26
    s_nop 0
    v_exp_f32 v92, v92
    v_exp_f32 v93, v93
    v_exp_f32 v94, v94
    v_mfma_f32_32x32x4_2b_bf16 v[112:143], v[24:25], v[10:11], v[112:143] cbsz:1 abid:1
    v_exp_f32 v95, v95
    v_exp_f32 v96, v96
    v_exp_f32 v97, v97
    v_exp_f32 v98, v98
    v_exp_f32 v99, v99
    v_exp_f32 v100, v100
    v_exp_f32 v101, v101
    v_exp_f32 v102, v102
    v_smfmac_f32_32x32x32_bf16 v[48:63], v[32:35], v[88:95], v26
    ds_read_b32 v24, v158 offset:50688
    v_exp_f32 v103, v103
    v_exp_f32 v104, v104
    v_exp_f32 v105, v105
    v_exp_f32 v106, v106
    v_smfmac_f32_32x32x32_bf16 v[64:79], v[28:31], v[96:103], v26
    s_waitcnt lgkmcnt(1)
    v_exp_f32 v107, v107
    v_exp_f32 v108, v108
    v_exp_f32 v109, v109
    v_exp_f32 v110, v110
    v_exp_f32 v111, v111
    v_exp_f32 v112, v112
    v_exp_f32 v113, v113
    v_smfmac_f32_32x32x32_bf16 v[64:79], v[32:35], v[104:111], v26
    ds_read_b128 v[28:31], v159 offset:50944
    v_exp_f32 v114, v114
    v_exp_f32 v115, v115
    v_exp_f32 v116, v116
    v_mfma_f32_32x32x16_bf16 v[80:95], v[20:23], v[12:15], 0
    ds_read_b128 v[32:35], v159 offset:51584
    v_exp_f32 v117, v117
    v_exp_f32 v118, v118
    v_exp_f32 v119, v119
    v_mfma_f32_32x32x16_bf16 v[96:111], v[20:23], v[16:19], 0
    ds_read_b128 v[20:23], v157 offset:49664
    v_exp_f32 v120, v120
    v_exp_f32 v121, v121
    v_exp_f32 v122, v122
    v_exp_f32 v123, v123
    v_smfmac_f32_32x32x32_bf16 v[48:63], v[36:39], v[112:119], v26
    s_waitcnt lgkmcnt(3)
    v_exp_f32 v124, v124
    v_exp_f32 v125, v125
    v_exp_f32 v126, v126
    v_mfma_f32_32x32x4_2b_bf16 v[80:111], v[24:25], v[10:11], v[80:111] cbsz:1 abid:0
    v_exp_f32 v127, v127
    v_exp_f32 v128, v128
    v_exp_f32 v129, v129
    v_exp_f32 v130, v130
    v_exp_f32 v131, v131
    v_exp_f32 v132, v132
    v_exp_f32 v133, v133
    v_exp_f32 v134, v134
    v_smfmac_f32_32x32x32_bf16 v[48:63], v[40:43], v[120:127], v26
    v_exp_f32 v135, v135
    v_exp_f32 v136, v136
    v_exp_f32 v137, v137
    v_exp_f32 v138, v138
    v_smfmac_f32_32x32x32_bf16 v[64:79], v[36:39], v[128:135], v26
    s_waitcnt lgkmcnt(0)
    v_exp_f32 v139, v139
    v_exp_f32 v140, v140
    v_exp_f32 v141, v141
    v_exp_f32 v142, v142
    v_exp_f32 v143, v143
    v_exp_f32 v80, v80
    v_exp_f32 v81, v81
    v_smfmac_f32_32x32x32_bf16 v[64:79], v[40:43], v[136:143], v26
    ds_read_b128 v[36:39], v159 offset:52224
    v_exp_f32 v82, v82
    v_exp_f32 v83, v83
    v_exp_f32 v84, v84
    v_mfma_f32_32x32x16_bf16 v[112:127], v[20:23], v[12:15], 0
    ds_read_b128 v[40:43], v159 offset:52864
    v_exp_f32 v85, v85
    v_exp_f32 v86, v86
    v_exp_f32 v87, v87
    v_mfma_f32_32x32x16_bf16 v[128:143], v[20:23], v[16:19], 0
    s_waitcnt vmcnt(0) lgkmcnt(0)
    s_barrier
    ds_read_b128 v[20:23], v3 offset:0
    v_exp_f32 v88, v88
    v_exp_f32 v89, v89
    v_exp_f32 v90, v90
    v_exp_f32 v91, v91
    v_smfmac_f32_32x32x32_bf16 v[48:63], v[28:31], v[80:87], v26
    s_nop 0
    v_exp_f32 v92, v92
    v_exp_f32 v93, v93
    v_exp_f32 v94, v94
    v_mfma_f32_32x32x4_2b_bf16 v[112:143], v[24:25], v[10:11], v[112:143] cbsz:1 abid:1
    v_exp_f32 v95, v95
    v_exp_f32 v96, v96
    v_exp_f32 v97, v97
    v_exp_f32 v98, v98
    v_exp_f32 v99, v99
    v_exp_f32 v100, v100
    v_exp_f32 v101, v101
    v_exp_f32 v102, v102
    v_smfmac_f32_32x32x32_bf16 v[48:63], v[32:35], v[88:95], v26
    ds_read_b32 v24, v4 offset:2048
    v_exp_f32 v103, v103
    v_exp_f32 v104, v104
    v_exp_f32 v105, v105
    v_exp_f32 v106, v106
    v_smfmac_f32_32x32x32_bf16 v[64:79], v[28:31], v[96:103], v26
    s_waitcnt lgkmcnt(1)
    v_exp_f32 v107, v107
    v_exp_f32 v108, v108
    v_exp_f32 v109, v109
    v_exp_f32 v110, v110
    v_exp_f32 v111, v111
    v_exp_f32 v112, v112
    v_exp_f32 v113, v113
    v_smfmac_f32_32x32x32_bf16 v[64:79], v[32:35], v[104:111], v26
    ds_read_b128 v[28:31], v5 offset:2304
    v_exp_f32 v114, v114
    v_exp_f32 v115, v115
    v_exp_f32 v116, v116
    v_mfma_f32_32x32x16_bf16 v[80:95], v[20:23], v[12:15], 0
    ds_read_b128 v[32:35], v5 offset:2944
    v_exp_f32 v117, v117
    v_exp_f32 v118, v118
    v_exp_f32 v119, v119
    v_mfma_f32_32x32x16_bf16 v[96:111], v[20:23], v[16:19], 0
    ds_read_b128 v[20:23], v3 offset:1024
    v_exp_f32 v120, v120
    v_exp_f32 v121, v121
    v_exp_f32 v122, v122
    v_exp_f32 v123, v123
    v_smfmac_f32_32x32x32_bf16 v[48:63], v[36:39], v[112:119], v26
    s_waitcnt lgkmcnt(3)
    v_exp_f32 v124, v124
    v_exp_f32 v125, v125
    v_exp_f32 v126, v126
    v_mfma_f32_32x32x4_2b_bf16 v[80:111], v[24:25], v[10:11], v[80:111] cbsz:1 abid:0
    v_exp_f32 v127, v127
    v_exp_f32 v128, v128
    v_exp_f32 v129, v129
    v_exp_f32 v130, v130
    v_exp_f32 v131, v131
    v_exp_f32 v132, v132
    v_exp_f32 v133, v133
    v_exp_f32 v134, v134
    v_smfmac_f32_32x32x32_bf16 v[48:63], v[40:43], v[120:127], v26
    v_exp_f32 v135, v135
    v_exp_f32 v136, v136
    v_exp_f32 v137, v137
    v_exp_f32 v138, v138
    v_smfmac_f32_32x32x32_bf16 v[64:79], v[36:39], v[128:135], v26
    s_waitcnt lgkmcnt(0)
    v_exp_f32 v139, v139
    v_exp_f32 v140, v140
    v_exp_f32 v141, v141
    v_exp_f32 v142, v142
    v_exp_f32 v143, v143
    v_exp_f32 v80, v80
    v_exp_f32 v81, v81
    v_smfmac_f32_32x32x32_bf16 v[64:79], v[40:43], v[136:143], v26
    ds_read_b128 v[36:39], v5 offset:3584
    v_exp_f32 v82, v82
    v_exp_f32 v83, v83
    v_exp_f32 v84, v84
    v_mfma_f32_32x32x16_bf16 v[112:127], v[20:23], v[12:15], 0
    ds_read_b128 v[40:43], v5 offset:4224
    v_exp_f32 v85, v85
    v_exp_f32 v86, v86
    v_exp_f32 v87, v87
    v_mfma_f32_32x32x16_bf16 v[128:143], v[20:23], v[16:19], 0
    ds_read_b128 v[20:23], v3 offset:9728
    v_exp_f32 v88, v88
    v_exp_f32 v89, v89
    v_exp_f32 v90, v90
    v_exp_f32 v91, v91
    v_smfmac_f32_32x32x32_bf16 v[48:63], v[28:31], v[80:87], v26
    s_nop 0
    v_exp_f32 v92, v92
    v_exp_f32 v93, v93
    v_exp_f32 v94, v94
    v_mfma_f32_32x32x4_2b_bf16 v[112:143], v[24:25], v[10:11], v[112:143] cbsz:1 abid:1
    v_exp_f32 v95, v95
    v_exp_f32 v96, v96
    v_exp_f32 v97, v97
    v_exp_f32 v98, v98
    v_exp_f32 v99, v99
    v_exp_f32 v100, v100
    v_exp_f32 v101, v101
    v_exp_f32 v102, v102
    v_smfmac_f32_32x32x32_bf16 v[48:63], v[32:35], v[88:95], v26
    ds_read_b32 v24, v4 offset:11776
    v_exp_f32 v103, v103
    v_exp_f32 v104, v104
    v_exp_f32 v105, v105
    v_exp_f32 v106, v106
    v_smfmac_f32_32x32x32_bf16 v[64:79], v[28:31], v[96:103], v26
    s_waitcnt lgkmcnt(1)
    v_exp_f32 v107, v107
    v_exp_f32 v108, v108
    v_exp_f32 v109, v109
    v_exp_f32 v110, v110
    v_exp_f32 v111, v111
    v_exp_f32 v112, v112
    v_exp_f32 v113, v113
    v_smfmac_f32_32x32x32_bf16 v[64:79], v[32:35], v[104:111], v26
    ds_read_b128 v[28:31], v5 offset:12032
    v_exp_f32 v114, v114
    v_exp_f32 v115, v115
    v_exp_f32 v116, v116
    v_mfma_f32_32x32x16_bf16 v[80:95], v[20:23], v[12:15], 0
    ds_read_b128 v[32:35], v5 offset:12672
    v_exp_f32 v117, v117
    v_exp_f32 v118, v118
    v_exp_f32 v119, v119
    v_mfma_f32_32x32x16_bf16 v[96:111], v[20:23], v[16:19], 0
    ds_read_b128 v[20:23], v3 offset:10752
    v_exp_f32 v120, v120
    v_exp_f32 v121, v121
    v_exp_f32 v122, v122
    v_exp_f32 v123, v123
    v_smfmac_f32_32x32x32_bf16 v[48:63], v[36:39], v[112:119], v26
    s_waitcnt lgkmcnt(3)
    v_exp_f32 v124, v124
    v_exp_f32 v125, v125
    v_exp_f32 v126, v126
    v_mfma_f32_32x32x4_2b_bf16 v[80:111], v[24:25], v[10:11], v[80:111] cbsz:1 abid:0
    v_exp_f32 v127, v127
    v_exp_f32 v128, v128
    v_exp_f32 v129, v129
    v_exp_f32 v130, v130
    v_exp_f32 v131, v131
    v_exp_f32 v132, v132
    v_exp_f32 v133, v133
    v_exp_f32 v134, v134
    v_smfmac_f32_32x32x32_bf16 v[48:63], v[40:43], v[120:127], v26
    v_exp_f32 v135, v135
    v_exp_f32 v136, v136
    v_exp_f32 v137, v137
    v_exp_f32 v138, v138
    v_smfmac_f32_32x32x32_bf16 v[64:79], v[36:39], v[128:135], v26
    s_waitcnt lgkmcnt(0)
    v_exp_f32 v139, v139
    v_exp_f32 v140, v140
    v_exp_f32 v141, v141
    v_exp_f32 v142, v142
    v_exp_f32 v143, v143
    v_exp_f32 v80, v80
    v_exp_f32 v81, v81
    v_smfmac_f32_32x32x32_bf16 v[64:79], v[40:43], v[136:143], v26
    ds_read_b128 v[36:39], v5 offset:13312
    v_exp_f32 v82, v82
    v_exp_f32 v83, v83
    v_exp_f32 v84, v84
    v_mfma_f32_32x32x16_bf16 v[112:127], v[20:23], v[12:15], 0
    ds_read_b128 v[40:43], v5 offset:13952
    v_exp_f32 v85, v85
    v_exp_f32 v86, v86
    v_exp_f32 v87, v87
    v_mfma_f32_32x32x16_bf16 v[128:143], v[20:23], v[16:19], 0
    ds_read_b128 v[20:23], v157 offset:0
    v_exp_f32 v88, v88
    v_exp_f32 v89, v89
    v_exp_f32 v90, v90
    v_exp_f32 v91, v91
    v_smfmac_f32_32x32x32_bf16 v[48:63], v[28:31], v[80:87], v26
    s_nop 0
    v_exp_f32 v92, v92
    v_exp_f32 v93, v93
    v_exp_f32 v94, v94
    v_mfma_f32_32x32x4_2b_bf16 v[112:143], v[24:25], v[10:11], v[112:143] cbsz:1 abid:1
    v_exp_f32 v95, v95
    v_exp_f32 v96, v96
    v_exp_f32 v97, v97
    v_exp_f32 v98, v98
    v_exp_f32 v99, v99
    v_exp_f32 v100, v100
    v_exp_f32 v101, v101
    v_exp_f32 v102, v102
    v_smfmac_f32_32x32x32_bf16 v[48:63], v[32:35], v[88:95], v26
    ds_read_b32 v24, v158 offset:2048
    v_exp_f32 v103, v103
    v_exp_f32 v104, v104
    v_exp_f32 v105, v105
    v_exp_f32 v106, v106
    v_smfmac_f32_32x32x32_bf16 v[64:79], v[28:31], v[96:103], v26
    s_waitcnt lgkmcnt(1)
    v_exp_f32 v107, v107
    v_exp_f32 v108, v108
    v_exp_f32 v109, v109
    v_exp_f32 v110, v110
    v_exp_f32 v111, v111
    v_exp_f32 v112, v112
    v_exp_f32 v113, v113
    v_smfmac_f32_32x32x32_bf16 v[64:79], v[32:35], v[104:111], v26
    ds_read_b128 v[28:31], v159 offset:2304
    v_exp_f32 v114, v114
    v_exp_f32 v115, v115
    v_exp_f32 v116, v116
    v_mfma_f32_32x32x16_bf16 v[80:95], v[20:23], v[12:15], 0
    ds_read_b128 v[32:35], v159 offset:2944
    v_exp_f32 v117, v117
    v_exp_f32 v118, v118
    v_exp_f32 v119, v119
    v_mfma_f32_32x32x16_bf16 v[96:111], v[20:23], v[16:19], 0
    ds_read_b128 v[20:23], v157 offset:1024
    v_exp_f32 v120, v120
    v_exp_f32 v121, v121
    v_exp_f32 v122, v122
    v_exp_f32 v123, v123
    v_smfmac_f32_32x32x32_bf16 v[48:63], v[36:39], v[112:119], v26
    s_waitcnt lgkmcnt(3)
    v_exp_f32 v124, v124
    v_exp_f32 v125, v125
    v_exp_f32 v126, v126
    v_mfma_f32_32x32x4_2b_bf16 v[80:111], v[24:25], v[10:11], v[80:111] cbsz:1 abid:0
    v_exp_f32 v127, v127
    v_exp_f32 v128, v128
    v_exp_f32 v129, v129
    v_exp_f32 v130, v130
    v_exp_f32 v131, v131
    v_exp_f32 v132, v132
    v_exp_f32 v133, v133
    v_exp_f32 v134, v134
    v_smfmac_f32_32x32x32_bf16 v[48:63], v[40:43], v[120:127], v26
    v_exp_f32 v135, v135
    v_exp_f32 v136, v136
    v_exp_f32 v137, v137
    v_exp_f32 v138, v138
    v_smfmac_f32_32x32x32_bf16 v[64:79], v[36:39], v[128:135], v26
    s_waitcnt lgkmcnt(0)
    v_exp_f32 v139, v139
    v_exp_f32 v140, v140
    v_exp_f32 v141, v141
    v_exp_f32 v142, v142
    v_exp_f32 v143, v143
    v_exp_f32 v80, v80
    v_exp_f32 v81, v81
    v_smfmac_f32_32x32x32_bf16 v[64:79], v[40:43], v[136:143], v26
    ds_read_b128 v[36:39], v159 offset:3584
    v_exp_f32 v82, v82
    v_exp_f32 v83, v83
    v_exp_f32 v84, v84
    v_mfma_f32_32x32x16_bf16 v[112:127], v[20:23], v[12:15], 0
    ds_read_b128 v[40:43], v159 offset:4224
    v_exp_f32 v85, v85
    v_exp_f32 v86, v86
    v_exp_f32 v87, v87
    v_mfma_f32_32x32x16_bf16 v[128:143], v[20:23], v[16:19], 0
    ds_read_b128 v[20:23], v157 offset:9728
    v_exp_f32 v88, v88
    v_exp_f32 v89, v89
    v_exp_f32 v90, v90
    v_exp_f32 v91, v91
    v_smfmac_f32_32x32x32_bf16 v[48:63], v[28:31], v[80:87], v26
    s_nop 0
    v_exp_f32 v92, v92
    v_exp_f32 v93, v93
    v_exp_f32 v94, v94
    v_mfma_f32_32x32x4_2b_bf16 v[112:143], v[24:25], v[10:11], v[112:143] cbsz:1 abid:1
    v_exp_f32 v95, v95
    v_exp_f32 v96, v96
    v_exp_f32 v97, v97
    v_exp_f32 v98, v98
    v_exp_f32 v99, v99
    v_exp_f32 v100, v100
    v_exp_f32 v101, v101
    v_exp_f32 v102, v102
    v_smfmac_f32_32x32x32_bf16 v[48:63], v[32:35], v[88:95], v26
    ds_read_b32 v24, v158 offset:11776
    v_exp_f32 v103, v103
    v_exp_f32 v104, v104
    v_exp_f32 v105, v105
    v_exp_f32 v106, v106
    v_smfmac_f32_32x32x32_bf16 v[64:79], v[28:31], v[96:103], v26
    s_waitcnt lgkmcnt(1)
    v_exp_f32 v107, v107
    v_exp_f32 v108, v108
    v_exp_f32 v109, v109
    v_exp_f32 v110, v110
    v_exp_f32 v111, v111
    v_exp_f32 v112, v112
    v_exp_f32 v113, v113
    v_smfmac_f32_32x32x32_bf16 v[64:79], v[32:35], v[104:111], v26
    ds_read_b128 v[28:31], v159 offset:12032
    v_exp_f32 v114, v114
    v_exp_f32 v115, v115
    v_exp_f32 v116, v116
    v_mfma_f32_32x32x16_bf16 v[80:95], v[20:23], v[12:15], 0
    ds_read_b128 v[32:35], v159 offset:12672
    v_exp_f32 v117, v117
    v_exp_f32 v118, v118
    v_exp_f32 v119, v119
    v_mfma_f32_32x32x16_bf16 v[96:111], v[20:23], v[16:19], 0
    ds_read_b128 v[20:23], v157 offset:10752
    v_exp_f32 v120, v120
    v_exp_f32 v121, v121
    v_exp_f32 v122, v122
    v_exp_f32 v123, v123
    v_smfmac_f32_32x32x32_bf16 v[48:63], v[36:39], v[112:119], v26
    s_waitcnt lgkmcnt(3)
    v_exp_f32 v124, v124
    v_exp_f32 v125, v125
    v_exp_f32 v126, v126
    v_mfma_f32_32x32x4_2b_bf16 v[80:111], v[24:25], v[10:11], v[80:111] cbsz:1 abid:0
    v_exp_f32 v127, v127
    v_exp_f32 v128, v128
    v_exp_f32 v129, v129
    v_exp_f32 v130, v130
    v_exp_f32 v131, v131
    v_exp_f32 v132, v132
    v_exp_f32 v133, v133
    v_exp_f32 v134, v134
    v_smfmac_f32_32x32x32_bf16 v[48:63], v[40:43], v[120:127], v26
    v_exp_f32 v135, v135
    v_exp_f32 v136, v136
    v_exp_f32 v137, v137
    v_exp_f32 v138, v138
    v_smfmac_f32_32x32x32_bf16 v[64:79], v[36:39], v[128:135], v26
    s_waitcnt lgkmcnt(0)
    v_exp_f32 v139, v139
    v_exp_f32 v140, v140
    v_exp_f32 v141, v141
    v_exp_f32 v142, v142
    v_exp_f32 v143, v143
    v_exp_f32 v80, v80
    v_exp_f32 v81, v81
    v_smfmac_f32_32x32x32_bf16 v[64:79], v[40:43], v[136:143], v26
    ds_read_b128 v[36:39], v159 offset:13312
    v_exp_f32 v82, v82
    v_exp_f32 v83, v83
    v_exp_f32 v84, v84
    v_mfma_f32_32x32x16_bf16 v[112:127], v[20:23], v[12:15], 0
    ds_read_b128 v[40:43], v159 offset:13952
    v_exp_f32 v85, v85
    v_exp_f32 v86, v86
    v_exp_f32 v87, v87
    v_mfma_f32_32x32x16_bf16 v[128:143], v[20:23], v[16:19], 0
    v_exp_f32 v88, v88
    v_exp_f32 v89, v89
    v_exp_f32 v90, v90
    v_exp_f32 v91, v91
    v_smfmac_f32_32x32x32_bf16 v[48:63], v[28:31], v[80:87], v26
    s_nop 0
    v_exp_f32 v92, v92
    v_exp_f32 v93, v93
    v_exp_f32 v94, v94
    s_nop 0
    v_mfma_f32_32x32x4_2b_bf16 v[112:143], v[24:25], v[10:11], v[112:143] cbsz:1 abid:1
    v_exp_f32 v95, v95
    v_exp_f32 v96, v96
    v_exp_f32 v97, v97
    v_exp_f32 v98, v98
    v_exp_f32 v99, v99
    v_exp_f32 v100, v100
    v_exp_f32 v101, v101
    v_exp_f32 v102, v102
    v_smfmac_f32_32x32x32_bf16 v[48:63], v[32:35], v[88:95], v26
    v_exp_f32 v103, v103
    v_exp_f32 v104, v104
    v_exp_f32 v105, v105
    v_exp_f32 v106, v106
    v_smfmac_f32_32x32x32_bf16 v[64:79], v[28:31], v[96:103], v26
    s_waitcnt lgkmcnt(0)
    v_exp_f32 v107, v107
    v_exp_f32 v108, v108
    v_exp_f32 v109, v109
    v_exp_f32 v110, v110
    v_exp_f32 v111, v111
    v_exp_f32 v112, v112
    v_exp_f32 v113, v113
    v_smfmac_f32_32x32x32_bf16 v[64:79], v[32:35], v[104:111], v26
    v_exp_f32 v114, v114
    v_exp_f32 v115, v115
    v_exp_f32 v116, v116
    v_exp_f32 v117, v117
    v_exp_f32 v118, v118
    v_exp_f32 v119, v119
    v_exp_f32 v120, v120
    v_exp_f32 v121, v121
    v_exp_f32 v122, v122
    v_exp_f32 v123, v123
    v_smfmac_f32_32x32x32_bf16 v[48:63], v[36:39], v[112:119], v26
    s_waitcnt lgkmcnt(3)
    v_exp_f32 v124, v124
    v_exp_f32 v125, v125
    v_exp_f32 v126, v126
    v_exp_f32 v127, v127
    v_exp_f32 v128, v128
    v_exp_f32 v129, v129
    v_exp_f32 v130, v130
    v_exp_f32 v131, v131
    v_exp_f32 v132, v132
    v_exp_f32 v133, v133
    v_exp_f32 v134, v134
    v_smfmac_f32_32x32x32_bf16 v[48:63], v[40:43], v[120:127], v26
    v_exp_f32 v135, v135
    v_exp_f32 v136, v136
    v_exp_f32 v137, v137
    v_exp_f32 v138, v138
    v_smfmac_f32_32x32x32_bf16 v[64:79], v[36:39], v[128:135], v26
    s_waitcnt lgkmcnt(0)
    v_exp_f32 v139, v139
    v_exp_f32 v140, v140
    v_exp_f32 v141, v141
    v_exp_f32 v142, v142
    v_exp_f32 v143, v143
    s_nop 1
    v_smfmac_f32_32x32x32_bf16 v[64:79], v[40:43], v[136:143], v26
LAfin_55:
    s_setprio 0
    s_cmp_eq_u32 s10, 1
    s_cbranch_scc1 LAkh1_80
    s_nop 8
    ds_write_b128 v27, v[64:67]
    ds_write_b128 v27, v[68:71] offset:1024
    ds_write_b128 v252, v[72:75]
    v_mov_b32 v46, s29
    s_add_u32 s56, s7, s31
    s_cmp_lg_u32 s56, 0
    s_cbranch_scc1 Lnw_82
    s_mov_b32 m0, s48
    s_add_u32 s48, s48, 4096
    buffer_load_dwordx4 v2, s[20:23], s47 offen sc1 lds
    s_add_u32 s47, s47, 4096
    s_mov_b32 m0, s48
    s_add_u32 s48, s48, 4096
    buffer_load_dwordx4 v2, s[20:23], s47 offen sc1 lds
    s_add_u32 s47, s47, 4096
    s_mov_b32 m0, s48
    s_add_u32 s48, s48, 4096
    buffer_load_dwordx4 v2, s[20:23], s47 offen sc1 lds
    s_add_u32 s47, s47, 4096
    s_mov_b32 m0, s48
    s_add_u32 s48, s48, 4096
    buffer_load_dwordx4 v2, s[20:23], s47 offen sc1 lds
    s_add_u32 s47, s47, 4096
    s_mov_b32 m0, s48
    s_add_u32 s48, s48, 4096
    buffer_load_dwordx4 v2, s[20:23], s47 offen sc1 lds
    s_add_u32 s47, s47, 4096
    s_mov_b32 m0, s48
    s_add_u32 s48, s48, 4096
    buffer_load_dwordx4 v2, s[20:23], s47 offen sc1 lds
    s_add_u32 s47, s47, 4096
    s_mov_b32 m0, s48
    s_add_u32 s48, s48, 4096
    buffer_load_dwordx4 v2, s[20:23], s47 offen sc1 lds
    s_add_u32 s47, s47, 4096
    s_mov_b32 m0, s48
    s_add_u32 s48, s48, 4096
    buffer_load_dwordx4 v2, s[20:23], s47 offen sc1 lds
    s_add_u32 s47, s47, 4096
    s_mov_b32 m0, s48
    s_add_u32 s48, s48, 4096
    buffer_load_dwordx4 v2, s[20:23], s47 offen sc1 lds
    s_add_u32 s47, s47, 4096
    s_mov_b32 m0, s48
    s_add_u32 s48, s48, 4096
    buffer_load_dwordx4 v2, s[20:23], s47 offen sc1 lds
    s_add_u32 s47, s47, 4096
    s_mov_b32 m0, s48
    s_add_u32 s48, s48, 4096
    buffer_load_dwordx4 v2, s[20:23], s47 offen sc1 lds
    s_add_u32 s47, s47, 4096
    s_mov_b32 m0, s48
    s_add_u32 s48, s48, 4096
    buffer_load_dwordx4 v2, s[20:23], s47 offen sc1 lds
    s_add_u32 s47, s47, 4096
    s_mov_b32 m0, s48
    s_add_u32 s48, s48, 4096
    buffer_load_dwordx4 v2, s[20:23], s47 offen sc1 lds
    s_add_u32 s47, s47, 4096
    s_mov_b32 m0, s48
    s_add_u32 s48, s48, 4096
    buffer_load_dwordx4 v2, s[20:23], s47 offen sc1 lds
    s_add_u32 s47, s47, 4096
    s_mov_b32 m0, s48
    s_add_u32 s48, s48, 4096
    buffer_load_dwordx4 v2, s[20:23], s47 offen sc1 lds
    s_add_u32 s47, s47, 4096
    s_mov_b32 m0, s48
    s_add_u32 s48, s48, 4096
    buffer_load_dwordx4 v2, s[20:23], s47 offen sc1 lds
    s_add_u32 s47, s47, 4096
    s_mov_b32 m0, s48
    s_add_u32 s48, s48, 4096
    buffer_load_dwordx4 v2, s[20:23], s47 offen sc1 lds
    s_add_u32 s47, s47, 4096
    s_mov_b32 m0, s48
    s_add_u32 s48, s48, 4096
    buffer_load_dwordx4 v2, s[20:23], s47 offen sc1 lds
    s_add_u32 s47, s47, 4096
    s_mov_b32 m0, s48
    s_add_u32 s48, s48, 4096
    buffer_load_dwordx4 v2, s[20:23], s47 offen sc1 lds
    s_add_u32 s47, s47, 4096
    s_mov_b32 m0, s48
    s_add_u32 s48, s48, 4096
    buffer_load_dwordx4 v2, s[20:23], s47 offen sc1 lds
    s_add_u32 s47, s47, 4096
    s_cmp_lg_u32 s9, 0
    s_cbranch_scc1 Lnw_82
    s_mov_b32 m0, s48
    s_add_u32 s48, s48, 4096
    buffer_load_dwordx4 v2, s[20:23], s47 offen sc1 lds
    s_add_u32 s47, s47, 4096
Lnw_82:
    s_waitcnt lgkmcnt(0)
    s_barrier
    ds_read_b64 v[44:45], v46
    ds_read_b128 v[88:91], v7
    ds_read_b128 v[80:83], v6
    ds_read_b128 v[84:87], v6 offset:1024
    s_waitcnt lgkmcnt(2)
    v_mul_f32 v44, v44, v45
    v_add_f32 v90, v90, v58
    v_cmp_ge_f32 vcc, 0x45c80000, v44
    s_nop 0
    s_or_b32 vcc_lo, vcc_lo, s31
    s_cmp_eq_u32 vcc_lo, 0
    s_cbranch_scc1 Lslow_54
    v_rcp_f32 v90, v90
    v_add_f32 v88, v88, v56
    v_add_f32 v89, v89, v57
    s_waitcnt lgkmcnt(0)
    v_pk_add_f32 v[80:81], v[80:81], v[48:49]
    v_pk_add_f32 v[82:83], v[82:83], v[50:51]
    v_pk_add_f32 v[84:85], v[84:85], v[52:53]
    v_pk_add_f32 v[86:87], v[86:87], v[54:55]
    s_branch LAcj_81
LAkh1_80:
    s_nop 1
    ds_write_b128 v27, v[48:51]
    ds_write_b128 v27, v[52:55] offset:1024
    ds_write_b128 v252, v[56:59]
    v_mov_b32 v46, s29
    s_waitcnt lgkmcnt(0)
    s_barrier
    ds_read_b64 v[44:45], v46
    ds_read_b128 v[88:91], v7
    ds_read_b128 v[80:83], v6
    ds_read_b128 v[84:87], v6 offset:1024
    s_waitcnt lgkmcnt(2)
    v_mul_f32 v44, v44, v45
    v_add_f32 v90, v90, v74
    v_cmp_ge_f32 vcc, 0x45c80000, v44
    s_nop 0
    s_or_b32 vcc_lo, vcc_lo, s31
    s_cmp_eq_u32 vcc_lo, 0
    s_cbranch_scc1 Lslow_54
    v_rcp_f32 v90, v90
    v_add_f32 v88, v88, v72
    v_add_f32 v89, v89, v73
    s_waitcnt lgkmcnt(0)
    v_pk_add_f32 v[80:81], v[80:81], v[64:65]
    v_pk_add_f32 v[82:83], v[82:83], v[66:67]
    v_pk_add_f32 v[84:85], v[84:85], v[68:69]
    v_pk_add_f32 v[86:87], v[86:87], v[70:71]
LAcj_81:
    v_pk_mul_f32 v[80:81], v[80:81], v[90:91] op_sel_hi:[1,0]
    v_pk_mul_f32 v[82:83], v[82:83], v[90:91] op_sel_hi:[1,0]
    v_pk_mul_f32 v[84:85], v[84:85], v[90:91] op_sel_hi:[1,0]
    v_pk_mul_f32 v[86:87], v[86:87], v[90:91] op_sel_hi:[1,0]
    v_pk_mul_f32 v[88:89], v[88:89], v[90:91] op_sel_hi:[1,0]
    v_cvt_pk_bf16_f32 v92, v80, v81
    v_cvt_pk_bf16_f32 v93, v82, v83
    v_cvt_pk_bf16_f32 v94, v84, v85
    v_cvt_pk_bf16_f32 v95, v86, v87
    v_cvt_pk_bf16_f32 v96, v88, v89
    s_cmp_eq_u32 s53, 0
    s_cbranch_scc1 Lrem_83
    buffer_store_dwordx4 v[92:95], v9, s[20:23], s50 offen
    s_mov_b32 exec_hi, 0
    buffer_store_dword v96, v8, s[20:23], s51 offen
    s_mov_b32 exec_hi, -1
    s_waitcnt vmcnt(0)
    v_mov_b32 v10, s6
    v_mov_b32 v11, 0
    s_mov_b64 exec, 1
    buffer_store_dword v10, v11, s[20:23], s52 offen
    s_mov_b64 exec, -1
    s_branch Ldj_84
Lrem_83:
    buffer_store_dwordx4 v[92:95], v9, s[20:23], s50 offen sc1
    s_mov_b32 exec_hi, 0
    buffer_store_dword v96, v8, s[20:23], s51 offen sc1
    s_mov_b32 exec_hi, -1
    s_waitcnt vmcnt(0)
    v_mov_b32 v10, s6
    v_mov_b32 v11, 0
    s_mov_b64 exec, 1
    buffer_store_dword v10, v11, s[20:23], s52 offen sc1
    s_mov_b64 exec, -1
Ldj_84:
    s_lshr_b32 s11, s2, 6
    s_and_b32 s12, s2, 7
    s_lshl_b32 s12, s12, 2
    s_add_u32 s11, s11, s12
    s_bfe_u32 s12, s2, 0x30003
    s_lshl_b32 s13, s11, 1
    s_lshr_b32 s14, s9, 1
    s_add_u32 s13, s13, s14
    s_and_b32 s14, s9, 1
    s_lshl_b32 s64, s13, 11
    s_add_u32 s64, s64, s7
    s_add_u32 s64, s64, 16449536
    v_lshlrev_b32 v10, 4, v148
    s_and_b32 s63, s3, 5
    s_cmp_lg_u32 s63, 0
    s_cbranch_scc1 LWnp0_90
    buffer_load_dword v11, v10, s[20:23], s64 offen sc1
LWnp0_90:
    v_and_b32 v3, 15, v1
    v_lshrrev_b32 v4, 4, v1
    s_lshl_b32 s15, s14, 4
    v_add_u32 v5, s15, v3
    s_cmp_eq_u32 s10, 0
    s_cbranch_scc1 Lnoxy_87
    s_cmp_lg_u32 s7, 0
    s_cbranch_scc1 Lnoxy_87
    s_mul_i32 s56, s13, 36864
    s_add_u32 s58, s56, 8574976
    s_add_u32 s56, s56, 6215680
    s_add_u32 s56, s56, s20
    s_addc_u32 s57, s21, 0
    s_add_u32 s58, s58, s20
    s_addc_u32 s59, s21, 0
    s_mul_i32 s61, s12, 36
    v_lshl_add_u32 v16, v4, 1, s61
    v_lshlrev_b32 v17, 2, v5
    v_add_u32 v18, 0, v16
    v_and_b32 v19, 3, v18
    v_bfe_u32 v20, v18, 2, 1
    v_lshl_or_b32 v19, v19, 1, v20
    v_and_b32 v18, 0xfff8, v18
    v_or_b32 v18, v18, v19
    v_lshl_add_u32 v26, v18, 7, v17
    v_mov_b32 v240, 0
    v_mov_b32 v250, 0
    v_add_u32 v18, 1, v16
    v_and_b32 v19, 3, v18
    v_bfe_u32 v20, v18, 2, 1
    v_lshl_or_b32 v19, v19, 1, v20
    v_and_b32 v18, 0xfff8, v18
    v_or_b32 v18, v18, v19
    v_lshl_add_u32 v27, v18, 7, v17
    v_mov_b32 v241, 0
    v_mov_b32 v251, 0
    global_load_dword v232, v26, s[56:57] offset:-2048 sc1
    global_load_dword v233, v27, s[56:57] offset:-2048 sc1
    global_load_dword v242, v26, s[58:59] offset:-2048 sc1
    global_load_dword v243, v27, s[58:59] offset:-2048 sc1
    global_load_dword v234, v26, s[56:57] offset:-1024 sc1
    global_load_dword v235, v27, s[56:57] offset:-1024 sc1
    global_load_dword v244, v26, s[58:59] offset:-1024 sc1
    global_load_dword v245, v27, s[58:59] offset:-1024 sc1
    global_load_dword v236, v26, s[56:57] offset:0 sc1
    global_load_dword v237, v27, s[56:57] offset:0 sc1
    global_load_dword v246, v26, s[58:59] offset:0 sc1
    global_load_dword v247, v27, s[58:59] offset:0 sc1
    global_load_dword v238, v26, s[56:57] offset:1024 sc1
    global_load_dword v239, v27, s[56:57] offset:1024 sc1
    global_load_dword v248, v26, s[58:59] offset:1024 sc1
    global_load_dword v249, v27, s[58:59] offset:1024 sc1
    s_mov_b32 exec_hi, 0
    global_load_dword v240, v26, s[56:57] offset:2048 sc1
    global_load_dword v241, v27, s[56:57] offset:2048 sc1
    global_load_dword v250, v26, s[58:59] offset:2048 sc1
    global_load_dword v251, v27, s[58:59] offset:2048 sc1
    s_mov_b32 exec_hi, -1
Lnoxy_87:
    s_lshl_b32 s17, s13, 1
    s_add_u32 s17, s17, s14
    s_lshl_b32 s16, s17, 14
    s_add_u32 s16, s16, s7
    s_add_u32 s16, s16, 21561344
    s_lshl_b32 s17, s17, 11
    s_add_u32 s17, s17, s7
    s_add_u32 s17, s17, 23658496
    s_add_u32 s60, s17, s20
    s_addc_u32 s61, s21, 0
    v_lshlrev_b32 v7, 2, v3
    v_lshl_add_u32 v7, v4, 8, v7
    v_lshrrev_b32 v13, 1, v4
    v_mul_u32_u24 v13, 2304, v13
    v_lshrrev_b32 v14, 3, v3
    v_lshl_add_u32 v13, v14, 8, v13
    v_and_b32 v14, 1, v4
    v_lshl_add_u32 v13, v14, 7, v13
    v_and_b32 v14, 7, v3
    v_lshl_add_u32 v13, v14, 4, v13
    s_mul_i32 s62, s10, 41472
    v_add_u32 v13, s62, v13
    s_mul_i32 s62, s9, 5120
    s_add_u32 s62, s62, 130048
    v_add_u32 v14, s62, v2
    s_and_b32 s63, s3, 5
    s_cmp_lg_u32 s63, 0
    s_cbranch_scc1 LWnp_91
    s_waitcnt vmcnt(0)
    v_cmp_ne_u32 vcc, s6, v11
    s_cbranch_vccz LWnp_91
    s_mov_b32 s83, 0
Lpoll_92:
    buffer_load_dword v11, v10, s[20:23], s64 offen sc1
    s_add_u32 s83, s83, 1
    s_waitcnt vmcnt(0)
    v_cmp_ne_u32 vcc, s6, v11
    s_cbranch_vccz Lpolld_93
    s_cmp_lt_u32 s83, 524288
    s_cbranch_scc1 Lpoll_92
Lpolld_93:
LWnp_91:
    s_waitcnt vmcnt(0)
    s_barrier
    s_cmp_eq_u32 s10, 1
    s_cbranch_scc1 LWisB_85
    s_add_u32 s63, s16, 0
    buffer_load_dwordx4 v[28:31], v2, s[20:23], s63 offen offset:0 sc1
    buffer_load_dwordx4 v[32:35], v2, s[20:23], s63 offen offset:1024 sc1
    buffer_load_dwordx4 v[36:39], v2, s[20:23], s63 offen offset:2048 sc1
    buffer_load_dwordx4 v[40:43], v2, s[20:23], s63 offen offset:3072 sc1
    s_add_u32 s63, s63, 4096
    buffer_load_dwordx4 v[44:47], v2, s[20:23], s63 offen offset:0 sc1
    buffer_load_dwordx4 v[48:51], v2, s[20:23], s63 offen offset:1024 sc1
    buffer_load_dwordx4 v[52:55], v2, s[20:23], s63 offen offset:2048 sc1
    buffer_load_dwordx4 v[56:59], v2, s[20:23], s63 offen offset:3072 sc1
    s_add_u32 s63, s63, 4096
    buffer_load_dwordx4 v[60:63], v2, s[20:23], s63 offen offset:0 sc1
    ds_read_b128 v[84:87], v13 offset:0
    ds_read_b128 v[88:91], v13 offset:512
    ds_read_b128 v[92:95], v13 offset:1024
    ds_read_b128 v[96:99], v13 offset:1536
    ds_read_b128 v[100:103], v13 offset:2048
    ds_read_b128 v[104:107], v13 offset:4608
    ds_read_b128 v[108:111], v13 offset:5120
    ds_read_b128 v[112:115], v13 offset:5632
    ds_read_b128 v[116:119], v13 offset:6144
    ds_read_b128 v[120:123], v13 offset:6656
    s_waitcnt vmcnt(8) lgkmcnt(5)
    v_mfma_f32_16x16x32_bf16 v[64:67], v[84:87], v[28:31], 0
    ds_read_b128 v[124:127], v13 offset:9216
    v_mfma_f32_16x16x32_bf16 v[68:71], v[88:91], v[28:31], 0
    ds_read_b128 v[128:131], v13 offset:9728
    v_mfma_f32_16x16x32_bf16 v[72:75], v[92:95], v[28:31], 0
    ds_read_b128 v[132:135], v13 offset:10240
    v_mfma_f32_16x16x32_bf16 v[76:79], v[96:99], v[28:31], 0
    ds_read_b128 v[136:139], v13 offset:10752
    v_mfma_f32_16x16x32_bf16 v[80:83], v[100:103], v[28:31], 0
    ds_read_b128 v[140:143], v13 offset:11264
    s_waitcnt vmcnt(7) lgkmcnt(5)
    v_mfma_f32_16x16x32_bf16 v[64:67], v[104:107], v[32:35], v[64:67]
    ds_read_b128 v[84:87], v13 offset:13824
    v_mfma_f32_16x16x32_bf16 v[68:71], v[108:111], v[32:35], v[68:71]
    ds_read_b128 v[88:91], v13 offset:14336
    v_mfma_f32_16x16x32_bf16 v[72:75], v[112:115], v[32:35], v[72:75]
    ds_read_b128 v[92:95], v13 offset:14848
    v_mfma_f32_16x16x32_bf16 v[76:79], v[116:119], v[32:35], v[76:79]
    ds_read_b128 v[96:99], v13 offset:15360
    v_mfma_f32_16x16x32_bf16 v[80:83], v[120:123], v[32:35], v[80:83]
    ds_read_b128 v[100:103], v13 offset:15872
    s_waitcnt vmcnt(6) lgkmcnt(5)
    v_mfma_f32_16x16x32_bf16 v[64:67], v[124:127], v[36:39], v[64:67]
    ds_read_b128 v[104:107], v13 offset:18432
    v_mfma_f32_16x16x32_bf16 v[68:71], v[128:131], v[36:39], v[68:71]
    ds_read_b128 v[108:111], v13 offset:18944
    v_mfma_f32_16x16x32_bf16 v[72:75], v[132:135], v[36:39], v[72:75]
    ds_read_b128 v[112:115], v13 offset:19456
    v_mfma_f32_16x16x32_bf16 v[76:79], v[136:139], v[36:39], v[76:79]
    ds_read_b128 v[116:119], v13 offset:19968
    v_mfma_f32_16x16x32_bf16 v[80:83], v[140:143], v[36:39], v[80:83]
    ds_read_b128 v[120:123], v13 offset:20480
    s_waitcnt vmcnt(5) lgkmcnt(5)
    v_mfma_f32_16x16x32_bf16 v[64:67], v[84:87], v[40:43], v[64:67]
    ds_read_b128 v[124:127], v13 offset:23040
    v_mfma_f32_16x16x32_bf16 v[68:71], v[88:91], v[40:43], v[68:71]
    ds_read_b128 v[128:131], v13 offset:23552
    v_mfma_f32_16x16x32_bf16 v[72:75], v[92:95], v[40:43], v[72:75]
    ds_read_b128 v[132:135], v13 offset:24064
    v_mfma_f32_16x16x32_bf16 v[76:79], v[96:99], v[40:43], v[76:79]
    ds_read_b128 v[136:139], v13 offset:24576
    v_mfma_f32_16x16x32_bf16 v[80:83], v[100:103], v[40:43], v[80:83]
    ds_read_b128 v[140:143], v13 offset:25088
    s_waitcnt vmcnt(4) lgkmcnt(5)
    v_mfma_f32_16x16x32_bf16 v[64:67], v[104:107], v[44:47], v[64:67]
    ds_read_b128 v[84:87], v13 offset:27648
    v_mfma_f32_16x16x32_bf16 v[68:71], v[108:111], v[44:47], v[68:71]
    ds_read_b128 v[88:91], v13 offset:28160
    v_mfma_f32_16x16x32_bf16 v[72:75], v[112:115], v[44:47], v[72:75]
    ds_read_b128 v[92:95], v13 offset:28672
    v_mfma_f32_16x16x32_bf16 v[76:79], v[116:119], v[44:47], v[76:79]
    ds_read_b128 v[96:99], v13 offset:29184
    v_mfma_f32_16x16x32_bf16 v[80:83], v[120:123], v[44:47], v[80:83]
    ds_read_b128 v[100:103], v13 offset:29696
    s_waitcnt vmcnt(3) lgkmcnt(5)
    v_mfma_f32_16x16x32_bf16 v[64:67], v[124:127], v[48:51], v[64:67]
    ds_read_b128 v[104:107], v13 offset:32256
    v_mfma_f32_16x16x32_bf16 v[68:71], v[128:131], v[48:51], v[68:71]
    ds_read_b128 v[108:111], v13 offset:32768
    v_mfma_f32_16x16x32_bf16 v[72:75], v[132:135], v[48:51], v[72:75]
    ds_read_b128 v[112:115], v13 offset:33280
    v_mfma_f32_16x16x32_bf16 v[76:79], v[136:139], v[48:51], v[76:79]
    ds_read_b128 v[116:119], v13 offset:33792
    v_mfma_f32_16x16x32_bf16 v[80:83], v[140:143], v[48:51], v[80:83]
    ds_read_b128 v[120:123], v13 offset:34304
    s_waitcnt vmcnt(2) lgkmcnt(5)
    v_mfma_f32_16x16x32_bf16 v[64:67], v[84:87], v[52:55], v[64:67]
    ds_read_b128 v[124:127], v13 offset:36864
    v_mfma_f32_16x16x32_bf16 v[68:71], v[88:91], v[52:55], v[68:71]
    ds_read_b128 v[128:131], v13 offset:37376
    v_mfma_f32_16x16x32_bf16 v[72:75], v[92:95], v[52:55], v[72:75]
    ds_read_b128 v[132:135], v13 offset:37888
    v_mfma_f32_16x16x32_bf16 v[76:79], v[96:99], v[52:55], v[76:79]
    ds_read_b128 v[136:139], v13 offset:38400
    v_mfma_f32_16x16x32_bf16 v[80:83], v[100:103], v[52:55], v[80:83]
    ds_read_b128 v[140:143], v13 offset:38912
    s_waitcnt vmcnt(1) lgkmcnt(5)
    v_mfma_f32_16x16x32_bf16 v[64:67], v[104:107], v[56:59], v[64:67]
    v_mfma_f32_16x16x32_bf16 v[68:71], v[108:111], v[56:59], v[68:71]
    v_mfma_f32_16x16x32_bf16 v[72:75], v[112:115], v[56:59], v[72:75]
    v_mfma_f32_16x16x32_bf16 v[76:79], v[116:119], v[56:59], v[76:79]
    v_mfma_f32_16x16x32_bf16 v[80:83], v[120:123], v[56:59], v[80:83]
    s_waitcnt vmcnt(0) lgkmcnt(0)
    v_mfma_f32_16x16x32_bf16 v[64:67], v[124:127], v[60:63], v[64:67]
    v_mfma_f32_16x16x32_bf16 v[68:71], v[128:131], v[60:63], v[68:71]
    v_mfma_f32_16x16x32_bf16 v[72:75], v[132:135], v[60:63], v[72:75]
    v_mfma_f32_16x16x32_bf16 v[76:79], v[136:139], v[60:63], v[76:79]
    v_mfma_f32_16x16x32_bf16 v[80:83], v[140:143], v[60:63], v[80:83]
    s_nop 3
    ds_write_b128 v14, v[64:67] offset:0
    ds_write_b128 v14, v[68:71] offset:1024
    ds_write_b128 v14, v[72:75] offset:2048
    ds_write_b128 v14, v[76:79] offset:3072
    ds_write_b128 v14, v[80:83] offset:4096
    s_waitcnt lgkmcnt(0)
    s_barrier
    s_cmp_lg_u32 s7, 0
    s_cbranch_scc1 Lend_1
    s_lshl_b32 s56, s3, 10
    s_add_u32 s56, s56, 86016
    v_add_u32 v4, s56, v2
    v_add_u32 v5, 65536, v4
    s_barrier
    ds_write_b128 v4, v[160:163] offset:0
    ds_write_b128 v4, v[164:167] offset:4096
    ds_write_b128 v4, v[168:171] offset:8192
    ds_write_b128 v4, v[172:175] offset:12288
    ds_write_b128 v4, v[176:179] offset:16384
    ds_write_b128 v4, v[180:183] offset:20480
    ds_write_b128 v4, v[184:187] offset:24576
    ds_write_b128 v4, v[188:191] offset:28672
    ds_write_b128 v4, v[192:195] offset:32768
    ds_write_b128 v4, v[196:199] offset:36864
    ds_write_b128 v4, v[200:203] offset:40960
    ds_write_b128 v4, v[204:207] offset:45056
    ds_write_b128 v4, v[208:211] offset:49152
    ds_write_b128 v4, v[212:215] offset:53248
    ds_write_b128 v4, v[216:219] offset:57344
    ds_write_b128 v4, v[220:223] offset:61440
    ds_write_b128 v5, v[224:227] offset:0
    ds_write_b128 v5, v[228:231] offset:4096
    s_mov_b32 s7, 7602176
    s_branch Ltop_8
LWisB_85:
    s_add_u32 s63, s16, 9216
    buffer_load_dwordx4 v[28:31], v2, s[20:23], s63 offen offset:0 sc1
    buffer_load_dwordx4 v[32:35], v2, s[20:23], s63 offen offset:1024 sc1
    buffer_load_dwordx4 v[36:39], v2, s[20:23], s63 offen offset:2048 sc1
    buffer_load_dwordx4 v[40:43], v2, s[20:23], s63 offen offset:3072 sc1
    s_add_u32 s63, s63, 4096
    buffer_load_dwordx4 v[44:47], v2, s[20:23], s63 offen offset:0 sc1
    buffer_load_dwordx4 v[48:51], v2, s[20:23], s63 offen offset:1024 sc1
    buffer_load_dwordx4 v[52:55], v2, s[20:23], s63 offen offset:2048 sc1
    buffer_load_dwordx4 v[56:59], v2, s[20:23], s17 offen offset:0 sc1
    buffer_load_dwordx4 v[60:63], v2, s[20:23], s17 offen offset:1024 sc1
    ds_read_b128 v[84:87], v13 offset:0
    ds_read_b128 v[88:91], v13 offset:512
    ds_read_b128 v[92:95], v13 offset:1024
    ds_read_b128 v[96:99], v13 offset:1536
    ds_read_b128 v[100:103], v13 offset:2048
    ds_read_b128 v[104:107], v13 offset:4608
    ds_read_b128 v[108:111], v13 offset:5120
    ds_read_b128 v[112:115], v13 offset:5632
    ds_read_b128 v[116:119], v13 offset:6144
    ds_read_b128 v[120:123], v13 offset:6656
    v_lshlrev_b32 v124, 16, v232
    v_and_b32 v125, 0xffff0000, v232
    v_lshlrev_b32 v126, 16, v233
    v_and_b32 v127, 0xffff0000, v233
    v_lshlrev_b32 v128, 16, v234
    v_and_b32 v129, 0xffff0000, v234
    v_lshlrev_b32 v130, 16, v235
    v_and_b32 v131, 0xffff0000, v235
    v_lshlrev_b32 v132, 16, v236
    v_and_b32 v133, 0xffff0000, v236
    v_lshlrev_b32 v134, 16, v237
    v_and_b32 v135, 0xffff0000, v237
    v_lshlrev_b32 v136, 16, v238
    v_and_b32 v137, 0xffff0000, v238
    v_lshlrev_b32 v138, 16, v239
    v_and_b32 v139, 0xffff0000, v239
    v_lshlrev_b32 v140, 16, v240
    v_and_b32 v141, 0xffff0000, v240
    v_lshlrev_b32 v142, 16, v241
    v_and_b32 v143, 0xffff0000, v241
    s_waitcnt vmcnt(8) lgkmcnt(5)
    v_mfma_f32_16x16x32_bf16 v[64:67], v[84:87], v[28:31], 0
    ds_read_b128 v[160:163], v13 offset:9216
    v_mfma_f32_16x16x32_bf16 v[68:71], v[88:91], v[28:31], 0
    ds_read_b128 v[164:167], v13 offset:9728
    v_mfma_f32_16x16x32_bf16 v[72:75], v[92:95], v[28:31], 0
    ds_read_b128 v[168:171], v13 offset:10240
    v_mfma_f32_16x16x32_bf16 v[76:79], v[96:99], v[28:31], 0
    ds_read_b128 v[172:175], v13 offset:10752
    v_mfma_f32_16x16x32_bf16 v[80:83], v[100:103], v[28:31], 0
    ds_read_b128 v[176:179], v13 offset:11264
    s_waitcnt vmcnt(7) lgkmcnt(5)
    v_mfma_f32_16x16x32_bf16 v[64:67], v[104:107], v[32:35], v[64:67]
    ds_read_b128 v[84:87], v13 offset:13824
    v_mfma_f32_16x16x32_bf16 v[68:71], v[108:111], v[32:35], v[68:71]
    ds_read_b128 v[88:91], v13 offset:14336
    v_mfma_f32_16x16x32_bf16 v[72:75], v[112:115], v[32:35], v[72:75]
    ds_read_b128 v[92:95], v13 offset:14848
    v_mfma_f32_16x16x32_bf16 v[76:79], v[116:119], v[32:35], v[76:79]
    ds_read_b128 v[96:99], v13 offset:15360
    v_mfma_f32_16x16x32_bf16 v[80:83], v[120:123], v[32:35], v[80:83]
    ds_read_b128 v[100:103], v13 offset:15872
    s_waitcnt vmcnt(6) lgkmcnt(5)
    v_mfma_f32_16x16x32_bf16 v[64:67], v[160:163], v[36:39], v[64:67]
    ds_read_b128 v[104:107], v13 offset:18432
    v_mfma_f32_16x16x32_bf16 v[68:71], v[164:167], v[36:39], v[68:71]
    ds_read_b128 v[108:111], v13 offset:18944
    v_mfma_f32_16x16x32_bf16 v[72:75], v[168:171], v[36:39], v[72:75]
    ds_read_b128 v[112:115], v13 offset:19456
    v_mfma_f32_16x16x32_bf16 v[76:79], v[172:175], v[36:39], v[76:79]
    ds_read_b128 v[116:119], v13 offset:19968
    v_mfma_f32_16x16x32_bf16 v[80:83], v[176:179], v[36:39], v[80:83]
    ds_read_b128 v[120:123], v13 offset:20480
    s_waitcnt vmcnt(5) lgkmcnt(5)
    v_mfma_f32_16x16x32_bf16 v[64:67], v[84:87], v[40:43], v[64:67]
    ds_read_b128 v[160:163], v13 offset:23040
    v_mfma_f32_16x16x32_bf16 v[68:71], v[88:91], v[40:43], v[68:71]
    ds_read_b128 v[164:167], v13 offset:23552
    v_mfma_f32_16x16x32_bf16 v[72:75], v[92:95], v[40:43], v[72:75]
    ds_read_b128 v[168:171], v13 offset:24064
    v_mfma_f32_16x16x32_bf16 v[76:79], v[96:99], v[40:43], v[76:79]
    ds_read_b128 v[172:175], v13 offset:24576
    v_mfma_f32_16x16x32_bf16 v[80:83], v[100:103], v[40:43], v[80:83]
    ds_read_b128 v[176:179], v13 offset:25088
    s_waitcnt vmcnt(4) lgkmcnt(5)
    v_mfma_f32_16x16x32_bf16 v[64:67], v[104:107], v[44:47], v[64:67]
    ds_read_b128 v[84:87], v13 offset:27648
    v_mfma_f32_16x16x32_bf16 v[68:71], v[108:111], v[44:47], v[68:71]
    ds_read_b128 v[88:91], v13 offset:28160
    v_mfma_f32_16x16x32_bf16 v[72:75], v[112:115], v[44:47], v[72:75]
    ds_read_b128 v[92:95], v13 offset:28672
    v_mfma_f32_16x16x32_bf16 v[76:79], v[116:119], v[44:47], v[76:79]
    ds_read_b128 v[96:99], v13 offset:29184
    v_mfma_f32_16x16x32_bf16 v[80:83], v[120:123], v[44:47], v[80:83]
    ds_read_b128 v[100:103], v13 offset:29696
    s_waitcnt vmcnt(3) lgkmcnt(5)
    v_mfma_f32_16x16x32_bf16 v[64:67], v[160:163], v[48:51], v[64:67]
    ds_read_b128 v[104:107], v13 offset:32256
    v_mfma_f32_16x16x32_bf16 v[68:71], v[164:167], v[48:51], v[68:71]
    ds_read_b128 v[108:111], v13 offset:32768
    v_mfma_f32_16x16x32_bf16 v[72:75], v[168:171], v[48:51], v[72:75]
    ds_read_b128 v[112:115], v13 offset:33280
    v_mfma_f32_16x16x32_bf16 v[76:79], v[172:175], v[48:51], v[76:79]
    ds_read_b128 v[116:119], v13 offset:33792
    v_mfma_f32_16x16x32_bf16 v[80:83], v[176:179], v[48:51], v[80:83]
    ds_read_b128 v[120:123], v13 offset:34304
    s_waitcnt vmcnt(2) lgkmcnt(5)
    v_mfma_f32_16x16x32_bf16 v[64:67], v[84:87], v[52:55], v[64:67]
    ds_read_b128 v[160:163], v13 offset:36864
    v_mfma_f32_16x16x32_bf16 v[68:71], v[88:91], v[52:55], v[68:71]
    ds_read_b128 v[164:167], v13 offset:37376
    v_mfma_f32_16x16x32_bf16 v[72:75], v[92:95], v[52:55], v[72:75]
    ds_read_b128 v[168:171], v13 offset:37888
    v_mfma_f32_16x16x32_bf16 v[76:79], v[96:99], v[52:55], v[76:79]
    ds_read_b128 v[172:175], v13 offset:38400
    v_mfma_f32_16x16x32_bf16 v[80:83], v[100:103], v[52:55], v[80:83]
    ds_read_b128 v[176:179], v13 offset:38912
    s_waitcnt vmcnt(1) lgkmcnt(5)
    v_mfma_f32_16x16x32_bf16 v[64:67], v[104:107], v[56:59], v[64:67]
    v_mfma_f32_16x16x32_bf16 v[68:71], v[108:111], v[56:59], v[68:71]
    v_mfma_f32_16x16x32_bf16 v[72:75], v[112:115], v[56:59], v[72:75]
    v_mfma_f32_16x16x32_bf16 v[76:79], v[116:119], v[56:59], v[76:79]
    v_mfma_f32_16x16x32_bf16 v[80:83], v[120:123], v[56:59], v[80:83]
    s_waitcnt vmcnt(0) lgkmcnt(0)
    v_mfma_f32_16x16x32_bf16 v[64:67], v[160:163], v[60:63], v[64:67]
    v_mfma_f32_16x16x32_bf16 v[68:71], v[164:167], v[60:63], v[68:71]
    v_mfma_f32_16x16x32_bf16 v[72:75], v[168:171], v[60:63], v[72:75]
    v_mfma_f32_16x16x32_bf16 v[76:79], v[172:175], v[60:63], v[76:79]
    v_mfma_f32_16x16x32_bf16 v[80:83], v[176:179], v[60:63], v[80:83]
    s_nop 3
    v_pk_add_f32 v[124:125], v[124:125], v[64:65]
    v_pk_add_f32 v[126:127], v[126:127], v[66:67]
    v_pk_add_f32 v[128:129], v[128:129], v[68:69]
    v_pk_add_f32 v[130:131], v[130:131], v[70:71]
    v_pk_add_f32 v[132:133], v[132:133], v[72:73]
    v_pk_add_f32 v[134:135], v[134:135], v[74:75]
    v_pk_add_f32 v[136:137], v[136:137], v[76:77]
    v_pk_add_f32 v[138:139], v[138:139], v[78:79]
    v_pk_add_f32 v[140:141], v[140:141], v[80:81]
    v_pk_add_f32 v[142:143], v[142:143], v[82:83]
    s_barrier
    ds_read_b128 v[64:67], v14 offset:0
    ds_read_b128 v[68:71], v14 offset:1024
    ds_read_b128 v[72:75], v14 offset:2048
    ds_read_b128 v[76:79], v14 offset:3072
    ds_read_b128 v[80:83], v14 offset:4096
    v_mov_b32 v9, 2147483648
    v_cmp_gt_u32 vcc, 2, v4
    s_waitcnt lgkmcnt(4)
    v_pk_add_f32 v[124:125], v[124:125], v[64:65]
    v_pk_add_f32 v[126:127], v[126:127], v[66:67]
    s_waitcnt lgkmcnt(3)
    v_pk_add_f32 v[128:129], v[128:129], v[68:69]
    v_pk_add_f32 v[130:131], v[130:131], v[70:71]
    s_waitcnt lgkmcnt(2)
    v_pk_add_f32 v[132:133], v[132:133], v[72:73]
    v_pk_add_f32 v[134:135], v[134:135], v[74:75]
    s_waitcnt lgkmcnt(1)
    v_pk_add_f32 v[136:137], v[136:137], v[76:77]
    v_pk_add_f32 v[138:139], v[138:139], v[78:79]
    s_waitcnt lgkmcnt(0)
    v_pk_add_f32 v[140:141], v[140:141], v[80:81]
    v_pk_add_f32 v[142:143], v[142:143], v[82:83]
    s_cmp_lg_u32 s7, 0
    s_cbranch_scc1 LWl1_86
    s_barrier
    v_cndmask_b32 v140, 0, v140, vcc
    v_cndmask_b32 v141, 0, v141, vcc
    v_cndmask_b32 v142, 0, v142, vcc
    v_cndmask_b32 v143, 0, v143, vcc
    v_pk_add_f32 v[18:19], v[124:125], v[126:127]
    v_pk_mul_f32 v[20:21], v[124:125], v[124:125]
    v_pk_fma_f32 v[20:21], v[126:127], v[126:127], v[20:21]
    v_pk_add_f32 v[18:19], v[18:19], v[128:129]
    v_pk_fma_f32 v[20:21], v[128:129], v[128:129], v[20:21]
    v_pk_add_f32 v[18:19], v[18:19], v[130:131]
    v_pk_fma_f32 v[20:21], v[130:131], v[130:131], v[20:21]
    v_pk_add_f32 v[18:19], v[18:19], v[132:133]
    v_pk_fma_f32 v[20:21], v[132:133], v[132:133], v[20:21]
    v_pk_add_f32 v[18:19], v[18:19], v[134:135]
    v_pk_fma_f32 v[20:21], v[134:135], v[134:135], v[20:21]
    v_pk_add_f32 v[18:19], v[18:19], v[136:137]
    v_pk_fma_f32 v[20:21], v[136:137], v[136:137], v[20:21]
    v_pk_add_f32 v[18:19], v[18:19], v[138:139]
    v_pk_fma_f32 v[20:21], v[138:139], v[138:139], v[20:21]
    v_pk_add_f32 v[18:19], v[18:19], v[140:141]
    v_pk_fma_f32 v[20:21], v[140:141], v[140:141], v[20:21]
    v_pk_add_f32 v[18:19], v[18:19], v[142:143]
    v_pk_fma_f32 v[20:21], v[142:143], v[142:143], v[20:21]
    v_add_f32 v16, v18, v19
    v_add_f32 v17, v20, v21
    v_mov_b32 v18, v16
    v_mov_b32 v19, v17
    s_nop 0
    v_permlane32_swap_b32 v16, v18
    v_permlane32_swap_b32 v17, v19
    v_add_f32 v16, v16, v18
    v_add_f32 v17, v17, v19
    v_mov_b32 v18, v16
    v_mov_b32 v19, v17
    s_nop 0
    v_permlane16_swap_b32 v16, v18
    v_permlane16_swap_b32 v17, v19
    v_add_f32 v16, v16, v18
    v_add_f32 v17, v17, v19
    s_lshl_b32 s24, s11, 2
    s_add_u32 s24, s24, s9
    s_lshl_b32 s24, s24, 10
    s_add_u32 s24, s24, 1363968
    s_lshl_b32 s25, s12, 7
    s_add_u32 s25, s25, s24
    v_lshlrev_b32 v15, 3, v3
    s_mov_b64 exec, 0xffff
    s_cmp_eq_u32 s53, 0
    s_cbranch_scc1 Lrem_100
    buffer_store_dwordx2 v[16:17], v15, s[20:23], s25 offen
    s_branch Ldj_101
Lrem_100:
    buffer_store_dwordx2 v[16:17], v15, s[20:23], s25 offen sc1
Ldj_101:
    s_mov_b64 exec, -1
    v_lshl_add_u32 v15, v4, 8, v15
    v_lshlrev_b32 v28, 16, v242
    v_and_b32 v29, 0xffff0000, v242
    v_lshlrev_b32 v30, 16, v243
    v_and_b32 v31, 0xffff0000, v243
    v_lshlrev_b32 v32, 16, v244
    v_and_b32 v33, 0xffff0000, v244
    v_lshlrev_b32 v34, 16, v245
    v_and_b32 v35, 0xffff0000, v245
    v_lshlrev_b32 v36, 16, v246
    v_and_b32 v37, 0xffff0000, v246
    v_lshlrev_b32 v38, 16, v247
    v_and_b32 v39, 0xffff0000, v247
    v_lshlrev_b32 v40, 16, v248
    v_and_b32 v41, 0xffff0000, v248
    v_lshlrev_b32 v42, 16, v249
    v_and_b32 v43, 0xffff0000, v249
    v_lshlrev_b32 v44, 16, v250
    v_and_b32 v45, 0xffff0000, v250
    v_lshlrev_b32 v46, 16, v251
    v_and_b32 v47, 0xffff0000, v251
    v_lshrrev_b32 v11, 1, v4
    v_lshlrev_b32 v11, 9, v11
    v_lshl_add_u32 v11, v5, 4, v11
    v_and_b32 v12, 1, v4
    v_lshl_add_u32 v11, v12, 3, v11
    v_mov_b32 v9, 2147483648
    v_cmp_gt_u32 vcc, 2, v4
    s_mul_i32 s18, s13, 36864
    s_mul_i32 s19, s12, 4608
    s_add_u32 s18, s18, s19
    s_add_u32 s18, s18, 13959168
    s_add_u32 s19, s18, 4096
    v_cndmask_b32 v12, v9, v11, vcc
    s_mov_b32 s83, 0
LWpoll_98:
    buffer_load_dwordx2 v[16:17], v15, s[20:23], s24 offen sc1
    buffer_load_dwordx2 v[18:19], v15, s[20:23], s24 offen offset:128 sc1
    s_add_u32 s83, s83, 1
    s_waitcnt vmcnt(0)
    v_cmp_eq_u32 s[30:31], -1, v17
    v_cmp_eq_u32 s[32:33], -1, v19
    s_nop 0
    s_or_b64 s[30:31], s[30:31], s[32:33]
    s_cbranch_scc0 LWgot_99
    s_cmp_lt_u32 s83, 524288
    s_cbranch_scc1 LWpoll_98
LWgot_99:
    v_add_f32 v16, v16, v18
    v_add_f32 v17, v17, v19
    v_mov_b32 v18, v16
    v_mov_b32 v19, v17
    s_nop 0
    v_permlane32_swap_b32 v16, v18
    v_permlane32_swap_b32 v17, v19
    v_add_f32 v16, v16, v18
    v_add_f32 v17, v17, v19
    v_mov_b32 v18, v16
    v_mov_b32 v19, v17
    s_nop 0
    v_permlane16_swap_b32 v16, v18
    v_permlane16_swap_b32 v17, v19
    v_add_f32 v16, v16, v18
    v_add_f32 v17, v17, v19
    s_mov_b32 s26, 0x3ae38e39
    v_mul_f32 v16, s26, v16
    v_mul_f32 v17, s26, v17
    v_fma_f32 v17, -v16, v16, v17
    v_max_f32 v17, 0, v17
    v_add_f32 v17, 0x3727c5ac, v17
    v_rsq_f32 v17, v17
    s_nop 0
    v_mul_f32 v16, -v16, v17
    v_pk_fma_f32 v[72:73], v[124:125], v[16:17], v[16:17] op_sel:[0,1,0] op_sel_hi:[1,1,0]
    v_pk_fma_f32 v[74:75], v[126:127], v[16:17], v[16:17] op_sel:[0,1,0] op_sel_hi:[1,1,0]
    v_pk_fma_f32 v[76:77], v[128:129], v[16:17], v[16:17] op_sel:[0,1,0] op_sel_hi:[1,1,0]
    v_pk_fma_f32 v[78:79], v[130:131], v[16:17], v[16:17] op_sel:[0,1,0] op_sel_hi:[1,1,0]
    v_pk_fma_f32 v[80:81], v[132:133], v[16:17], v[16:17] op_sel:[0,1,0] op_sel_hi:[1,1,0]
    v_pk_fma_f32 v[82:83], v[134:135], v[16:17], v[16:17] op_sel:[0,1,0] op_sel_hi:[1,1,0]
    v_pk_fma_f32 v[84:85], v[136:137], v[16:17], v[16:17] op_sel:[0,1,0] op_sel_hi:[1,1,0]
    v_pk_fma_f32 v[86:87], v[138:139], v[16:17], v[16:17] op_sel:[0,1,0] op_sel_hi:[1,1,0]
    v_pk_fma_f32 v[88:89], v[140:141], v[16:17], v[16:17] op_sel:[0,1,0] op_sel_hi:[1,1,0]
    v_pk_fma_f32 v[90:91], v[142:143], v[16:17], v[16:17] op_sel:[0,1,0] op_sel_hi:[1,1,0]
    v_pk_fma_f32 v[124:125], v[72:73], v[28:29], v[124:125]
    v_pk_fma_f32 v[126:127], v[74:75], v[30:31], v[126:127]
    v_pk_fma_f32 v[128:129], v[76:77], v[32:33], v[128:129]
    v_pk_fma_f32 v[130:131], v[78:79], v[34:35], v[130:131]
    v_pk_fma_f32 v[132:133], v[80:81], v[36:37], v[132:133]
    v_pk_fma_f32 v[134:135], v[82:83], v[38:39], v[134:135]
    v_pk_fma_f32 v[136:137], v[84:85], v[40:41], v[136:137]
    v_pk_fma_f32 v[138:139], v[86:87], v[42:43], v[138:139]
    v_pk_fma_f32 v[140:141], v[88:89], v[44:45], v[140:141]
    v_pk_fma_f32 v[142:143], v[90:91], v[46:47], v[142:143]
    v_cvt_pk_bf16_f32 v232, v124, v125
    v_cvt_pk_bf16_f32 v233, v126, v127
    v_cvt_pk_bf16_f32 v234, v128, v129
    v_cvt_pk_bf16_f32 v235, v130, v131
    v_cvt_pk_bf16_f32 v236, v132, v133
    v_cvt_pk_bf16_f32 v237, v134, v135
    v_cvt_pk_bf16_f32 v238, v136, v137
    v_cvt_pk_bf16_f32 v239, v138, v139
    v_cvt_pk_bf16_f32 v240, v140, v141
    v_cvt_pk_bf16_f32 v241, v142, v143
    s_cmp_eq_u32 s53, 0
    s_cbranch_scc1 Lrem_102
    buffer_store_dwordx2 v[232:233], v11, s[20:23], s18 offen offset:0
    buffer_store_dwordx2 v[234:235], v11, s[20:23], s18 offen offset:1024
    buffer_store_dwordx2 v[236:237], v11, s[20:23], s18 offen offset:2048
    buffer_store_dwordx2 v[238:239], v11, s[20:23], s18 offen offset:3072
    buffer_store_dwordx2 v[240:241], v12, s[20:23], s19 offen
    s_branch Ldj_103
Lrem_102:
    buffer_store_dwordx2 v[232:233], v11, s[20:23], s18 offen offset:0 sc1
    buffer_store_dwordx2 v[234:235], v11, s[20:23], s18 offen offset:1024 sc1
    buffer_store_dwordx2 v[236:237], v11, s[20:23], s18 offen offset:2048 sc1
    buffer_store_dwordx2 v[238:239], v11, s[20:23], s18 offen offset:3072 sc1
    buffer_store_dwordx2 v[240:241], v12, s[20:23], s19 offen sc1
Ldj_103:
    v_pk_mul_f32 v[16:17], v[124:125], v[124:125]
    v_pk_fma_f32 v[16:17], v[126:127], v[126:127], v[16:17]
    v_pk_fma_f32 v[16:17], v[128:129], v[128:129], v[16:17]
    v_pk_fma_f32 v[16:17], v[130:131], v[130:131], v[16:17]
    v_pk_fma_f32 v[16:17], v[132:133], v[132:133], v[16:17]
    v_pk_fma_f32 v[16:17], v[134:135], v[134:135], v[16:17]
    v_pk_fma_f32 v[16:17], v[136:137], v[136:137], v[16:17]
    v_pk_fma_f32 v[16:17], v[138:139], v[138:139], v[16:17]
    v_pk_fma_f32 v[16:17], v[140:141], v[140:141], v[16:17]
    v_pk_fma_f32 v[16:17], v[142:143], v[142:143], v[16:17]
    v_add_f32 v16, v16, v17
    s_lshl_b32 s56, s13, 3
    s_add_u32 s56, s56, s12
    s_lshl_b32 s56, s56, 8
    s_add_u32 s56, s56, 249856
    v_mov_b32 v18, v16
    v_lshlrev_b32 v15, 3, v5
    v_mov_b32 v17, s6
    v_permlane32_swap_b32 v16, v18
    v_add_f32 v16, v16, v18
    v_mov_b32 v18, v16
    s_nop 1
    v_permlane16_swap_b32 v16, v18
    v_add_f32 v16, v16, v18
    s_mov_b64 exec, 0xffff
    s_waitcnt vmcnt(0)
    s_cmp_eq_u32 s53, 0
    s_cbranch_scc1 Lrem_104
    buffer_store_dwordx2 v[16:17], v15, s[20:23], s56 offen
    s_branch Ldj_105
Lrem_104:
    buffer_store_dwordx2 v[16:17], v15, s[20:23], s56 offen sc1
Ldj_105:
    s_mov_b64 exec, -1
    s_mov_b32 s7, 7602176
    s_branch Ltop_8
LWl1_86:
    s_load_dwordx2 s[28:29], s[0:1], 72
    v_cvt_pk_bf16_f32 v72, v124, v125
    v_cvt_pk_bf16_f32 v73, v126, v127
    v_cvt_pk_bf16_f32 v74, v128, v129
    v_cvt_pk_bf16_f32 v75, v130, v131
    v_cvt_pk_bf16_f32 v76, v132, v133
    v_cvt_pk_bf16_f32 v77, v134, v135
    v_cvt_pk_bf16_f32 v78, v136, v137
    v_cvt_pk_bf16_f32 v79, v138, v139
    v_cvt_pk_bf16_f32 v80, v140, v141
    v_cvt_pk_bf16_f32 v81, v142, v143
    v_mul_u32_u24 v15, 1152, v5
    v_lshl_add_u32 v15, v4, 3, v15
    v_cndmask_b32 v16, v9, v15, vcc
    s_mul_i32 s14, s13, 36864
    s_mul_i32 s15, s12, 144
    s_add_u32 s14, s14, s15
    s_waitcnt lgkmcnt(0)
    s_mov_b32 s24, s28
    s_mov_b32 s25, s29
    s_mov_b32 s26, 2359296
    s_mov_b32 s27, 0x20000
    buffer_store_dwordx2 v[72:73], v15, s[24:27], s14 offen offset:0
    buffer_store_dwordx2 v[74:75], v15, s[24:27], s14 offen offset:32
    buffer_store_dwordx2 v[76:77], v15, s[24:27], s14 offen offset:64
    buffer_store_dwordx2 v[78:79], v15, s[24:27], s14 offen offset:96
    buffer_store_dwordx2 v[80:81], v16, s[24:27], s14 offen offset:128
Lend_1:
Lend0_2:
    s_endpgm
LGsq_45:
    v_add_u32 v104, 159744, v148
    ds_read_b32 v96, v104 offset:0
    ds_read_b32 v97, v104 offset:128
    ds_read_b32 v98, v104 offset:256
    ds_read_b32 v99, v104 offset:384
    ds_read_b32 v100, v104 offset:512
    ds_read_b32 v101, v104 offset:640
    ds_read_b32 v102, v104 offset:768
    ds_read_b32 v103, v104 offset:896
    s_getreg_b32 s56, hwreg(HW_REG_XCC_ID, 0, 4)
    v_cmp_ne_u32 vcc, s56, v5
    s_nop 0
    s_cmp_eq_u64 vcc, 0
    s_cselect_b32 s53, 1, 0
    v_lshlrev_b32 v104, 3, v1
    v_mov_b32 v113, s6
    s_waitcnt lgkmcnt(0)
    v_add_f32 v96, v96, v97
    v_add_f32 v98, v98, v99
    v_add_f32 v100, v100, v101
    v_add_f32 v102, v102, v103
    v_add_f32 v96, v96, v98
    v_add_f32 v100, v100, v102
    v_add_f32 v112, v96, v100
    s_mov_b32 exec_hi, 0
    s_cmp_eq_u32 s53, 0
    s_cbranch_scc1 Lrem_106
    buffer_store_dwordx2 v[112:113], v104, s[20:23], s58 offen
    s_branch Ldj_107
Lrem_106:
    buffer_store_dwordx2 v[112:113], v104, s[20:23], s58 offen sc1
Ldj_107:
    s_mov_b64 exec, -1
    s_branch LGsqb_46
LAearly_63:
    s_waitcnt vmcnt(0)
    v_cmp_ne_u32 vcc, s6, v45
    s_nop 0
    s_lshr_b64 s[60:61], vcc, s30
    s_and_b32 s56, s60, 15
    s_cbranch_scc1 LAearlyb_64
    s_add_u32 m0, s45, 0
    s_add_u32 s59, s44, 0
    buffer_load_dwordx4 v2, s[20:23], s59 offen sc1 lds
    buffer_load_dwordx4 v2, s[20:23], s59 offen offset:1024 sc1 lds
    s_mov_b64 exec, 0xffffff
    buffer_load_dwordx4 v2, s[20:23], s59 offen offset:2048 sc1 lds
    s_mov_b64 exec, -1
    s_mov_b32 s28, 4
    s_and_b32 s56, s60, 0xf0
    s_cbranch_scc1 LAearlyb_64
    s_add_u32 m0, s45, 9728
    s_add_u32 s59, s44, 9728
    buffer_load_dwordx4 v2, s[20:23], s59 offen sc1 lds
    buffer_load_dwordx4 v2, s[20:23], s59 offen offset:1024 sc1 lds
    s_mov_b64 exec, 0xffffff
    buffer_load_dwordx4 v2, s[20:23], s59 offen offset:2048 sc1 lds
    s_mov_b64 exec, -1
    s_mov_b32 s28, 1
    s_lshr_b64 s[60:61], vcc, s46
    s_and_b32 s56, s60, 0xff
    s_cbranch_scc1 LAearlyb_64
    s_add_u32 s56, s40, s4
    s_and_b32 s56, s56, 7
    s_mul_i32 s56, s56, 19456
    s_add_u32 s57, s40, 1
    s_and_b32 s57, s57, 3
    s_mul_i32 s57, s57, 19456
    s_add_u32 s57, s57, s42
    s_add_u32 s56, s56, s41
    s_mov_b32 m0, s57
    s_add_u32 s40, s40, 1
    buffer_load_dwordx4 v2, s[20:23], s56 offen offset:0 sc1 lds
    buffer_load_dwordx4 v2, s[20:23], s56 offen offset:1024 sc1 lds
    buffer_load_dwordx4 v2, s[20:23], s56 offen offset:2048 sc1 lds
    buffer_load_dwordx4 v2, s[20:23], s56 offen offset:3072 sc1 lds
    s_add_u32 m0, s57, 4096
    s_add_u32 s56, s56, 4096
    s_mov_b32 exec_hi, 0xffff
    buffer_load_dwordx4 v2, s[20:23], s56 offen sc1 lds
    s_mov_b32 exec_hi, -1
    s_mov_b32 s28, 3
    s_branch LAearlyb_64
Lh0_78p:
    s_mov_b32 s83, 0
Lhl_108:
    buffer_load_dwordx2 v[44:45], v46, s[20:23], s27 offen sc1
    s_add_u32 s83, s83, 1
    s_waitcnt vmcnt(0)
    v_cmp_ne_u32 vcc, s6, v45
    s_nop 0
    s_lshr_b64 s[60:61], vcc, s30
    s_and_b32 s56, s60, 240
    s_cbranch_scc1 Lhn_109
    s_branch Lhg_110
Lhn_109:
    s_cmp_lt_u32 s83, 524288
    s_cbranch_scc1 Lhl_108
Lhg_110:
    s_add_u32 m0, s45, 9728
    s_add_u32 s59, s44, 9728
    buffer_load_dwordx4 v2, s[20:23], s59 offen sc1 lds
    buffer_load_dwordx4 v2, s[20:23], s59 offen offset:1024 sc1 lds
    s_mov_b64 exec, 0xffffff
    buffer_load_dwordx4 v2, s[20:23], s59 offen offset:2048 sc1 lds
    s_mov_b64 exec, -1
    s_mov_b32 s28, 1
    s_branch Lh0_78q
Lh0_78:
    v_cmp_ne_u32 vcc, s6, v45
    s_nop 0
    s_lshr_b64 s[60:61], vcc, s46
    s_and_b32 s56, s60, 255
    s_cbranch_scc1 Lh0b_79
    s_add_u32 s56, s40, s4
    s_and_b32 s56, s56, 7
    s_mul_i32 s56, s56, 19456
    s_add_u32 s57, s40, 1
    s_and_b32 s57, s57, 3
    s_mul_i32 s57, s57, 19456
    s_add_u32 s57, s57, s42
    s_add_u32 s56, s56, s41
    s_mov_b32 m0, s57
    s_add_u32 s40, s40, 1
    buffer_load_dwordx4 v2, s[20:23], s56 offen offset:0 sc1 lds
    buffer_load_dwordx4 v2, s[20:23], s56 offen offset:1024 sc1 lds
    buffer_load_dwordx4 v2, s[20:23], s56 offen offset:2048 sc1 lds
    buffer_load_dwordx4 v2, s[20:23], s56 offen offset:3072 sc1 lds
    s_add_u32 m0, s57, 4096
    s_add_u32 s56, s56, 4096
    s_mov_b32 exec_hi, 0xffff
    buffer_load_dwordx4 v2, s[20:23], s56 offen sc1 lds
    s_mov_b32 exec_hi, -1
    s_mov_b32 s28, 3
    s_cbranch_vccnz Lh0b_79
    v_lshlrev_b32 v47, 16, v44
    v_and_b32 v44, 0xffff0000, v44
    s_nop 1
    v_max_u32_dpp v44, v44, v44 quad_perm:[1,0,3,2] row_mask:0xf bank_mask:0xf
    v_max_u32_dpp v47, v47, v47 quad_perm:[1,0,3,2] row_mask:0xf bank_mask:0xf
    s_nop 0
    v_max_u32_dpp v44, v44, v44 quad_perm:[2,3,0,1] row_mask:0xf bank_mask:0xf
    v_max_u32_dpp v47, v47, v47 quad_perm:[2,3,0,1] row_mask:0xf bank_mask:0xf
    s_nop 0
    v_max_u32_dpp v44, v44, v44 row_half_mirror row_mask:0xf bank_mask:0xf
    v_max_u32_dpp v47, v47, v47 row_half_mirror row_mask:0xf bank_mask:0xf
    s_nop 0
    v_max_u32_dpp v44, v44, v44 row_mirror row_mask:0xf bank_mask:0xf
    v_max_u32_dpp v47, v47, v47 row_mirror row_mask:0xf bank_mask:0xf
    s_nop 0
    v_max_u32_dpp v44, v44, v44 row_bcast:15 row_mask:0xa bank_mask:0xf
    v_max_u32_dpp v47, v47, v47 row_bcast:15 row_mask:0xa bank_mask:0xf
    s_nop 0
    v_max_u32_dpp v44, v44, v44 row_bcast:31 row_mask:0xc bank_mask:0xf
    v_max_u32_dpp v47, v47, v47 row_bcast:31 row_mask:0xc bank_mask:0xf
    v_mov_b32 v45, v47
    v_mov_b32 v47, s29
    s_mov_b32 exec_lo, 0
    s_mov_b32 exec_hi, 0x80000000
    ds_write_b64 v47, v[44:45]
    s_mov_b64 exec, -1
    s_mov_b32 s28, 2
    s_branch Lh0b_79
LAhook_61:
    s_waitcnt vmcnt(0)
    v_cmp_ne_u32 vcc, s6, v45
    s_cbranch_vccz Lseen_112
    s_mov_b32 s83, 0
Lpoll_113:
    buffer_load_dwordx2 v[44:45], v46, s[20:23], s27 offen sc1
    s_add_u32 s83, s83, 1
    s_waitcnt vmcnt(0)
    v_cmp_ne_u32 vcc, s6, v45
    s_cbranch_vccz Lpolld_114
    s_cmp_lt_u32 s83, 524288
    s_cbranch_scc1 Lpoll_113
Lpolld_114:
Lseen_112:
    s_cmp_eq_u32 s28, 3
    s_cbranch_scc1 Lc2_111
    s_add_u32 s56, s40, s4
    s_and_b32 s56, s56, 7
    s_mul_i32 s56, s56, 19456
    s_add_u32 s57, s40, 1
    s_and_b32 s57, s57, 3
    s_mul_i32 s57, s57, 19456
    s_add_u32 s57, s57, s42
    s_add_u32 s56, s56, s41
    s_mov_b32 m0, s57
    s_add_u32 s40, s40, 1
    buffer_load_dwordx4 v2, s[20:23], s56 offen offset:0 sc1 lds
    buffer_load_dwordx4 v2, s[20:23], s56 offen offset:1024 sc1 lds
    buffer_load_dwordx4 v2, s[20:23], s56 offen offset:2048 sc1 lds
    buffer_load_dwordx4 v2, s[20:23], s56 offen offset:3072 sc1 lds
    s_add_u32 m0, s57, 4096
    s_add_u32 s56, s56, 4096
    s_mov_b32 exec_hi, 0xffff
    buffer_load_dwordx4 v2, s[20:23], s56 offen sc1 lds
    s_mov_b32 exec_hi, -1
Lc2_111:
    v_lshlrev_b32 v47, 16, v44
    v_and_b32 v44, 0xffff0000, v44
    s_nop 1
    v_max_u32_dpp v44, v44, v44 quad_perm:[1,0,3,2] row_mask:0xf bank_mask:0xf
    v_max_u32_dpp v47, v47, v47 quad_perm:[1,0,3,2] row_mask:0xf bank_mask:0xf
    s_nop 0
    v_max_u32_dpp v44, v44, v44 quad_perm:[2,3,0,1] row_mask:0xf bank_mask:0xf
    v_max_u32_dpp v47, v47, v47 quad_perm:[2,3,0,1] row_mask:0xf bank_mask:0xf
    s_nop 0
    v_max_u32_dpp v44, v44, v44 row_half_mirror row_mask:0xf bank_mask:0xf
    v_max_u32_dpp v47, v47, v47 row_half_mirror row_mask:0xf bank_mask:0xf
    s_nop 0
    v_max_u32_dpp v44, v44, v44 row_mirror row_mask:0xf bank_mask:0xf
    v_max_u32_dpp v47, v47, v47 row_mirror row_mask:0xf bank_mask:0xf
    s_nop 0
    v_max_u32_dpp v44, v44, v44 row_bcast:15 row_mask:0xa bank_mask:0xf
    v_max_u32_dpp v47, v47, v47 row_bcast:15 row_mask:0xa bank_mask:0xf
    s_nop 0
    v_max_u32_dpp v44, v44, v44 row_bcast:31 row_mask:0xc bank_mask:0xf
    v_max_u32_dpp v47, v47, v47 row_bcast:31 row_mask:0xc bank_mask:0xf
    v_mov_b32 v45, v47
    v_mov_b32 v47, s29
    s_mov_b32 exec_lo, 0
    s_mov_b32 exec_hi, 0x80000000
    ds_write_b64 v47, v[44:45]
    s_mov_b64 exec, -1
    s_mov_b32 s28, 2
    s_branch LAhookb_62
Ljob_70:
    s_add_u32 m0, s42, 0
    s_add_u32 s56, s63, 4096
    buffer_load_dwordx4 v2, s[20:23], s63 offen offset:0 sc1 lds
    buffer_load_dwordx4 v2, s[20:23], s63 offen offset:1024 sc1 lds
    buffer_load_dwordx4 v2, s[20:23], s63 offen offset:2048 sc1 lds
    buffer_load_dwordx4 v2, s[20:23], s63 offen offset:3072 sc1 lds
    s_add_u32 m0, s42, 4096
    s_mov_b32 exec_hi, 0xffff
    buffer_load_dwordx4 v2, s[20:23], s56 offen sc1 lds
    s_mov_b32 exec_hi, -1
    s_add_u32 m0, s42, 19456
    s_add_u32 s56, s64, 4096
    buffer_load_dwordx4 v2, s[20:23], s64 offen offset:0 sc1 lds
    buffer_load_dwordx4 v2, s[20:23], s64 offen offset:1024 sc1 lds
    buffer_load_dwordx4 v2, s[20:23], s64 offen offset:2048 sc1 lds
    buffer_load_dwordx4 v2, s[20:23], s64 offen offset:3072 sc1 lds
    s_add_u32 m0, s42, 23552
    s_mov_b32 exec_hi, 0xffff
    buffer_load_dwordx4 v2, s[20:23], s56 offen sc1 lds
    s_mov_b32 exec_hi, -1
    s_branch Ljobb_71
Ljob_72:
    s_add_u32 m0, s42, 38912
    s_add_u32 s56, s65, 4096
    buffer_load_dwordx4 v2, s[20:23], s65 offen offset:0 sc1 lds
    buffer_load_dwordx4 v2, s[20:23], s65 offen offset:1024 sc1 lds
    buffer_load_dwordx4 v2, s[20:23], s65 offen offset:2048 sc1 lds
    buffer_load_dwordx4 v2, s[20:23], s65 offen offset:3072 sc1 lds
    s_add_u32 m0, s42, 43008
    s_mov_b32 exec_hi, 0xffff
    buffer_load_dwordx4 v2, s[20:23], s56 offen sc1 lds
    s_mov_b32 exec_hi, -1
    s_branch Ljobb_73
Ljob_74:
    s_add_u32 m0, s42, 58368
    s_add_u32 s56, s66, 4096
    buffer_load_dwordx4 v2, s[20:23], s66 offen offset:0 sc1 lds
    buffer_load_dwordx4 v2, s[20:23], s66 offen offset:1024 sc1 lds
    buffer_load_dwordx4 v2, s[20:23], s66 offen offset:2048 sc1 lds
    buffer_load_dwordx4 v2, s[20:23], s66 offen offset:3072 sc1 lds
    s_add_u32 m0, s42, 62464
    s_mov_b32 exec_hi, 0xffff
    buffer_load_dwordx4 v2, s[20:23], s56 offen sc1 lds
    s_mov_b32 exec_hi, -1
    s_add_u32 m0, s42, 0
    s_add_u32 s56, s67, 4096
    buffer_load_dwordx4 v2, s[20:23], s67 offen offset:0 sc1 lds
    buffer_load_dwordx4 v2, s[20:23], s67 offen offset:1024 sc1 lds
    buffer_load_dwordx4 v2, s[20:23], s67 offen offset:2048 sc1 lds
    buffer_load_dwordx4 v2, s[20:23], s67 offen offset:3072 sc1 lds
    s_add_u32 m0, s42, 4096
    s_mov_b32 exec_hi, 0xffff
    buffer_load_dwordx4 v2, s[20:23], s56 offen sc1 lds
    s_mov_b32 exec_hi, -1
    s_branch Ljobb_75
Lslow_54:
    s_mov_b32 s31, 1
    v_mov_b32 v44, 0xff800000
    v_mov_b32 v45, 0xff800000
    v_mov_b32 v48, 0
    v_mov_b32 v49, 0
    v_mov_b32 v50, 0
    v_mov_b32 v51, 0
    v_mov_b32 v52, 0
    v_mov_b32 v53, 0
    v_mov_b32 v54, 0
    v_mov_b32 v55, 0
    v_mov_b32 v56, 0
    v_mov_b32 v57, 0
    v_mov_b32 v58, 0
    v_mov_b32 v59, 0
    v_mov_b32 v60, 0
    v_mov_b32 v61, 0
    v_mov_b32 v62, 0
    v_mov_b32 v63, 0
    v_mov_b32 v64, 0
    v_mov_b32 v65, 0
    v_mov_b32 v66, 0
    v_mov_b32 v67, 0
    v_mov_b32 v68, 0
    v_mov_b32 v69, 0
    v_mov_b32 v70, 0
    v_mov_b32 v71, 0
    v_mov_b32 v72, 0
    v_mov_b32 v73, 0
    v_mov_b32 v74, 0
    v_mov_b32 v75, 0
    v_mov_b32 v76, 0
    v_mov_b32 v77, 0
    v_mov_b32 v78, 0
    v_mov_b32 v79, 0
    s_mov_b32 s40, 0
    s_mov_b32 s19, 0
Lslp_115:
    s_waitcnt vmcnt(0) lgkmcnt(0)
    s_barrier
    s_cmp_eq_u32 s10, 0
    s_cbranch_scc0 Lslb_116
    s_mul_i32 s56, s40, 19456
    s_add_u32 s57, s42, 19456
    s_add_u32 s56, s56, s41
    s_mov_b32 m0, s57
    s_add_u32 s40, s40, 1
    buffer_load_dwordx4 v2, s[20:23], s56 offen offset:0 sc1 lds
    buffer_load_dwordx4 v2, s[20:23], s56 offen offset:1024 sc1 lds
    buffer_load_dwordx4 v2, s[20:23], s56 offen offset:2048 sc1 lds
    buffer_load_dwordx4 v2, s[20:23], s56 offen offset:3072 sc1 lds
    s_add_u32 m0, s57, 4096
    s_add_u32 s56, s56, 4096
    s_mov_b32 exec_hi, 0xffff
    buffer_load_dwordx4 v2, s[20:23], s56 offen sc1 lds
    s_mov_b32 exec_hi, -1
Lslb_116:
    s_waitcnt vmcnt(0)
    s_barrier
    ds_read_b128 v[20:23], v157 offset:19456
    ds_read_b32 v24, v158 offset:21504
    ds_read_b128 v[28:31], v159 offset:21760
    ds_read_b128 v[32:35], v159 offset:22400
    s_waitcnt lgkmcnt(0)
    v_mfma_f32_32x32x16_bf16 v[80:95], v[20:23], v[12:15], 0
    v_mfma_f32_32x32x16_bf16 v[96:111], v[20:23], v[16:19], 0
    s_nop 9
    v_mfma_f32_32x32x4_2b_bf16 v[80:111], v[24:25], v[10:11], v[80:111] cbsz:1 abid:0
    s_nop 15
    s_nop 3
    v_max3_f32 v44, v80, v81, v44
    v_max3_f32 v44, v82, v83, v44
    v_max3_f32 v44, v84, v85, v44
    v_max3_f32 v44, v86, v87, v44
    v_max3_f32 v44, v88, v89, v44
    v_max3_f32 v44, v90, v91, v44
    v_max3_f32 v44, v92, v93, v44
    v_max3_f32 v44, v94, v95, v44
    v_max3_f32 v45, v96, v97, v45
    v_max3_f32 v45, v98, v99, v45
    v_max3_f32 v45, v100, v101, v45
    v_max3_f32 v45, v102, v103, v45
    v_max3_f32 v45, v104, v105, v45
    v_max3_f32 v45, v106, v107, v45
    v_max3_f32 v45, v108, v109, v45
    v_max3_f32 v45, v110, v111, v45
    ds_read_b128 v[20:23], v157 offset:20480
    ds_read_b32 v24, v158 offset:21504
    ds_read_b128 v[28:31], v159 offset:23040
    ds_read_b128 v[32:35], v159 offset:23680
    s_waitcnt lgkmcnt(0)
    v_mfma_f32_32x32x16_bf16 v[80:95], v[20:23], v[12:15], 0
    v_mfma_f32_32x32x16_bf16 v[96:111], v[20:23], v[16:19], 0
    s_nop 9
    v_mfma_f32_32x32x4_2b_bf16 v[80:111], v[24:25], v[10:11], v[80:111] cbsz:1 abid:1
    s_nop 15
    s_nop 3
    v_max3_f32 v44, v80, v81, v44
    v_max3_f32 v44, v82, v83, v44
    v_max3_f32 v44, v84, v85, v44
    v_max3_f32 v44, v86, v87, v44
    v_max3_f32 v44, v88, v89, v44
    v_max3_f32 v44, v90, v91, v44
    v_max3_f32 v44, v92, v93, v44
    v_max3_f32 v44, v94, v95, v44
    v_max3_f32 v45, v96, v97, v45
    v_max3_f32 v45, v98, v99, v45
    v_max3_f32 v45, v100, v101, v45
    v_max3_f32 v45, v102, v103, v45
    v_max3_f32 v45, v104, v105, v45
    v_max3_f32 v45, v106, v107, v45
    v_max3_f32 v45, v108, v109, v45
    v_max3_f32 v45, v110, v111, v45
    ds_read_b128 v[20:23], v157 offset:29184
    ds_read_b32 v24, v158 offset:31232
    ds_read_b128 v[28:31], v159 offset:31488
    ds_read_b128 v[32:35], v159 offset:32128
    s_waitcnt lgkmcnt(0)
    v_mfma_f32_32x32x16_bf16 v[80:95], v[20:23], v[12:15], 0
    v_mfma_f32_32x32x16_bf16 v[96:111], v[20:23], v[16:19], 0
    s_nop 9
    v_mfma_f32_32x32x4_2b_bf16 v[80:111], v[24:25], v[10:11], v[80:111] cbsz:1 abid:0
    s_nop 15
    s_nop 3
    v_max3_f32 v44, v80, v81, v44
    v_max3_f32 v44, v82, v83, v44
    v_max3_f32 v44, v84, v85, v44
    v_max3_f32 v44, v86, v87, v44
    v_max3_f32 v44, v88, v89, v44
    v_max3_f32 v44, v90, v91, v44
    v_max3_f32 v44, v92, v93, v44
    v_max3_f32 v44, v94, v95, v44
    v_max3_f32 v45, v96, v97, v45
    v_max3_f32 v45, v98, v99, v45
    v_max3_f32 v45, v100, v101, v45
    v_max3_f32 v45, v102, v103, v45
    v_max3_f32 v45, v104, v105, v45
    v_max3_f32 v45, v106, v107, v45
    v_max3_f32 v45, v108, v109, v45
    v_max3_f32 v45, v110, v111, v45
    ds_read_b128 v[20:23], v157 offset:30208
    ds_read_b32 v24, v158 offset:31232
    ds_read_b128 v[28:31], v159 offset:32768
    ds_read_b128 v[32:35], v159 offset:33408
    s_waitcnt lgkmcnt(0)
    v_mfma_f32_32x32x16_bf16 v[80:95], v[20:23], v[12:15], 0
    v_mfma_f32_32x32x16_bf16 v[96:111], v[20:23], v[16:19], 0
    s_nop 9
    v_mfma_f32_32x32x4_2b_bf16 v[80:111], v[24:25], v[10:11], v[80:111] cbsz:1 abid:1
    s_nop 15
    s_nop 3
    v_max3_f32 v44, v80, v81, v44
    v_max3_f32 v44, v82, v83, v44
    v_max3_f32 v44, v84, v85, v44
    v_max3_f32 v44, v86, v87, v44
    v_max3_f32 v44, v88, v89, v44
    v_max3_f32 v44, v90, v91, v44
    v_max3_f32 v44, v92, v93, v44
    v_max3_f32 v44, v94, v95, v44
    v_max3_f32 v45, v96, v97, v45
    v_max3_f32 v45, v98, v99, v45
    v_max3_f32 v45, v100, v101, v45
    v_max3_f32 v45, v102, v103, v45
    v_max3_f32 v45, v104, v105, v45
    v_max3_f32 v45, v106, v107, v45
    v_max3_f32 v45, v108, v109, v45
    v_max3_f32 v45, v110, v111, v45
    s_add_u32 s19, s19, 1
    s_cmp_lt_u32 s19, 8
    s_cbranch_scc1 Lslp_115
    v_mov_b32 v46, v44
    v_mov_b32 v47, v45
    s_nop 0
    v_permlane32_swap_b32 v44, v46
    v_permlane32_swap_b32 v45, v47
    v_max_f32 v44, v44, v46
    v_max_f32 v45, v45, v47
    s_lshl_b32 s56, s3, 10
    s_xor_b32 s57, s56, 4096
    s_add_u32 s56, s56, 86016
    s_add_u32 s57, s57, 86016
    v_add_u32 v46, s56, v2
    v_add_u32 v47, s57, v2
    ds_write_b64 v46, v[44:45]
    s_waitcnt lgkmcnt(0)
    s_barrier
    ds_read_b64 v[46:47], v47
    s_waitcnt lgkmcnt(0)
    v_max_f32 v44, v44, v46
    v_max_f32 v45, v45, v47
    s_mov_b32 s40, 0
    s_mov_b32 s19, 0
Lslp_117:
    s_waitcnt vmcnt(0) lgkmcnt(0)
    s_barrier
    s_cmp_eq_u32 s10, 0
    s_cbranch_scc0 Lslb_118
    s_mul_i32 s56, s40, 19456
    s_add_u32 s57, s42, 19456
    s_add_u32 s56, s56, s41
    s_mov_b32 m0, s57
    s_add_u32 s40, s40, 1
    buffer_load_dwordx4 v2, s[20:23], s56 offen offset:0 sc1 lds
    buffer_load_dwordx4 v2, s[20:23], s56 offen offset:1024 sc1 lds
    buffer_load_dwordx4 v2, s[20:23], s56 offen offset:2048 sc1 lds
    buffer_load_dwordx4 v2, s[20:23], s56 offen offset:3072 sc1 lds
    s_add_u32 m0, s57, 4096
    s_add_u32 s56, s56, 4096
    s_mov_b32 exec_hi, 0xffff
    buffer_load_dwordx4 v2, s[20:23], s56 offen sc1 lds
    s_mov_b32 exec_hi, -1
Lslb_118:
    s_waitcnt vmcnt(0)
    s_barrier
    ds_read_b128 v[20:23], v157 offset:19456
    ds_read_b32 v24, v158 offset:21504
    ds_read_b128 v[28:31], v159 offset:21760
    ds_read_b128 v[32:35], v159 offset:22400
    s_waitcnt lgkmcnt(0)
    v_mfma_f32_32x32x16_bf16 v[80:95], v[20:23], v[12:15], 0
    v_mfma_f32_32x32x16_bf16 v[96:111], v[20:23], v[16:19], 0
    s_nop 9
    v_mfma_f32_32x32x4_2b_bf16 v[80:111], v[24:25], v[10:11], v[80:111] cbsz:1 abid:0
    s_nop 15
    s_nop 3
    v_sub_f32 v80, v80, v44
    v_sub_f32 v81, v81, v44
    v_sub_f32 v82, v82, v44
    v_sub_f32 v83, v83, v44
    v_sub_f32 v84, v84, v44
    v_sub_f32 v85, v85, v44
    v_sub_f32 v86, v86, v44
    v_sub_f32 v87, v87, v44
    v_sub_f32 v88, v88, v44
    v_sub_f32 v89, v89, v44
    v_sub_f32 v90, v90, v44
    v_sub_f32 v91, v91, v44
    v_sub_f32 v92, v92, v44
    v_sub_f32 v93, v93, v44
    v_sub_f32 v94, v94, v44
    v_sub_f32 v95, v95, v44
    v_sub_f32 v96, v96, v45
    v_sub_f32 v97, v97, v45
    v_sub_f32 v98, v98, v45
    v_sub_f32 v99, v99, v45
    v_sub_f32 v100, v100, v45
    v_sub_f32 v101, v101, v45
    v_sub_f32 v102, v102, v45
    v_sub_f32 v103, v103, v45
    v_sub_f32 v104, v104, v45
    v_sub_f32 v105, v105, v45
    v_sub_f32 v106, v106, v45
    v_sub_f32 v107, v107, v45
    v_sub_f32 v108, v108, v45
    v_sub_f32 v109, v109, v45
    v_sub_f32 v110, v110, v45
    v_sub_f32 v111, v111, v45
    v_exp_f32 v80, v80
    v_exp_f32 v81, v81
    v_exp_f32 v82, v82
    v_exp_f32 v83, v83
    v_exp_f32 v84, v84
    v_exp_f32 v85, v85
    v_exp_f32 v86, v86
    v_exp_f32 v87, v87
    v_exp_f32 v88, v88
    v_exp_f32 v89, v89
    v_exp_f32 v90, v90
    v_exp_f32 v91, v91
    v_exp_f32 v92, v92
    v_exp_f32 v93, v93
    v_exp_f32 v94, v94
    v_exp_f32 v95, v95
    v_exp_f32 v96, v96
    v_exp_f32 v97, v97
    v_exp_f32 v98, v98
    v_exp_f32 v99, v99
    v_exp_f32 v100, v100
    v_exp_f32 v101, v101
    v_exp_f32 v102, v102
    v_exp_f32 v103, v103
    v_exp_f32 v104, v104
    v_exp_f32 v105, v105
    v_exp_f32 v106, v106
    v_exp_f32 v107, v107
    v_exp_f32 v108, v108
    v_exp_f32 v109, v109
    v_exp_f32 v110, v110
    v_exp_f32 v111, v111
    v_smfmac_f32_32x32x32_bf16 v[48:63], v[28:31], v[80:87], v26
    v_smfmac_f32_32x32x32_bf16 v[48:63], v[32:35], v[88:95], v26
    v_smfmac_f32_32x32x32_bf16 v[64:79], v[28:31], v[96:103], v26
    v_smfmac_f32_32x32x32_bf16 v[64:79], v[32:35], v[104:111], v26
    ds_read_b128 v[20:23], v157 offset:20480
    ds_read_b32 v24, v158 offset:21504
    ds_read_b128 v[28:31], v159 offset:23040
    ds_read_b128 v[32:35], v159 offset:23680
    s_waitcnt lgkmcnt(0)
    v_mfma_f32_32x32x16_bf16 v[80:95], v[20:23], v[12:15], 0
    v_mfma_f32_32x32x16_bf16 v[96:111], v[20:23], v[16:19], 0
    s_nop 9
    v_mfma_f32_32x32x4_2b_bf16 v[80:111], v[24:25], v[10:11], v[80:111] cbsz:1 abid:1
    s_nop 15
    s_nop 3
    v_sub_f32 v80, v80, v44
    v_sub_f32 v81, v81, v44
    v_sub_f32 v82, v82, v44
    v_sub_f32 v83, v83, v44
    v_sub_f32 v84, v84, v44
    v_sub_f32 v85, v85, v44
    v_sub_f32 v86, v86, v44
    v_sub_f32 v87, v87, v44
    v_sub_f32 v88, v88, v44
    v_sub_f32 v89, v89, v44
    v_sub_f32 v90, v90, v44
    v_sub_f32 v91, v91, v44
    v_sub_f32 v92, v92, v44
    v_sub_f32 v93, v93, v44
    v_sub_f32 v94, v94, v44
    v_sub_f32 v95, v95, v44
    v_sub_f32 v96, v96, v45
    v_sub_f32 v97, v97, v45
    v_sub_f32 v98, v98, v45
    v_sub_f32 v99, v99, v45
    v_sub_f32 v100, v100, v45
    v_sub_f32 v101, v101, v45
    v_sub_f32 v102, v102, v45
    v_sub_f32 v103, v103, v45
    v_sub_f32 v104, v104, v45
    v_sub_f32 v105, v105, v45
    v_sub_f32 v106, v106, v45
    v_sub_f32 v107, v107, v45
    v_sub_f32 v108, v108, v45
    v_sub_f32 v109, v109, v45
    v_sub_f32 v110, v110, v45
    v_sub_f32 v111, v111, v45
    v_exp_f32 v80, v80
    v_exp_f32 v81, v81
    v_exp_f32 v82, v82
    v_exp_f32 v83, v83
    v_exp_f32 v84, v84
    v_exp_f32 v85, v85
    v_exp_f32 v86, v86
    v_exp_f32 v87, v87
    v_exp_f32 v88, v88
    v_exp_f32 v89, v89
    v_exp_f32 v90, v90
    v_exp_f32 v91, v91
    v_exp_f32 v92, v92
    v_exp_f32 v93, v93
    v_exp_f32 v94, v94
    v_exp_f32 v95, v95
    v_exp_f32 v96, v96
    v_exp_f32 v97, v97
    v_exp_f32 v98, v98
    v_exp_f32 v99, v99
    v_exp_f32 v100, v100
    v_exp_f32 v101, v101
    v_exp_f32 v102, v102
    v_exp_f32 v103, v103
    v_exp_f32 v104, v104
    v_exp_f32 v105, v105
    v_exp_f32 v106, v106
    v_exp_f32 v107, v107
    v_exp_f32 v108, v108
    v_exp_f32 v109, v109
    v_exp_f32 v110, v110
    v_exp_f32 v111, v111
    v_smfmac_f32_32x32x32_bf16 v[48:63], v[28:31], v[80:87], v26
    v_smfmac_f32_32x32x32_bf16 v[48:63], v[32:35], v[88:95], v26
    v_smfmac_f32_32x32x32_bf16 v[64:79], v[28:31], v[96:103], v26
    v_smfmac_f32_32x32x32_bf16 v[64:79], v[32:35], v[104:111], v26
    ds_read_b128 v[20:23], v157 offset:29184
    ds_read_b32 v24, v158 offset:31232
    ds_read_b128 v[28:31], v159 offset:31488
    ds_read_b128 v[32:35], v159 offset:32128
    s_waitcnt lgkmcnt(0)
    v_mfma_f32_32x32x16_bf16 v[80:95], v[20:23], v[12:15], 0
    v_mfma_f32_32x32x16_bf16 v[96:111], v[20:23], v[16:19], 0
    s_nop 9
    v_mfma_f32_32x32x4_2b_bf16 v[80:111], v[24:25], v[10:11], v[80:111] cbsz:1 abid:0
    s_nop 15
    s_nop 3
    v_sub_f32 v80, v80, v44
    v_sub_f32 v81, v81, v44
    v_sub_f32 v82, v82, v44
    v_sub_f32 v83, v83, v44
    v_sub_f32 v84, v84, v44
    v_sub_f32 v85, v85, v44
    v_sub_f32 v86, v86, v44
    v_sub_f32 v87, v87, v44
    v_sub_f32 v88, v88, v44
    v_sub_f32 v89, v89, v44
    v_sub_f32 v90, v90, v44
    v_sub_f32 v91, v91, v44
    v_sub_f32 v92, v92, v44
    v_sub_f32 v93, v93, v44
    v_sub_f32 v94, v94, v44
    v_sub_f32 v95, v95, v44
    v_sub_f32 v96, v96, v45
    v_sub_f32 v97, v97, v45
    v_sub_f32 v98, v98, v45
    v_sub_f32 v99, v99, v45
    v_sub_f32 v100, v100, v45
    v_sub_f32 v101, v101, v45
    v_sub_f32 v102, v102, v45
    v_sub_f32 v103, v103, v45
    v_sub_f32 v104, v104, v45
    v_sub_f32 v105, v105, v45
    v_sub_f32 v106, v106, v45
    v_sub_f32 v107, v107, v45
    v_sub_f32 v108, v108, v45
    v_sub_f32 v109, v109, v45
    v_sub_f32 v110, v110, v45
    v_sub_f32 v111, v111, v45
    v_exp_f32 v80, v80
    v_exp_f32 v81, v81
    v_exp_f32 v82, v82
    v_exp_f32 v83, v83
    v_exp_f32 v84, v84
    v_exp_f32 v85, v85
    v_exp_f32 v86, v86
    v_exp_f32 v87, v87
    v_exp_f32 v88, v88
    v_exp_f32 v89, v89
    v_exp_f32 v90, v90
    v_exp_f32 v91, v91
    v_exp_f32 v92, v92
    v_exp_f32 v93, v93
    v_exp_f32 v94, v94
    v_exp_f32 v95, v95
    v_exp_f32 v96, v96
    v_exp_f32 v97, v97
    v_exp_f32 v98, v98
    v_exp_f32 v99, v99
    v_exp_f32 v100, v100
    v_exp_f32 v101, v101
    v_exp_f32 v102, v102
    v_exp_f32 v103, v103
    v_exp_f32 v104, v104
    v_exp_f32 v105, v105
    v_exp_f32 v106, v106
    v_exp_f32 v107, v107
    v_exp_f32 v108, v108
    v_exp_f32 v109, v109
    v_exp_f32 v110, v110
    v_exp_f32 v111, v111
    v_smfmac_f32_32x32x32_bf16 v[48:63], v[28:31], v[80:87], v26
    v_smfmac_f32_32x32x32_bf16 v[48:63], v[32:35], v[88:95], v26
    v_smfmac_f32_32x32x32_bf16 v[64:79], v[28:31], v[96:103], v26
    v_smfmac_f32_32x32x32_bf16 v[64:79], v[32:35], v[104:111], v26
    ds_read_b128 v[20:23], v157 offset:30208
    ds_read_b32 v24, v158 offset:31232
    ds_read_b128 v[28:31], v159 offset:32768
    ds_read_b128 v[32:35], v159 offset:33408
    s_waitcnt lgkmcnt(0)
    v_mfma_f32_32x32x16_bf16 v[80:95], v[20:23], v[12:15], 0
    v_mfma_f32_32x32x16_bf16 v[96:111], v[20:23], v[16:19], 0
    s_nop 9
    v_mfma_f32_32x32x4_2b_bf16 v[80:111], v[24:25], v[10:11], v[80:111] cbsz:1 abid:1
    s_nop 15
    s_nop 3
    v_sub_f32 v80, v80, v44
    v_sub_f32 v81, v81, v44
    v_sub_f32 v82, v82, v44
    v_sub_f32 v83, v83, v44
    v_sub_f32 v84, v84, v44
    v_sub_f32 v85, v85, v44
    v_sub_f32 v86, v86, v44
    v_sub_f32 v87, v87, v44
    v_sub_f32 v88, v88, v44
    v_sub_f32 v89, v89, v44
    v_sub_f32 v90, v90, v44
    v_sub_f32 v91, v91, v44
    v_sub_f32 v92, v92, v44
    v_sub_f32 v93, v93, v44
    v_sub_f32 v94, v94, v44
    v_sub_f32 v95, v95, v44
    v_sub_f32 v96, v96, v45
    v_sub_f32 v97, v97, v45
    v_sub_f32 v98, v98, v45
    v_sub_f32 v99, v99, v45
    v_sub_f32 v100, v100, v45
    v_sub_f32 v101, v101, v45
    v_sub_f32 v102, v102, v45
    v_sub_f32 v103, v103, v45
    v_sub_f32 v104, v104, v45
    v_sub_f32 v105, v105, v45
    v_sub_f32 v106, v106, v45
    v_sub_f32 v107, v107, v45
    v_sub_f32 v108, v108, v45
    v_sub_f32 v109, v109, v45
    v_sub_f32 v110, v110, v45
    v_sub_f32 v111, v111, v45
    v_exp_f32 v80, v80
    v_exp_f32 v81, v81
    v_exp_f32 v82, v82
    v_exp_f32 v83, v83
    v_exp_f32 v84, v84
    v_exp_f32 v85, v85
    v_exp_f32 v86, v86
    v_exp_f32 v87, v87
    v_exp_f32 v88, v88
    v_exp_f32 v89, v89
    v_exp_f32 v90, v90
    v_exp_f32 v91, v91
    v_exp_f32 v92, v92
    v_exp_f32 v93, v93
    v_exp_f32 v94, v94
    v_exp_f32 v95, v95
    v_exp_f32 v96, v96
    v_exp_f32 v97, v97
    v_exp_f32 v98, v98
    v_exp_f32 v99, v99
    v_exp_f32 v100, v100
    v_exp_f32 v101, v101
    v_exp_f32 v102, v102
    v_exp_f32 v103, v103
    v_exp_f32 v104, v104
    v_exp_f32 v105, v105
    v_exp_f32 v106, v106
    v_exp_f32 v107, v107
    v_exp_f32 v108, v108
    v_exp_f32 v109, v109
    v_exp_f32 v110, v110
    v_exp_f32 v111, v111
    v_smfmac_f32_32x32x32_bf16 v[48:63], v[28:31], v[80:87], v26
    v_smfmac_f32_32x32x32_bf16 v[48:63], v[32:35], v[88:95], v26
    v_smfmac_f32_32x32x32_bf16 v[64:79], v[28:31], v[96:103], v26
    v_smfmac_f32_32x32x32_bf16 v[64:79], v[32:35], v[104:111], v26
    s_add_u32 s19, s19, 1
    s_cmp_lt_u32 s19, 8
    s_cbranch_scc1 Lslp_117
    s_waitcnt vmcnt(0)
    s_barrier
    s_branch LAfin_55
.section .rodata,"a"
.p2align 6
.amdhsa_kernel interleave_layers__ssm_conv_h3__softmax_full_mha__prompt_kernel
  .amdhsa_next_free_vgpr 253
  .amdhsa_next_free_sgpr 84
  .amdhsa_accum_offset 256
  .amdhsa_group_segment_fixed_size 0
  .amdhsa_kernarg_size 96
  .amdhsa_user_sgpr_count 2
  .amdhsa_user_sgpr_kernarg_segment_ptr 1
  .amdhsa_system_sgpr_workgroup_id_x 1
.end_amdhsa_kernel
```
